```python
import torch

def _softmax(x, axis=-1):
    return torch.softmax(x, dim=axis)
def _gelu(x):
    return torch.nn.functional.gelu(x, approximate="tanh")
def _silu(x):
    return torch.nn.functional.silu(x)
def _sigmoid(x):
    return torch.sigmoid(x)
def _layernorm(x, axis=-1, eps=1e-5):
    m = x.mean(dim=axis, keepdim=True)
    v = x.var(dim=axis, keepdim=True, unbiased=False)
    return (x - m) / torch.sqrt(v + eps)
def _scatter_add(tgt, idx, src, axis=0):
    return tgt.clone().index_add_(axis, idx, src)
def _segment_sum(src, seg, n):
    out = torch.zeros((n,) + src.shape[1:], dtype=src.dtype)
    return out.index_add_(0, seg, src)
def _pad(x, pw):
    flat = tuple(v for pair in reversed(pw) for v in pair)
    return torch.nn.functional.pad(x, flat)

kernel_name = 'gated_mix__sliding_block__swiglu_ffn__prompt'

def setup_inputs():

    _w = (lambda a: (lambda t: t.to(torch.bfloat16) if t.is_floating_point() else t)(torch.as_tensor(a)))
    def _A_setup():
        B, S, D = 1, 2048, 512
        return {
            "x": _w((lambda *s: torch.randn(*s, dtype=torch.bfloat16) * 0.05)(B, S, D)),
            "wqkv": _w((lambda *s: torch.randn(*s, dtype=torch.bfloat16) * 0.8)(D, 3 * D)),
            "wo": _w((lambda *s: torch.randn(*s, dtype=torch.bfloat16) * 0.05)(D, D)),
        }
    _A_in = _A_setup()

    def _B_setup():
        B, S, D, F = 1, 2048, 512, 1376
        return {
            "x": _w((lambda *s: torch.randn(*s, dtype=torch.bfloat16) * 0.05)(B, S, D)),
            "w_gate": _w((lambda *s: torch.randn(*s, dtype=torch.bfloat16) * 0.2)(D, F)),
            "w_up": _w((lambda *s: torch.randn(*s, dtype=torch.bfloat16) * 0.2)(D, F)),
            "w_down": _w((lambda *s: torch.randn(*s, dtype=torch.bfloat16) * 0.2)(F, D)),
        }
    _B_in = _B_setup()

    return {
        "A_x": _A_in["x"],
        "A_wqkv": _A_in["wqkv"],
        "A_wo": _A_in["wo"],
        "B_x": _B_in["x"],
        "B_w_gate": _B_in["w_gate"],
        "B_w_up": _B_in["w_up"],
        "B_w_down": _B_in["w_down"],
        "gate_w": _w((lambda *s: torch.randn(*s, dtype=torch.bfloat16) * 0.05)(512) * 16.0),
    }

def reference(A_x, A_wqkv, A_wo, B_x, B_w_gate, B_w_up, B_w_down, gate_w):
    def _A_ref(x, wqkv, wo):
        B, S, D = x.shape
        H = 32; Dh = D // H; W = 256
        qkv = (lambda x, *d: x.permute(*d))((x @ wqkv).reshape(B, S, 3, H, Dh), 2, 0, 3, 1, 4)
        q, k, v = qkv[0], qkv[1], qkv[2]
        scores = torch.einsum("bhqd,bhkd->bhqk", q, k) * (Dh ** -0.5)
        idx = torch.arange(S)
        mask = (idx[:, None] - idx[None, :] >= 0) & (idx[:, None] - idx[None, :] < W)
        scores = torch.where(mask[None, None], scores, -1e9)
        p = _softmax(scores, axis=-1)
        o = torch.einsum("bhqk,bhkd->bhqd", p, v)
        return (lambda x, *d: x.permute(*d))(o, 0, 2, 1, 3).reshape(B, S, D) @ wo

    def _B_ref(x, w_gate, w_up, w_down):
        g = _silu(x @ w_gate)
        u = x @ w_up
        return (g * u) @ w_down

    x = A_x
    g = _sigmoid((x * gate_w).sum(-1, keepdims=True))
    a = _A_ref(x, A_wqkv, A_wo)
    b = _B_ref(x, B_w_gate, B_w_up, B_w_down)
    return g * a + (1 - g) * b
```

```asm
; @launch grid=(256,1,1) block=(512,1,1) lds=163840
.amdgcn_target "amdgcn-amd-amdhsa--gfx950"
.text
.globl gated_mix__sliding_block__swiglu_ffn__prompt_kernel
.p2align 8
.type gated_mix__sliding_block__swiglu_ffn__prompt_kernel,@function
gated_mix__sliding_block__swiglu_ffn__prompt_kernel:
    s_cmp_ge_u32 s2, 256
    s_cbranch_scc1 L_end
    s_load_dwordx2 s[8:9], s[0:1], 0
    s_load_dwordx2 s[12:13], s[0:1], 8
    s_load_dwordx2 s[40:41], s[0:1], 56
    s_getpc_b64 s[56:57]
L_cw:
    s_lshr_b32 s55, s2, 3
    v_lshlrev_b32 v1, 7, v0
    s_lshl_b32 s55, s55, 7
    s_mov_b32 exec_lo, 1
    v_add_u32 v1, s55, v1
    s_mov_b32 exec_hi, 1
    v_min_u32 v1, L_end-L_cw, v1
    global_load_dword a126, v1, s[56:57]
    s_mov_b64 exec, -1
    v_lshrrev_b32 v1, 6, v0
    v_and_b32 v0, 63, v0
    v_readfirstlane_b32 s48, v1
    s_bfe_u32 s55, s2, 0x30003
    s_and_b32 s49, s2, 1
    s_lshl3_add_u32 s49, s49, s55
    s_lshr_b32 s56, s2, 6
    s_bfe_u32 s50, s2, 0x20001
    s_lshl2_add_u32 s50, s50, s56

    s_mul_i32 s51, s56, 4
    s_mul_i32 s57, s55, 4
    s_add_u32 s51, s51, s57
    s_and_b32 s51, s51, 7
    v_lshrrev_b32 v1, 3, v0
    v_and_b32 v2, 7, v0
    v_lshrrev_b32 v3, 4, v0
    v_lshrrev_b32 v4, 5, v0
    v_and_or_b32 v4, v1, 2, v4
    v_xor_b32 v4, v2, v4
    s_lshl_b32 s55, s49, 17
    v_lshl_add_u32 v5, v1, 10, s55
    v_lshl_add_u32 v8, v4, 4, v5
    v_xor_b32 v9, 64, v8
    v_add_u32 v9, 8192, v9
    s_mov_b32 s10, 2097152
    s_mov_b32 s11, 0x20000
    s_lshl_b32 s53, s48, 14
    s_lshl_b32 s3, s48, 11
    v_lshlrev_b32 v6, 4, v0
    v_add_u32 v16, 153344, v6
    v_mov_b32 v12, -1
    v_mov_b32 v13, -1
    v_mov_b32 v14, -1
    v_mov_b32 v15, -1
    s_add_u32 s57, s51, 0
    s_and_b32 s57, s57, 7
    s_lshl_b32 s59, s57, 7
    s_mul_i32 s61, s57, 196608
    s_add_u32 s59, s59, s53
    s_add_u32 m0, s3, 0
    s_waitcnt lgkmcnt(0)
    buffer_load_dwordx4 v8, s[8:11], s59 offen lds
    s_add_u32 m0, s3, 1024
    ds_write_b128 v16, v[12:15]
    buffer_load_dwordx4 v9, s[8:11], s59 offen lds
    s_lshr_b32 s55, s50, 1
    s_lshl_b32 s55, s55, 7
    s_and_b32 s56, s50, 1
    s_lshl_b32 s58, s56, 10
    s_add_u32 s58, s58, s55
    s_add_u32 s58, s58, 1024
    s_movk_i32 s56, 3072
    v_and_b32 v3, 1, v3
    v_lshlrev_b32 v3, 2, v3
    v_xor_b32 v2, v2, v3
    v_lshl_add_u32 v2, v2, 4, s58
    v_mad_u32_u24 v10, v1, s56, v2
    s_mov_b32 s14, 1572864
    s_mov_b32 s15, 0x20000
    s_mul_i32 s54, s48, 24576
    s_lshr_b32 s6, s48, 1
    s_lshl_b32 s6, s6, 5
    s_lshl_b32 s4, s48, 10
    s_add_u32 s5, s4, s6
    s_add_u32 s61, s61, s54
    s_add_u32 m0, s5, 65536
    s_lshl_b32 s55, s50, 6
    buffer_load_dwordx4 v10, s[12:15], s61 offen lds
    v_lshrrev_b32 v1, 2, v0
    v_and_b32 v2, 3, v0
    v_lshl_add_u32 v2, v2, 4, s55
    v_mad_u32_u24 v11, v1, s56, v2
    s_lshl_b32 s55, s48, 9
    s_add_u32 s6, s6, s55
    s_add_u32 m0, s6, 73856
    s_mov_b32 exec_hi, 0
    buffer_load_dwordx4 v11, s[12:15], s61 offen lds
    s_mov_b32 exec_hi, -1
    s_lshl_b32 s55, s51, 7
    v_add_u32 v6, s55, v6
    v_and_b32 v6, 1023, v6
    s_min_u32 s55, s4, 1024
    s_mov_b32 s42, 1024
    s_mov_b32 s43, 0x20000
    s_add_u32 m0, s55, 154368
    s_mov_b32 s58, 2147483632
    buffer_load_dwordx4 v6, s[40:43], s55 offen lds
    s_lshl2_add_u32 m0, s48, 153344
    s_waitcnt lgkmcnt(0)
    s_barrier
    s_mov_b64 exec, 1
    buffer_load_dword v0, s[8:11], s58 offen lds
    s_mov_b64 exec, -1
    s_load_dwordx2 s[16:17], s[0:1], 32
    s_load_dwordx2 s[32:33], s[0:1], 80
    s_load_dwordx2 s[44:45], s[0:1], 72
    s_load_dwordx2 s[20:21], s[0:1], 40
    s_load_dwordx2 s[24:25], s[0:1], 48
    s_load_dwordx2 s[28:29], s[0:1], 16
    s_load_dwordx2 s[36:37], s[0:1], 64
    s_add_u32 s57, s51, 1
    s_and_b32 s57, s57, 7
    s_lshl_b32 s59, s57, 7
    s_mul_i32 s61, s57, 196608
    s_add_u32 s59, s59, s53
    s_add_u32 m0, s3, 16384
    s_add_u32 s61, s61, s54
    buffer_load_dwordx4 v8, s[8:11], s59 offen lds
    s_add_u32 m0, s5, 78080
    s_nop 0
    buffer_load_dwordx4 v10, s[12:15], s61 offen lds
    s_add_u32 m0, s3, 17408
    s_nop 0
    buffer_load_dwordx4 v9, s[8:11], s59 offen lds
    s_add_u32 m0, s6, 86400
    s_mov_b32 exec_hi, 0
    buffer_load_dwordx4 v11, s[12:15], s61 offen lds
    s_lshl2_add_u32 m0, s48, 153376
    s_mov_b64 exec, 1
    buffer_load_dword v0, s[8:11], s58 offen lds
    s_mov_b64 exec, -1
    s_and_b32 s52, s48, 3
    s_lshl_b32 s3, s52, 12
    s_mul_i32 s5, s52, 2080
    s_mul_i32 s6, s52, 1056
    s_lshl2_add_u32 s40, s52, 153344
    s_mov_b32 s41, 2147483632
    s_bfe_u32 s56, s2, 0x20001
    s_lshr_b32 s55, s2, 6
    s_lshl3_add_u32 s55, s55, s48
    s_lshl2_add_u32 s55, s55, s56
    s_lshl_b32 s57, s49, 7
    s_add_u32 s55, s55, s57
    s_lshl_b32 s55, s55, 10
    v_lshlrev_b32 v1, 7, v0
    s_mov_b64 exec, 0xcc
    buffer_load_dword a125, v1, s[8:11], s55 offen
    s_mov_b64 exec, 0x3f
    s_and_b32 s55, s2, 0xf8
    s_add_u32 s55, s55, s48
    s_and_b32 s57, s2, 1
    s_lshl1_add_u32 s55, s55, s57
    s_mul_i32 s55, s55, 3072
    s_lshl_b32 s56, s56, 8
    s_add_u32 s55, s55, s56
    v_lshrrev_b32 v2, 1, v0
    v_and_b32 v1, 128, v1
    v_lshl_add_u32 v1, v2, 10, v1
    buffer_load_dword a125, v1, s[12:15], s55 offen
    s_mov_b64 exec, -1
    s_cmp_lt_u32 s48, 4
    s_cbranch_scc1 L_g1_A
    s_lshl_b32 s55, s52, 15
    s_mul_i32 s56, s52, 49152
    v_add_u32 v8, s55, v8
    v_add_u32 v9, s55, v9
    v_add_u32 v10, s56, v10
    v_add_u32 v11, s56, v11
    s_add_u32 s57, s51, 2
    s_and_b32 s57, s57, 7
    s_lshl_b32 s59, s57, 7
    s_mul_i32 s61, s57, 196608
    s_add_u32 m0, s3, 32768
    s_nop 0
    buffer_load_dwordx4 v8, s[8:11], s59 offen  lds
    s_add_u32 m0, s5, 90624
    s_nop 0
    buffer_load_dwordx4 v10, s[12:15], s61 offen  lds
    s_add_u32 m0, s3, 33792
    s_nop 0
    buffer_load_dwordx4 v9, s[8:11], s59 offen  lds
    s_add_u32 m0, s6, 98944
    s_nop 0
    buffer_load_dwordx4 v11, s[12:15], s61 offen  lds
    s_add_u32 s59, s59, 16384
    s_add_u32 s61, s61, 24576
    s_add_u32 m0, s3, 34816
    s_nop 0
    buffer_load_dwordx4 v8, s[8:11], s59 offen  lds
    s_add_u32 m0, s5, 91648
    s_nop 0
    buffer_load_dwordx4 v10, s[12:15], s61 offen  lds
    s_add_u32 m0, s3, 35840
    s_nop 0
    buffer_load_dwordx4 v9, s[8:11], s59 offen  lds
    s_add_u32 m0, s40, 64
    s_mov_b64 exec, 1
    buffer_load_dword v0, s[8:11], s41 offen lds
    s_mov_b64 exec, -1
    s_mov_b32 s101, 0
    s_mov_b32 s42, 400000
    s_waitcnt lgkmcnt(0)
    s_mov_b32 s18, 1409024
    s_mov_b32 s19, 0x20000
    s_mov_b32 s34, 268435456
    s_mov_b32 s35, 0x20000
    s_mov_b32 s46, 256
    s_mov_b32 s47, 0x20000
    s_mov_b32 s22, 1409024
    s_mov_b32 s23, 0x20000
    s_mov_b32 s26, 1409024
    s_mov_b32 s27, 0x20000
    s_mov_b32 s30, 524288
    s_mov_b32 s31, 0x20000
    s_mov_b32 s38, 2097152
    s_mov_b32 s39, 0x20000
    s_bfe_u32 s53, s2, 0x20001
    s_bfe_u32 s57, s2, 0x30003
    s_lshl3_add_u32 s96, s53, s57
    s_and_b32 s53, s2, 1
    s_lshr_b32 s97, s2, 6
    s_lshl2_add_u32 s97, s53, s97
    s_lshr_b32 s55, s50, 2
    s_and_b32 s56, s50, 3
    s_mul_i32 s55, s55, 11
    s_mul_i32 s56, s56, 3
    s_add_u32 s62, s55, s56
    s_sub_u32 s63, 11, s56
    s_min_u32 s63, s63, 3
    s_sub_u32 s55, 43, s62
    s_min_u32 s63, s63, s55
    s_mul_i32 s4, s52, 3104
    s_lshl2_add_u32 s7, s49, s52

    v_mov_b32 v6, 0
    v_and_b32 v125, 3, v0
    v_lshlrev_b32 v125, 2, v125
    v_add_u32 v125, 153344, v125
    v_lshlrev_b32 v121, 4, v0
    s_lshl3_add_u32 s55, s2, s48
    s_cmp_eq_u32 s55, 4
    s_cselect_b32 s53, 0, 2147483632
    s_add_u32 s54, s53, 15335424
    buffer_load_dword v15, v6, s[32:35], s54 offen sc1
    s_mul_i32 s55, s52, 44032
    s_lshl_b32 s56, s62, 6
    s_add_u32 s55, s55, s56
    s_movk_i32 s56, 2752
    s_and_b32 s57, s62, 1
    s_lshl_b32 s58, s63, 2
    v_mov_b32 v5, 2147483632
    v_add_u32 v1, 0, v0
    v_mul_u32_u24 v2, 171, v1
    v_lshrrev_b32 v2, 11, v2
    v_mul_u32_u24 v3, 12, v2
    v_sub_u32 v3, v1, v3
    v_xor_b32 v2, s57, v2
    v_mul_u32_u24 v2, s56, v2
    v_lshl_add_u32 v2, v3, 4, v2
    v_cmp_gt_u32 vcc, s58, v3
    v_add_u32 v2, s55, v2
    s_nop 0
    v_cndmask_b32 v12, v5, v2, vcc
    v_add_u32 v1, 64, v0
    v_mul_u32_u24 v2, 171, v1
    v_lshrrev_b32 v2, 11, v2
    v_mul_u32_u24 v3, 12, v2
    v_sub_u32 v3, v1, v3
    v_xor_b32 v2, s57, v2
    v_mul_u32_u24 v2, s56, v2
    v_lshl_add_u32 v2, v3, 4, v2
    v_cmp_gt_u32 vcc, s58, v3
    v_add_u32 v2, s55, v2
    s_nop 0
    v_cndmask_b32 v13, v5, v2, vcc
    v_add_u32 v1, 128, v0
    v_mul_u32_u24 v2, 171, v1
    v_lshrrev_b32 v2, 11, v2
    v_mul_u32_u24 v3, 12, v2
    v_sub_u32 v3, v1, v3
    v_xor_b32 v2, s57, v2
    v_mul_u32_u24 v2, s56, v2
    v_lshl_add_u32 v2, v3, 4, v2
    v_cmp_gt_u32 vcc, s58, v3
    v_add_u32 v2, s55, v2
    s_nop 0
    v_cndmask_b32 v14, v5, v2, vcc
    s_add_u32 s57, s51, 3
    s_and_b32 s57, s57, 7
    s_lshl_b32 s59, s57, 7
    s_mul_i32 s61, s57, 196608
    s_add_u32 m0, s3, 49152
    s_nop 0
    buffer_load_dwordx4 v8, s[8:11], s59 offen  lds
    s_add_u32 m0, s5, 103168
    s_nop 0
    buffer_load_dwordx4 v10, s[12:15], s61 offen  lds
    s_add_u32 m0, s3, 50176
    s_nop 0
    buffer_load_dwordx4 v9, s[8:11], s59 offen  lds
    s_add_u32 m0, s6, 111488
    s_nop 0
    buffer_load_dwordx4 v11, s[12:15], s61 offen  lds
    s_add_u32 s59, s59, 16384
    s_add_u32 s61, s61, 24576
    s_add_u32 m0, s3, 51200
    s_nop 0
    buffer_load_dwordx4 v8, s[8:11], s59 offen  lds
    s_add_u32 m0, s5, 104192
    s_nop 0
    buffer_load_dwordx4 v10, s[12:15], s61 offen  lds
    s_add_u32 m0, s3, 52224
    s_nop 0
    buffer_load_dwordx4 v9, s[8:11], s59 offen  lds
    s_add_u32 m0, s40, 80
    s_mov_b64 exec, 1
    buffer_load_dword v0, s[8:11], s41 offen lds
    s_mov_b64 exec, -1
    s_waitcnt vmcnt(8)
    v_add_u32 v15, 0x9e3779b9, v15
    v_max_u32 v15, 1, v15
    s_mov_b64 exec, 1
    buffer_store_dword v15, v6, s[44:47], s53 offen sc1
    buffer_store_dword v15, v6, s[32:35], s54 offen sc1
    s_mov_b64 exec, -1
    s_barrier
    s_add_u32 s57, s51, 4
    s_and_b32 s57, s57, 7
    s_lshl_b32 s59, s57, 7
    s_mul_i32 s61, s57, 196608
    s_add_u32 m0, s3, 0
    s_nop 0
    buffer_load_dwordx4 v8, s[8:11], s59 offen  lds
    v_and_b32 v3, 31, v0
    v_lshrrev_b32 v4, 5, v0
    v_lshlrev_b32 v4, 2, v4
    s_add_u32 m0, s5, 65536
    s_nop 0
    buffer_load_dwordx4 v10, s[12:15], s61 offen  lds
    v_sub_u32 v3, v3, v4
    v_mov_b32 v4, 0xffff
    v_mov_b32 v5, 0x3f803f80
    s_add_u32 m0, s3, 1024
    s_nop 0
    buffer_load_dwordx4 v9, s[8:11], s59 offen  lds
    s_mov_b32 vcc_lo, 0x110000
    s_mov_b32 vcc_hi, 0x110000
    v_cndmask_b32 v5, 0, v5, vcc
    v_sub_u32 v96, -1, v3
    v_ashrrev_i32 v96, 31, v96
    s_add_u32 m0, s6, 73856
    s_nop 0
    buffer_load_dwordx4 v11, s[12:15], s61 offen  lds
    v_sub_u32 v97, 0, v3
    v_ashrrev_i32 v97, 31, v97
    v_sub_u32 v98, 1, v3
    s_add_u32 s59, s59, 16384
    s_add_u32 s61, s61, 24576
    s_add_u32 m0, s3, 2048
    s_nop 0
    buffer_load_dwordx4 v8, s[8:11], s59 offen  lds
    v_ashrrev_i32 v98, 31, v98
    v_sub_u32 v99, 2, v3
    v_ashrrev_i32 v99, 31, v99
    s_add_u32 m0, s5, 66560
    s_nop 0
    buffer_load_dwordx4 v10, s[12:15], s61 offen  lds
    v_sub_u32 v100, 7, v3
    v_ashrrev_i32 v100, 31, v100
    v_sub_u32 v101, 8, v3
    s_add_u32 m0, s3, 3072
    s_nop 0
    buffer_load_dwordx4 v9, s[8:11], s59 offen  lds
    v_ashrrev_i32 v101, 31, v101
    v_sub_u32 v102, 9, v3
    v_ashrrev_i32 v102, 31, v102
    s_add_u32 m0, s40, 96
    s_mov_b64 exec, 1
    buffer_load_dword v0, s[8:11], s41 offen lds
    s_mov_b64 exec, -1
    s_barrier
    s_add_u32 s57, s51, 5
    s_and_b32 s57, s57, 7
    s_lshl_b32 s59, s57, 7
    s_mul_i32 s61, s57, 196608
    s_add_u32 m0, s3, 16384
    s_nop 0
    buffer_load_dwordx4 v8, s[8:11], s59 offen  lds
    v_sub_u32 v103, 10, v3
    v_ashrrev_i32 v103, 31, v103
    v_sub_u32 v104, 15, v3
    s_add_u32 m0, s5, 78080
    s_nop 0
    buffer_load_dwordx4 v10, s[12:15], s61 offen  lds
    v_ashrrev_i32 v104, 31, v104
    v_sub_u32 v105, 16, v3
    v_ashrrev_i32 v105, 31, v105
    s_add_u32 m0, s3, 17408
    s_nop 0
    buffer_load_dwordx4 v9, s[8:11], s59 offen  lds
    v_sub_u32 v106, 17, v3
    v_ashrrev_i32 v106, 31, v106
    v_sub_u32 v107, 18, v3
    s_add_u32 m0, s6, 86400
    s_nop 0
    buffer_load_dwordx4 v11, s[12:15], s61 offen  lds
    v_ashrrev_i32 v107, 31, v107
    v_sub_u32 v108, 23, v3
    v_ashrrev_i32 v108, 31, v108
    s_add_u32 s59, s59, 16384
    s_add_u32 s61, s61, 24576
    s_add_u32 m0, s3, 18432
    s_nop 0
    buffer_load_dwordx4 v8, s[8:11], s59 offen  lds
    v_sub_u32 v109, 24, v3
    v_ashrrev_i32 v109, 31, v109
    v_sub_u32 v110, 25, v3
    s_add_u32 m0, s5, 79104
    s_nop 0
    buffer_load_dwordx4 v10, s[12:15], s61 offen  lds
    v_ashrrev_i32 v110, 31, v110
    v_sub_u32 v111, 26, v3
    v_ashrrev_i32 v111, 31, v111
    s_add_u32 m0, s3, 19456
    s_nop 0
    buffer_load_dwordx4 v9, s[8:11], s59 offen  lds
    v_bfi_b32 v112, v4, v96, v97
    v_bfi_b32 v113, v4, v98, v99
    v_bfi_b32 v114, v4, v100, v101
    s_add_u32 m0, s40, 112
    s_mov_b64 exec, 1
    buffer_load_dword v0, s[8:11], s41 offen lds
    s_mov_b64 exec, -1
    v_and_b32 v1, 7, v0
    v_lshlrev_b32 v1, 7, v1
    v_min_u32 v1, 700, v1
    v_lshrrev_b32 v2, 3, v0
    v_mul_u32_u24 v2, 5504, v2
    s_lshr_b32 s55, s2, 3
    s_lshl2_add_u32 s55, s55, s52
    s_bfe_u32 s57, s2, 0x20001
    s_mul_i32 s58, s55, 11008
    s_mul_i32 s57, s57, 704
    s_add_u32 s58, s58, s57
    v_add3_u32 v42, v1, v2, s58
    s_and_b32 s56, s2, 1
    s_lshl3_add_u32 s58, s55, s56
    s_lshl_b32 s58, s58, 9
    v_and_b32 v1, 3, v0
    v_lshlrev_b32 v1, 7, v1
    v_lshrrev_b32 v2, 2, v0
    v_lshl_add_u32 v1, v2, 19, v1
    v_add_u32 v43, s58, v1
    s_xor_b32 s56, s2, 0
    s_and_b32 s56, s56, 1
    s_mul_i32 s56, s56, 2752
    s_mov_b64 exec, 0x7f7f
    buffer_load_dword v127, v42, s[16:19], s56 offen
    s_mov_b64 exec, -1
    s_xor_b32 s56, s2, 0
    s_and_b32 s56, s56, 1
    s_mul_i32 s56, s56, 2752
    s_mov_b64 exec, 0x7f7f
    buffer_load_dword v127, v42, s[20:23], s56 offen
    s_mov_b64 exec, -1
    s_barrier
    s_add_u32 s57, s51, 6
    s_and_b32 s57, s57, 7
    s_lshl_b32 s59, s57, 7
    s_mul_i32 s61, s57, 196608
    s_add_u32 m0, s3, 32768
    s_nop 0
    buffer_load_dwordx4 v8, s[8:11], s59 offen  lds
    v_bfi_b32 v115, v4, v102, v103
    v_bfi_b32 v116, v4, v104, v105
    v_bfi_b32 v117, v4, v106, v107
    s_add_u32 m0, s5, 90624
    s_nop 0
    buffer_load_dwordx4 v10, s[12:15], s61 offen  lds
    v_bfi_b32 v118, v4, v108, v109
    v_bfi_b32 v119, v4, v110, v111
    v_accvgpr_write_b32 a36, v5
    s_add_u32 m0, s3, 33792
    s_nop 0
    buffer_load_dwordx4 v9, s[8:11], s59 offen  lds
    v_accvgpr_write_b32 a37, v5
    v_accvgpr_write_b32 a38, v5
    v_accvgpr_write_b32 a39, v5
    s_add_u32 m0, s6, 98944
    s_nop 0
    buffer_load_dwordx4 v11, s[12:15], s61 offen  lds
    v_accvgpr_write_b32 a40, v5
    v_accvgpr_write_b32 a41, v5
    v_accvgpr_write_b32 a42, v5
    s_add_u32 s59, s59, 16384
    s_add_u32 s61, s61, 24576
    s_add_u32 m0, s3, 34816
    s_nop 0
    buffer_load_dwordx4 v8, s[8:11], s59 offen  lds
    v_accvgpr_write_b32 a43, v5
    v_accvgpr_write_b32 a44, v5
    v_accvgpr_write_b32 a45, v5
    s_add_u32 m0, s5, 91648
    s_nop 0
    buffer_load_dwordx4 v10, s[12:15], s61 offen  lds
    v_accvgpr_write_b32 a46, v5
    v_accvgpr_write_b32 a47, v5
    v_accvgpr_write_b32 a48, v5
    s_add_u32 m0, s3, 35840
    s_nop 0
    buffer_load_dwordx4 v9, s[8:11], s59 offen  lds
    v_accvgpr_write_b32 a49, v5
    v_accvgpr_write_b32 a50, v5
    v_accvgpr_write_b32 a51, v5
    s_add_u32 m0, s40, 128
    s_mov_b64 exec, 1
    buffer_load_dword v0, s[8:11], s41 offen lds
    s_mov_b64 exec, -1
    s_barrier
    s_add_u32 s57, s51, 7
    s_and_b32 s57, s57, 7
    s_lshl_b32 s59, s57, 7
    s_mul_i32 s61, s57, 196608
    s_add_u32 m0, s3, 49152
    s_nop 0
    buffer_load_dwordx4 v8, s[8:11], s59 offen  lds
    v_accvgpr_write_b32 a52, v5
    v_accvgpr_write_b32 a53, v5
    v_accvgpr_write_b32 a54, v5
    s_add_u32 m0, s5, 103168
    s_nop 0
    buffer_load_dwordx4 v10, s[12:15], s61 offen  lds
    v_accvgpr_write_b32 a55, v5
    v_accvgpr_write_b32 a56, v5
    v_accvgpr_write_b32 a57, v5
    s_add_u32 m0, s3, 50176
    s_nop 0
    buffer_load_dwordx4 v9, s[8:11], s59 offen  lds
    v_accvgpr_write_b32 a58, v5
    v_accvgpr_write_b32 a59, v5
    v_accvgpr_write_b32 a60, v5
    s_add_u32 m0, s6, 111488
    s_nop 0
    buffer_load_dwordx4 v11, s[12:15], s61 offen  lds
    v_accvgpr_write_b32 a61, v5
    v_accvgpr_write_b32 a62, v5
    v_accvgpr_write_b32 a63, v5
    s_add_u32 s59, s59, 16384
    s_add_u32 s61, s61, 24576
    s_add_u32 m0, s3, 51200
    s_nop 0
    buffer_load_dwordx4 v8, s[8:11], s59 offen  lds
    v_accvgpr_write_b32 a64, v5
    v_accvgpr_write_b32 a65, v5
    v_accvgpr_write_b32 a66, v5
    s_add_u32 m0, s5, 104192
    s_nop 0
    buffer_load_dwordx4 v10, s[12:15], s61 offen  lds
    v_accvgpr_write_b32 a67, v5
    v_accvgpr_write_b32 a68, v5
    v_accvgpr_write_b32 a69, v5
    s_add_u32 m0, s3, 52224
    s_nop 0
    buffer_load_dwordx4 v9, s[8:11], s59 offen  lds
    v_accvgpr_write_b32 a70, v5
    v_accvgpr_write_b32 a71, v5
    v_accvgpr_write_b32 a72, v5
    s_add_u32 m0, s40, 144
    s_mov_b64 exec, 1
    buffer_load_dword v0, s[8:11], s41 offen lds
    s_mov_b64 exec, -1
    s_add_u32 s57, s51, 0
    s_and_b32 s57, s57, 7
    s_mul_i32 s60, s57, 176128
    s_add_u32 m0, s4, 115712
    s_nop 0
    buffer_load_dwordx4 v12, s[16:19], s60 offen  lds
    v_accvgpr_write_b32 a73, v5
    v_accvgpr_write_b32 a74, v5
    v_accvgpr_write_b32 a75, v5
    s_add_u32 m0, s4, 116736
    s_nop 0
    buffer_load_dwordx4 v13, s[16:19], s60 offen  lds
    v_accvgpr_write_b32 a76, v5
    v_accvgpr_write_b32 a77, v5
    v_accvgpr_write_b32 a78, v5
    s_add_u32 m0, s4, 117760
    s_nop 0
    buffer_load_dwordx4 v14, s[16:19], s60 offen  lds
    v_accvgpr_write_b32 a79, v5
    v_accvgpr_write_b32 a80, v5
    v_accvgpr_write_b32 a81, v5
    s_add_u32 m0, s40, 160
    s_mov_b64 exec, 1
    buffer_load_dword v0, s[8:11], s41 offen lds
    s_mov_b64 exec, -1
    buffer_load_dword v15, off, s[44:47], 0 sc1
    s_add_u32 s57, s51, 1
    s_and_b32 s57, s57, 7
    s_mul_i32 s60, s57, 176128
    s_add_u32 m0, s4, 128256
    s_nop 0
    buffer_load_dwordx4 v12, s[16:19], s60 offen  lds
    v_accvgpr_write_b32 a82, v5
    v_accvgpr_write_b32 a83, v5
    v_accvgpr_write_b32 a84, v5
    s_add_u32 m0, s4, 129280
    s_nop 0
    buffer_load_dwordx4 v13, s[16:19], s60 offen  lds
    v_accvgpr_write_b32 a85, v5
    v_accvgpr_write_b32 a86, v5
    v_accvgpr_write_b32 a87, v5
    s_add_u32 m0, s4, 130304
    s_nop 0
    buffer_load_dwordx4 v14, s[16:19], s60 offen  lds
    v_accvgpr_write_b32 a88, v5
    v_accvgpr_write_b32 a89, v5
    v_accvgpr_write_b32 a90, v5
    s_add_u32 m0, s40, 176
    s_mov_b64 exec, 1
    buffer_load_dword v0, s[8:11], s41 offen lds
    s_mov_b64 exec, -1
    s_add_u32 s57, s51, 2
    s_and_b32 s57, s57, 7
    s_mul_i32 s60, s57, 176128
    s_add_u32 m0, s4, 140800
    s_nop 0
    buffer_load_dwordx4 v12, s[16:19], s60 offen  lds
    v_accvgpr_write_b32 a91, v5
    v_accvgpr_write_b32 a92, v5
    v_accvgpr_write_b32 a93, v5
    s_add_u32 m0, s4, 141824
    s_nop 0
    buffer_load_dwordx4 v13, s[16:19], s60 offen  lds
    v_accvgpr_write_b32 a94, v5
    v_accvgpr_write_b32 a95, v5
    v_accvgpr_write_b32 a96, v5
    s_add_u32 m0, s4, 142848
    s_nop 0
    buffer_load_dwordx4 v14, s[16:19], s60 offen  lds
    v_accvgpr_write_b32 a97, v5
    v_accvgpr_write_b32 a98, v5
    v_accvgpr_write_b32 a99, v5
    s_barrier
    s_add_u32 s57, s51, 3
    s_and_b32 s57, s57, 7
    s_mul_i32 s60, s57, 176128
    s_add_u32 m0, s4, 65536
    s_nop 0
    buffer_load_dwordx4 v12, s[16:19], s60 offen  lds
    v_accvgpr_write_b32 a100, v5
    v_accvgpr_write_b32 a101, v5
    v_accvgpr_write_b32 a102, v5
    s_add_u32 m0, s4, 66560
    s_nop 0
    buffer_load_dwordx4 v13, s[16:19], s60 offen  lds
    v_accvgpr_write_b32 a103, v5
    v_accvgpr_write_b32 a104, v5
    v_accvgpr_write_b32 a105, v5
    s_add_u32 m0, s4, 67584
    s_nop 0
    buffer_load_dwordx4 v14, s[16:19], s60 offen  lds
    v_accvgpr_write_b32 a106, v5
    v_accvgpr_write_b32 a107, v5
    s_add_u32 m0, s40, 192
    s_mov_b64 exec, 1
    buffer_load_dword v0, s[8:11], s41 offen lds
    s_mov_b64 exec, -1
    s_add_u32 s57, s51, 4
    s_and_b32 s57, s57, 7
    s_mul_i32 s60, s57, 176128
    s_add_u32 m0, s4, 0
    s_nop 0
    buffer_load_dwordx4 v12, s[16:19], s60 offen  lds
    s_add_u32 m0, s4, 1024
    s_nop 0
    buffer_load_dwordx4 v13, s[16:19], s60 offen  lds
    s_add_u32 m0, s4, 2048
    s_nop 0
    buffer_load_dwordx4 v14, s[16:19], s60 offen  lds
    s_add_u32 s57, s51, 5
    s_and_b32 s57, s57, 7
    s_mul_i32 s60, s57, 176128
    s_add_u32 m0, s4, 12416
    s_nop 0
    buffer_load_dwordx4 v12, s[16:19], s60 offen  lds
    s_add_u32 m0, s4, 13440
    s_nop 0
    buffer_load_dwordx4 v13, s[16:19], s60 offen  lds
    s_add_u32 m0, s4, 14464
    s_nop 0
    buffer_load_dwordx4 v14, s[16:19], s60 offen  lds
    s_barrier
    s_add_u32 s57, s51, 6
    s_and_b32 s57, s57, 7
    s_mul_i32 s60, s57, 176128
    s_add_u32 m0, s4, 24832
    s_nop 0
    buffer_load_dwordx4 v12, s[16:19], s60 offen  lds
    s_add_u32 m0, s4, 25856
    s_nop 0
    buffer_load_dwordx4 v13, s[16:19], s60 offen  lds
    s_add_u32 m0, s4, 26880
    s_nop 0
    buffer_load_dwordx4 v14, s[16:19], s60 offen  lds
    s_waitcnt vmcnt(20)
    v_readfirstlane_b32 s100, v15
    s_nop 0
    s_cmp_eq_u32 s100, 0
    s_cbranch_scc1 L_gated_mix__sliding_block__swiglu_ffn__prompt_kernel_non_1
L_gated_mix__sliding_block__swiglu_ffn__prompt_kernel_non_1b:
    s_add_u32 s57, s51, 7
    s_and_b32 s57, s57, 7
    s_mul_i32 s60, s57, 176128
    s_add_u32 m0, s4, 37248
    s_nop 0
    buffer_load_dwordx4 v12, s[16:19], s60 offen  lds
    s_add_u32 m0, s4, 38272
    s_nop 0
    buffer_load_dwordx4 v13, s[16:19], s60 offen  lds
    s_add_u32 m0, s4, 39296
    s_nop 0
    buffer_load_dwordx4 v14, s[16:19], s60 offen  lds
    s_add_u32 m0, s40, 208
    s_mov_b64 exec, 1
    buffer_load_dword v0, s[8:11], s41 offen lds
    s_mov_b64 exec, -1
    s_add_u32 s57, s51, 0
    s_and_b32 s57, s57, 7
    s_mul_i32 s60, s57, 176128
    s_add_u32 m0, s4, 78080
    s_nop 0
    buffer_load_dwordx4 v12, s[20:23], s60 offen  lds
    s_add_u32 m0, s4, 79104
    s_nop 0
    buffer_load_dwordx4 v13, s[20:23], s60 offen  lds
    s_add_u32 m0, s4, 80128
    s_nop 0
    buffer_load_dwordx4 v14, s[20:23], s60 offen  lds
    s_barrier
    s_add_u32 s57, s51, 1
    s_and_b32 s57, s57, 7
    s_mul_i32 s60, s57, 176128
    s_add_u32 m0, s4, 90624
    s_nop 0
    buffer_load_dwordx4 v12, s[20:23], s60 offen  lds
    s_add_u32 m0, s4, 91648
    s_nop 0
    buffer_load_dwordx4 v13, s[20:23], s60 offen  lds
    s_add_u32 m0, s4, 92672
    s_nop 0
    buffer_load_dwordx4 v14, s[20:23], s60 offen  lds
    s_add_u32 m0, s40, 224
    s_mov_b64 exec, 1
    buffer_load_dword v0, s[8:11], s41 offen lds
    s_mov_b64 exec, -1
    s_add_u32 s57, s51, 2
    s_and_b32 s57, s57, 7
    s_mul_i32 s60, s57, 176128
    s_add_u32 m0, s4, 103168
    s_nop 0
    buffer_load_dwordx4 v12, s[20:23], s60 offen  lds
    s_add_u32 m0, s4, 104192
    s_nop 0
    buffer_load_dwordx4 v13, s[20:23], s60 offen  lds
    s_add_u32 m0, s4, 105216
    s_nop 0
    buffer_load_dwordx4 v14, s[20:23], s60 offen  lds
    s_add_u32 s57, s51, 3
    s_and_b32 s57, s57, 7
    s_mul_i32 s60, s57, 176128
    s_add_u32 m0, s4, 49664
    s_nop 0
    buffer_load_dwordx4 v12, s[20:23], s60 offen  lds
    s_add_u32 m0, s4, 50688
    s_nop 0
    buffer_load_dwordx4 v13, s[20:23], s60 offen  lds
    s_add_u32 m0, s4, 51712
    s_nop 0
    buffer_load_dwordx4 v14, s[20:23], s60 offen  lds
    s_add_u32 m0, s40, 240
    s_mov_b64 exec, 1
    buffer_load_dword v0, s[8:11], s41 offen lds
    s_mov_b64 exec, -1
    s_bfe_u32 s56, s2, 0x20001
    s_xor_b32 s56, s56, 0
    s_lshl_b32 s56, s56, 10
    s_mov_b64 exec, 0xfff
    buffer_load_dword v127, v43, s[24:27], s56 offen
    s_mov_b64 exec, 0xf
    buffer_load_dword v127, v43, s[28:31], s56 offen
    s_mov_b64 exec, -1
    s_barrier
    s_lshl_b32 s55, s50, 6
    s_add_u32 s55, s55, s7
    s_lshl_b32 s55, s55, 7
    s_add_u32 s55, s55, 14680064
    v_mov_b32 v1, s100
    s_mov_b64 exec, 1
    buffer_store_dword v1, off, s[32:35], s55 sc1
    s_mov_b64 exec, -1
    s_add_u32 s57, s51, 4
    s_and_b32 s57, s57, 7
    s_mul_i32 s60, s57, 176128
    s_add_u32 m0, s4, 65536
    s_nop 0
    buffer_load_dwordx4 v12, s[20:23], s60 offen  lds
    s_add_u32 m0, s4, 66560
    s_nop 0
    buffer_load_dwordx4 v13, s[20:23], s60 offen  lds
    s_add_u32 m0, s4, 67584
    s_nop 0
    buffer_load_dwordx4 v14, s[20:23], s60 offen  lds
    s_add_u32 s57, s51, 5
    s_and_b32 s57, s57, 7
    s_mul_i32 s60, s57, 176128
    s_add_u32 m0, s4, 115712
    s_nop 0
    buffer_load_dwordx4 v12, s[20:23], s60 offen  lds
    s_add_u32 m0, s4, 116736
    s_nop 0
    buffer_load_dwordx4 v13, s[20:23], s60 offen  lds
    s_add_u32 m0, s4, 117760
    s_nop 0
    buffer_load_dwordx4 v14, s[20:23], s60 offen  lds
    s_add_u32 s57, s51, 6
    s_and_b32 s57, s57, 7
    s_mul_i32 s60, s57, 176128
    s_add_u32 m0, s4, 128256
    s_nop 0
    buffer_load_dwordx4 v12, s[20:23], s60 offen  lds
    s_add_u32 m0, s4, 129280
    s_nop 0
    buffer_load_dwordx4 v13, s[20:23], s60 offen  lds
    s_add_u32 m0, s4, 130304
    s_nop 0
    buffer_load_dwordx4 v14, s[20:23], s60 offen  lds
    s_add_u32 s57, s51, 7
    s_and_b32 s57, s57, 7
    s_mul_i32 s60, s57, 176128
    s_add_u32 m0, s4, 140800
    s_nop 0
    buffer_load_dwordx4 v12, s[20:23], s60 offen  lds
    s_add_u32 m0, s4, 141824
    s_nop 0
    buffer_load_dwordx4 v13, s[20:23], s60 offen  lds
    s_add_u32 m0, s4, 142848
    s_nop 0
    buffer_load_dwordx4 v14, s[20:23], s60 offen  lds
    s_add_u32 m0, s40, 256
    s_mov_b64 exec, 1
    buffer_load_dword v0, s[8:11], s41 offen lds
    s_mov_b64 exec, -1
    s_lshl_b32 s53, s49, 2
    s_sub_u32 s53, s53, 8
    v_and_b32 v40, 15, v0
    v_min_u32 v40, 11, v40
    v_add_u32 v40, s53, v40
    v_max_i32 v40, 0, v40
    v_bfe_u32 v2, v0, 4, 1
    v_xor_b32 v2, s50, v2
    v_lshl_add_u32 v40, v2, 6, v40
    v_lshlrev_b32 v40, 7, v40
    s_mov_b32 s54, 14680064
    s_mov_b64 exec, 0xfff0fff
    buffer_load_dword v41, v40, s[32:35], s54 offen sc1
    s_mov_b64 exec, -1
    s_barrier
    s_waitcnt vmcnt(0)
    v_cmp_ne_u32 vcc, s100, v41
    s_nop 0
    s_and_b32 vcc_lo, vcc_lo, 0xfff0fff
    s_cbranch_scc1 L_gated_mix__sliding_block__swiglu_ffn__prompt_kernel_poll_2
L_gated_mix__sliding_block__swiglu_ffn__prompt_kernel_poll_2b:
    s_lshl_b32 s55, s50, 17
    s_mul_i32 s56, s52, 3
    s_add_u32 s56, s56, s53
    s_mul_i32 s54, s52, 12288
    s_add_u32 s57, s56, 0
    s_max_i32 s57, s57, 0
    s_lshl_b32 s57, s57, 10
    s_add_u32 s58, s57, s55
    s_add_u32 s57, s57, s58
    s_add_u32 s58, s58, 10485760
    s_add_u32 s57, s57, 12582912
    s_add_u32 m0, s54, 0
    s_nop 0
    buffer_load_dwordx4 v121, s[32:35], s58 offen sc1 lds
    s_add_u32 s58, s58, 65536
    s_add_u32 m0, s54, 1024
    s_nop 0
    buffer_load_dwordx4 v121, s[32:35], s58 offen sc1 lds
    s_add_u32 m0, s54, 2048
    s_nop 0
    buffer_load_dwordx4 v121, s[32:35], s57 offen sc1 lds
    s_add_u32 m0, s54, 2048
    s_nop 0
    buffer_load_dwordx4 v121, s[32:35], s57 offen offset:1024 sc1 lds
    s_add_u32 s57, s56, 1
    s_max_i32 s57, s57, 0
    s_lshl_b32 s57, s57, 10
    s_add_u32 s58, s57, s55
    s_add_u32 s57, s57, s58
    s_add_u32 s58, s58, 10485760
    s_add_u32 s57, s57, 12582912
    s_add_u32 m0, s54, 4096
    s_nop 0
    buffer_load_dwordx4 v121, s[32:35], s58 offen sc1 lds
    s_add_u32 s58, s58, 65536
    s_add_u32 m0, s54, 5120
    s_nop 0
    buffer_load_dwordx4 v121, s[32:35], s58 offen sc1 lds
    s_add_u32 m0, s54, 6144
    s_nop 0
    buffer_load_dwordx4 v121, s[32:35], s57 offen sc1 lds
    s_add_u32 m0, s54, 6144
    s_nop 0
    buffer_load_dwordx4 v121, s[32:35], s57 offen offset:1024 sc1 lds
    s_add_u32 s57, s56, 2
    s_max_i32 s57, s57, 0
    s_lshl_b32 s57, s57, 10
    s_add_u32 s58, s57, s55
    s_add_u32 s57, s57, s58
    s_add_u32 s58, s58, 10485760
    s_add_u32 s57, s57, 12582912
    s_add_u32 m0, s54, 8192
    s_nop 0
    buffer_load_dwordx4 v121, s[32:35], s58 offen sc1 lds
    s_add_u32 s58, s58, 65536
    s_add_u32 m0, s54, 9216
    s_nop 0
    buffer_load_dwordx4 v121, s[32:35], s58 offen sc1 lds
    s_add_u32 m0, s54, 10240
    s_nop 0
    buffer_load_dwordx4 v121, s[32:35], s57 offen sc1 lds
    s_add_u32 m0, s54, 10240
    s_nop 0
    buffer_load_dwordx4 v121, s[32:35], s57 offen offset:1024 sc1 lds
    s_add_u32 m0, s40, 272
    s_mov_b64 exec, 1
    buffer_load_dword v0, s[8:11], s41 offen lds
    s_mov_b64 exec, -1
    s_lshl_b32 s57, s52, 11
    s_add_u32 s57, s57, 154368
    v_add_u32 v4, s57, v121
    ds_read_b128 a[108:111], v4
    ds_read_b128 a[112:115], v4 offset:1024
    s_lshl_b32 s57, s52, 8
    s_add_u32 s57, s57, 162560
    v_lshl_add_u32 v4, v0, 2, s57
    ds_read_b32 v120, v4
    s_waitcnt lgkmcnt(0)
    v_lshrrev_b32 v8, 3, v0
    v_lshlrev_b32 v8, 10, v8
    v_bfe_u32 v9, v0, 4, 1
    v_lshlrev_b32 v9, 2, v9
    v_and_b32 v10, 7, v0
    v_xor_b32 v9, v9, v10
    v_lshl_add_u32 v8, v9, 4, v8
    s_lshl_b32 s56, s97, 7
    v_add_u32 v122, s56, v8
    s_mul_i32 s3, s96, 241664
    s_lshl_b32 s4, s52, 12
    s_lshl_b32 s6, s52, 11
    s_mul_i32 s43, s6, 3
    s_mul_i32 s51, s6, 11
    s_barrier
    s_lshl4_add_u32 s58, s43, 0
    s_add_u32 m0, s4, 81920
    s_nop 0
    buffer_load_dwordx4 v122, s[24:27], s58 offen  lds
    s_lshl4_add_u32 s58, s43, 8192
    s_add_u32 m0, s4, 82944
    s_nop 0
    buffer_load_dwordx4 v122, s[24:27], s58 offen  lds
    s_lshl4_add_u32 s58, s43, 16384
    s_add_u32 m0, s4, 83968
    s_nop 0
    buffer_load_dwordx4 v122, s[24:27], s58 offen  lds
    s_lshl4_add_u32 s58, s43, 24576
    s_add_u32 m0, s4, 84992
    s_nop 0
    buffer_load_dwordx4 v122, s[24:27], s58 offen  lds
    s_add_u32 m0, s40, 288
    s_mov_b64 exec, 1
    buffer_load_dword v0, s[8:11], s41 offen lds
    s_mov_b64 exec, -1
    s_lshl4_add_u32 s58, s43, 360448
    s_add_u32 m0, s4, 98304
    s_nop 0
    buffer_load_dwordx4 v122, s[24:27], s58 offen  lds
    s_lshl4_add_u32 s58, s43, 368640
    s_add_u32 m0, s4, 99328
    s_nop 0
    buffer_load_dwordx4 v122, s[24:27], s58 offen  lds
    s_lshl4_add_u32 s58, s43, 376832
    s_add_u32 m0, s4, 100352
    s_nop 0
    buffer_load_dwordx4 v122, s[24:27], s58 offen  lds
    s_lshl4_add_u32 s58, s43, 385024
    s_add_u32 m0, s4, 101376
    s_nop 0
    buffer_load_dwordx4 v122, s[24:27], s58 offen  lds
    s_add_u32 m0, s40, 304
    s_mov_b64 exec, 1
    buffer_load_dword v0, s[8:11], s41 offen lds
    s_mov_b64 exec, -1
    s_waitcnt lgkmcnt(0)
    s_lshl_b32 s55, s52, 12
    v_add_u32 v1, s55, v121
    s_sub_u32 s53, 8, s7
    s_max_i32 s53, s53, 0
    s_mov_b32 s0, 0xffff
    s_mov_b32 s1, 0xffff

    ds_read_b32 v126, v125 offset:272
    s_waitcnt lgkmcnt(0)
    v_cmp_ne_u32 vcc, 0, v126
    s_nop 0
    s_cbranch_vccz L_gated_mix__sliding_block__swiglu_ffn__prompt_kernel_c_3b
L_gated_mix__sliding_block__swiglu_ffn__prompt_kernel_c_3l:
    ds_read_b32 v126, v125 offset:272
    s_add_u32 s101, s101, 1
    s_cmp_gt_u32 s101, s42
    s_cbranch_scc1 L_gated_mix__sliding_block__swiglu_ffn__prompt_kernel_c_3b
    s_waitcnt lgkmcnt(0)
    v_cmp_ne_u32 vcc, 0, v126
    s_nop 0
    s_cbranch_vccnz L_gated_mix__sliding_block__swiglu_ffn__prompt_kernel_c_3l
L_gated_mix__sliding_block__swiglu_ffn__prompt_kernel_c_3b:
    ds_read_b128 a[32:35], v1 offset:32768
    ds_read_b128 a[0:3], v1 offset:0
    ds_read_b128 a[28:31], v1 offset:28672
    ds_read_b128 a[24:27], v1 offset:24576
    ds_read_b128 a[20:23], v1 offset:20480
    s_setprio 1
    s_barrier
    s_lshl_b32 s61, s7, 4
    s_add_u32 s61, s61, s50
    s_lshl_b32 s61, s61, 8
    s_add_u32 s61, s61, 15073280
    s_waitcnt lgkmcnt(0)
    v_mfma_f32_32x32x16_bf16 v[48:63], a[32:35], a[108:111], 0
    ds_read_b128 a[32:35], v1 offset:33792
    s_cmp_lg_u32 s53, 0
    s_cbranch_scc1 L_at0_neg
    v_mfma_f32_32x32x16_bf16 v[16:31], a[0:3], a[108:111], 0
    ds_read_b128 a[0:3], v1 offset:1024
L_at0_negb:
    v_mfma_f32_32x32x16_bf16 v[32:47], a[28:31], a[108:111], 0
    ds_read_b128 a[28:31], v1 offset:29696
    s_mov_b64 exec, s[0:1]
    ds_read_b128 a[100:103], v1 offset:34816
    ds_read_b128 a[104:107], v1 offset:35840
    ds_read_b128 a[36:39], v1 offset:2048
    ds_read_b128 a[40:43], v1 offset:3072
    s_mov_b64 exec, -1
    ds_read_b128 a[16:19], v1 offset:16384
    ds_read_b128 a[12:15], v1 offset:12288
    ds_read_b128 a[8:11], v1 offset:8192
    ds_read_b128 a[4:7], v1 offset:4096
    s_mov_b64 exec, s[0:1]
    ds_read_b128 a[92:95], v1 offset:30720
    ds_read_b128 a[96:99], v1 offset:31744
    ds_read_b128 a[84:87], v1 offset:26624
    ds_read_b128 a[88:91], v1 offset:27648
    s_mov_b64 exec, -1
    s_mov_b64 exec, s[0:1]
    ds_read_b128 a[76:79], v1 offset:22528
    ds_read_b128 a[80:83], v1 offset:23552
    ds_read_b128 a[68:71], v1 offset:18432
    ds_read_b128 a[72:75], v1 offset:19456
    s_mov_b64 exec, -1
    s_mov_b64 exec, s[0:1]
    ds_read_b128 a[60:63], v1 offset:14336
    ds_read_b128 a[64:67], v1 offset:15360
    ds_read_b128 a[52:55], v1 offset:10240
    ds_read_b128 a[56:59], v1 offset:11264
    ds_read_b128 a[44:47], v1 offset:6144
    ds_read_b128 a[48:51], v1 offset:7168
    s_mov_b64 exec, -1
    v_bfi_b32 v48, v96, v48, v16
    v_bfi_b32 v49, v97, v49, v17
    v_bfi_b32 v50, v98, v50, v18
    v_bfi_b32 v51, v99, v51, v19
    v_bfi_b32 v52, v100, v52, v20
    v_bfi_b32 v53, v101, v53, v21
    v_bfi_b32 v54, v102, v54, v22
    v_bfi_b32 v55, v103, v55, v23
    v_bfi_b32 v56, v104, v56, v24
    v_bfi_b32 v57, v105, v57, v25
    v_bfi_b32 v58, v106, v58, v26
    v_bfi_b32 v59, v107, v59, v27
    v_bfi_b32 v60, v108, v60, v28
    v_bfi_b32 v61, v109, v61, v29
    v_bfi_b32 v62, v110, v62, v30
    v_bfi_b32 v63, v111, v63, v31
    v_mfma_f32_32x32x16_bf16 v[16:31], a[24:27], a[108:111], 0
    ds_read_b128 a[24:27], v1 offset:25600
    v_exp_f32 v48, v48
    v_exp_f32 v49, v49
    v_exp_f32 v50, v50
    v_exp_f32 v51, v51
    v_cvt_pk_bf16_f32 v64, v48, v49
    v_exp_f32 v52, v52
    v_exp_f32 v53, v53
    v_cvt_pk_bf16_f32 v65, v50, v51
    v_exp_f32 v54, v54
    v_exp_f32 v55, v55
    v_cvt_pk_bf16_f32 v66, v52, v53
    v_exp_f32 v56, v56
    v_exp_f32 v57, v57
    v_cvt_pk_bf16_f32 v67, v54, v55
    v_exp_f32 v58, v58
    v_exp_f32 v59, v59
    v_cvt_pk_bf16_f32 v68, v56, v57
    v_exp_f32 v60, v60
    v_exp_f32 v61, v61
    v_cvt_pk_bf16_f32 v69, v58, v59
    v_exp_f32 v62, v62
    v_exp_f32 v63, v63
    v_cvt_pk_bf16_f32 v70, v60, v61
    v_cvt_pk_bf16_f32 v71, v62, v63
    v_and_b32 v8, v64, v112
    v_and_b32 v9, v65, v113
    v_and_b32 v10, v66, v114
    v_and_b32 v11, v67, v115
    v_and_b32 v12, v68, v116
    v_and_b32 v13, v69, v117
    v_and_b32 v14, v70, v118
    v_and_b32 v15, v71, v119
    v_xor_b32 v64, v64, v8
    v_xor_b32 v65, v65, v9
    v_xor_b32 v66, v66, v10
    v_xor_b32 v67, v67, v11
    v_xor_b32 v68, v68, v12
    v_xor_b32 v69, v69, v13
    v_xor_b32 v70, v70, v14
    v_xor_b32 v71, v71, v15
    s_waitcnt lgkmcnt(1)
    s_cmp_gt_u32 s53, 7
    s_cbranch_scc1 L_at0_x7
    v_mfma_f32_32x32x16_bf16 v[48:63], a[20:23], a[108:111], 0
    ds_read_b128 a[20:23], v1 offset:21504
    v_exp_f32 v32, v32
    v_exp_f32 v33, v33
    v_exp_f32 v34, v34
    v_exp_f32 v35, v35
    v_mfma_f32_32x32x16_bf16 v[80:95], a[100:103], v[8:11], 0
    s_mov_b64 exec, s[0:1]
    ds_read_b128 a[100:103], v1 offset:35072
    s_mov_b64 exec, -1
    v_cvt_pk_bf16_f32 v72, v32, v33
    v_exp_f32 v36, v36
    v_exp_f32 v37, v37
    v_cvt_pk_bf16_f32 v73, v34, v35
    v_mfma_f32_32x32x16_bf16 v[80:95], a[104:107], v[12:15], v[80:95]
    s_mov_b64 exec, s[0:1]
    ds_read_b128 a[104:107], v1 offset:36096
    s_mov_b64 exec, -1
    v_exp_f32 v38, v38
    v_exp_f32 v39, v39
    v_cvt_pk_bf16_f32 v74, v36, v37
    v_exp_f32 v40, v40
    v_mfma_f32_32x32x16_bf16 v[80:95], a[36:39], v[64:67], v[80:95]
    s_mov_b64 exec, s[0:1]
    ds_read_b128 a[36:39], v1 offset:2304
    s_mov_b64 exec, -1
    v_exp_f32 v41, v41
    v_cvt_pk_bf16_f32 v75, v38, v39
    v_exp_f32 v42, v42
    v_exp_f32 v43, v43
    v_mfma_f32_32x32x16_bf16 v[80:95], a[40:43], v[68:71], v[80:95]
    s_mov_b64 exec, s[0:1]
    ds_read_b128 a[40:43], v1 offset:3328
    s_mov_b64 exec, -1
    v_cvt_pk_bf16_f32 v76, v40, v41
    v_exp_f32 v44, v44
    v_exp_f32 v45, v45
    v_cvt_pk_bf16_f32 v77, v42, v43
    v_exp_f32 v46, v46
    v_exp_f32 v47, v47
    v_cvt_pk_bf16_f32 v78, v44, v45
    v_cvt_pk_bf16_f32 v79, v46, v47
    s_cmp_gt_u32 s53, 6
    s_cbranch_scc1 L_at0_x6
    v_mfma_f32_32x32x16_bf16 v[32:47], a[16:19], a[108:111], 0
    ds_read_b128 a[16:19], v1 offset:17408
    v_exp_f32 v16, v16
    v_exp_f32 v17, v17
    v_exp_f32 v18, v18
    v_exp_f32 v19, v19
    v_cvt_pk_bf16_f32 v64, v16, v17
    v_exp_f32 v20, v20
    v_exp_f32 v21, v21
    v_mfma_f32_32x32x16_bf16 v[80:95], a[92:95], v[72:75], v[80:95]
    s_mov_b64 exec, s[0:1]
    ds_read_b128 a[92:95], v1 offset:30976
    s_mov_b64 exec, -1
    v_cvt_pk_bf16_f32 v65, v18, v19
    v_exp_f32 v22, v22
    v_exp_f32 v23, v23
    v_cvt_pk_bf16_f32 v66, v20, v21
    v_exp_f32 v24, v24
    v_exp_f32 v25, v25
    v_cvt_pk_bf16_f32 v67, v22, v23
    v_mfma_f32_32x32x16_bf16 v[80:95], a[96:99], v[76:79], v[80:95]
    s_mov_b64 exec, s[0:1]
    ds_read_b128 a[96:99], v1 offset:32000
    s_mov_b64 exec, -1
    v_exp_f32 v26, v26
    v_exp_f32 v27, v27
    v_cvt_pk_bf16_f32 v68, v24, v25
    v_exp_f32 v28, v28
    v_exp_f32 v29, v29
    v_cvt_pk_bf16_f32 v69, v26, v27
    v_exp_f32 v30, v30
    v_exp_f32 v31, v31
    v_cvt_pk_bf16_f32 v70, v28, v29
    v_cvt_pk_bf16_f32 v71, v30, v31
    s_cmp_gt_u32 s53, 5
    s_cbranch_scc1 L_at0_x5
    v_mfma_f32_32x32x16_bf16 v[16:31], a[12:15], a[108:111], 0
    ds_read_b128 a[12:15], v1 offset:13312
    v_exp_f32 v48, v48
    v_exp_f32 v49, v49
    v_exp_f32 v50, v50
    v_exp_f32 v51, v51
    v_cvt_pk_bf16_f32 v72, v48, v49
    v_exp_f32 v52, v52
    v_exp_f32 v53, v53
    v_mfma_f32_32x32x16_bf16 v[80:95], a[84:87], v[64:67], v[80:95]
    s_mov_b64 exec, s[0:1]
    ds_read_b128 a[84:87], v1 offset:26880
    s_mov_b64 exec, -1
    v_cvt_pk_bf16_f32 v73, v50, v51
    v_exp_f32 v54, v54
    v_exp_f32 v55, v55
    v_cvt_pk_bf16_f32 v74, v52, v53
    v_exp_f32 v56, v56
    v_exp_f32 v57, v57
    v_cvt_pk_bf16_f32 v75, v54, v55
    v_mfma_f32_32x32x16_bf16 v[80:95], a[88:91], v[68:71], v[80:95]
    s_mov_b64 exec, s[0:1]
    ds_read_b128 a[88:91], v1 offset:27904
    s_mov_b64 exec, -1
    v_exp_f32 v58, v58
    v_exp_f32 v59, v59
    v_cvt_pk_bf16_f32 v76, v56, v57
    v_exp_f32 v60, v60
    v_exp_f32 v61, v61
    v_cvt_pk_bf16_f32 v77, v58, v59
    v_exp_f32 v62, v62
    v_exp_f32 v63, v63
    v_cvt_pk_bf16_f32 v78, v60, v61
    v_cvt_pk_bf16_f32 v79, v62, v63
    s_cmp_gt_u32 s53, 4
    s_cbranch_scc1 L_at0_x4
    v_mfma_f32_32x32x16_bf16 v[48:63], a[8:11], a[108:111], 0
    ds_read_b128 a[8:11], v1 offset:9216
    v_exp_f32 v32, v32
    v_exp_f32 v33, v33
    v_exp_f32 v34, v34
    v_exp_f32 v35, v35
    v_cvt_pk_bf16_f32 v64, v32, v33
    v_exp_f32 v36, v36
    v_exp_f32 v37, v37
    v_mfma_f32_32x32x16_bf16 v[80:95], a[76:79], v[72:75], v[80:95]
    s_mov_b64 exec, s[0:1]
    ds_read_b128 a[76:79], v1 offset:22784
    s_mov_b64 exec, -1
    v_cvt_pk_bf16_f32 v65, v34, v35
    v_exp_f32 v38, v38
    v_exp_f32 v39, v39
    v_cvt_pk_bf16_f32 v66, v36, v37
    v_exp_f32 v40, v40
    v_exp_f32 v41, v41
    v_cvt_pk_bf16_f32 v67, v38, v39
    v_mfma_f32_32x32x16_bf16 v[80:95], a[80:83], v[76:79], v[80:95]
    s_mov_b64 exec, s[0:1]
    ds_read_b128 a[80:83], v1 offset:23808
    s_mov_b64 exec, -1
    v_exp_f32 v42, v42
    v_exp_f32 v43, v43
    v_cvt_pk_bf16_f32 v68, v40, v41
    v_exp_f32 v44, v44
    v_exp_f32 v45, v45
    v_cvt_pk_bf16_f32 v69, v42, v43
    v_exp_f32 v46, v46
    v_exp_f32 v47, v47
    v_cvt_pk_bf16_f32 v70, v44, v45
    v_cvt_pk_bf16_f32 v71, v46, v47
    s_cmp_gt_u32 s53, 3
    s_cbranch_scc1 L_at0_x3
    v_mfma_f32_32x32x16_bf16 v[32:47], a[4:7], a[108:111], 0
    ds_read_b128 a[4:7], v1 offset:5120
    v_exp_f32 v16, v16
    v_exp_f32 v17, v17
    v_exp_f32 v18, v18
    v_exp_f32 v19, v19
    v_cvt_pk_bf16_f32 v72, v16, v17
    v_exp_f32 v20, v20
    v_exp_f32 v21, v21
    v_mfma_f32_32x32x16_bf16 v[80:95], a[68:71], v[64:67], v[80:95]
    s_mov_b64 exec, s[0:1]
    ds_read_b128 a[68:71], v1 offset:18688
    s_mov_b64 exec, -1
    v_cvt_pk_bf16_f32 v73, v18, v19
    v_exp_f32 v22, v22
    v_exp_f32 v23, v23
    v_cvt_pk_bf16_f32 v74, v20, v21
    v_exp_f32 v24, v24
    v_exp_f32 v25, v25
    v_cvt_pk_bf16_f32 v75, v22, v23
    v_mfma_f32_32x32x16_bf16 v[80:95], a[72:75], v[68:71], v[80:95]
    s_mov_b64 exec, s[0:1]
    ds_read_b128 a[72:75], v1 offset:19712
    s_mov_b64 exec, -1
    v_exp_f32 v26, v26
    v_exp_f32 v27, v27
    v_cvt_pk_bf16_f32 v76, v24, v25
    v_exp_f32 v28, v28
    v_exp_f32 v29, v29
    v_cvt_pk_bf16_f32 v77, v26, v27
    v_exp_f32 v30, v30
    v_exp_f32 v31, v31
    v_cvt_pk_bf16_f32 v78, v28, v29
    v_cvt_pk_bf16_f32 v79, v30, v31
    s_cmp_gt_u32 s53, 2
    s_cbranch_scc1 L_at0_x2
    v_mfma_f32_32x32x16_bf16 v[16:31], a[0:3], a[112:115], 0
    v_exp_f32 v48, v48
    v_exp_f32 v49, v49
    v_exp_f32 v50, v50
    v_exp_f32 v51, v51
    v_cvt_pk_bf16_f32 v64, v48, v49
    v_exp_f32 v52, v52
    v_exp_f32 v53, v53
    v_mfma_f32_32x32x16_bf16 v[80:95], a[60:63], v[72:75], v[80:95]
    s_mov_b64 exec, s[0:1]
    ds_read_b128 a[60:63], v1 offset:14592
    s_mov_b64 exec, -1
    v_cvt_pk_bf16_f32 v65, v50, v51
    v_exp_f32 v54, v54
    v_exp_f32 v55, v55
    v_cvt_pk_bf16_f32 v66, v52, v53
    v_exp_f32 v56, v56
    v_exp_f32 v57, v57
    v_cvt_pk_bf16_f32 v67, v54, v55
    v_mfma_f32_32x32x16_bf16 v[80:95], a[64:67], v[76:79], v[80:95]
    s_mov_b64 exec, s[0:1]
    ds_read_b128 a[64:67], v1 offset:15616
    s_mov_b64 exec, -1
    v_exp_f32 v58, v58
    v_exp_f32 v59, v59
    v_cvt_pk_bf16_f32 v68, v56, v57
    v_exp_f32 v60, v60
    v_exp_f32 v61, v61
    v_cvt_pk_bf16_f32 v69, v58, v59
    v_exp_f32 v62, v62
    v_exp_f32 v63, v63
    v_cvt_pk_bf16_f32 v70, v60, v61
    v_cvt_pk_bf16_f32 v71, v62, v63
    s_cmp_gt_u32 s53, 1
    s_cbranch_scc1 L_at0_x1
    v_mfma_f32_32x32x16_bf16 v[48:63], a[32:35], a[112:115], 0
    v_exp_f32 v32, v32
    v_exp_f32 v33, v33
    v_exp_f32 v34, v34
    v_exp_f32 v35, v35
    v_cvt_pk_bf16_f32 v72, v32, v33
    v_exp_f32 v36, v36
    v_exp_f32 v37, v37
    v_mfma_f32_32x32x16_bf16 v[80:95], a[52:55], v[64:67], v[80:95]
    s_mov_b64 exec, s[0:1]
    ds_read_b128 a[52:55], v1 offset:10496
    s_mov_b64 exec, -1
    v_cvt_pk_bf16_f32 v73, v34, v35
    v_exp_f32 v38, v38
    v_exp_f32 v39, v39
    v_cvt_pk_bf16_f32 v74, v36, v37
    v_exp_f32 v40, v40
    v_exp_f32 v41, v41
    v_cvt_pk_bf16_f32 v75, v38, v39
    v_mfma_f32_32x32x16_bf16 v[80:95], a[56:59], v[68:71], v[80:95]
    s_mov_b64 exec, s[0:1]
    ds_read_b128 a[56:59], v1 offset:11520
    s_mov_b64 exec, -1
    v_exp_f32 v42, v42
    v_exp_f32 v43, v43
    v_cvt_pk_bf16_f32 v76, v40, v41
    v_exp_f32 v44, v44
    v_exp_f32 v45, v45
    v_cvt_pk_bf16_f32 v77, v42, v43
    v_exp_f32 v46, v46
    v_exp_f32 v47, v47
    v_cvt_pk_bf16_f32 v78, v44, v45
    v_cvt_pk_bf16_f32 v79, v46, v47
    v_mfma_f32_32x32x16_bf16 v[80:95], a[44:47], v[72:75], v[80:95]
    s_mov_b64 exec, s[0:1]
    ds_read_b128 a[44:47], v1 offset:6400
    s_mov_b64 exec, -1
    v_mfma_f32_32x32x16_bf16 v[80:95], a[48:51], v[76:79], v[80:95]
    s_mov_b64 exec, s[0:1]
    ds_read_b128 a[48:51], v1 offset:7424
    s_mov_b64 exec, -1
    v_mfma_f32_32x32x16_bf16 v[32:47], a[28:31], a[112:115], 0
    s_cmp_lg_u32 s53, 0
    s_cbranch_scc1 L_at0_ng1
L_at0_ng1b:
    v_bfi_b32 v48, v96, v48, v16
    v_bfi_b32 v49, v97, v49, v17
    v_bfi_b32 v50, v98, v50, v18
    v_bfi_b32 v51, v99, v51, v19
    v_bfi_b32 v52, v100, v52, v20
    v_bfi_b32 v53, v101, v53, v21
    v_bfi_b32 v54, v102, v54, v22
    v_bfi_b32 v55, v103, v55, v23
    v_bfi_b32 v56, v104, v56, v24
    v_bfi_b32 v57, v105, v57, v25
    v_bfi_b32 v58, v106, v58, v26
    v_bfi_b32 v59, v107, v59, v27
    v_bfi_b32 v60, v108, v60, v28
    v_bfi_b32 v61, v109, v61, v29
    v_bfi_b32 v62, v110, v62, v30
    v_bfi_b32 v63, v111, v63, v31
L_at0_fin:
    v_mov_b32 v9, 0x53800000
    v_cmp_nle_f32 vcc, 0x2b800000, v88
    v_cmp_nle_f32 s[56:57], v88, v9
    v_rcp_f32 v8, v88
    s_or_b64 vcc, vcc, s[56:57]
    s_cbranch_scc1 L_at0_slow
L_at0_back:
    s_mul_i32 s55, s7, 118
    s_lshl1_add_u32 s54, s50, s55
    v_mul_f32 v8, v8, v120
    s_add_u32 s55, s54, 86
    s_lshl_b32 s55, s55, 10
    v_mul_f32 v80, v80, v8
    v_mul_f32 v81, v81, v8
    v_mul_f32 v82, v82, v8
    v_mul_f32 v83, v83, v8
    v_mul_f32 v84, v84, v8
    v_mul_f32 v85, v85, v8
    v_mul_f32 v86, v86, v8
    v_mul_f32 v87, v87, v8
    v_cvt_pk_bf16_f32 v4, v80, v81
    v_cvt_pk_bf16_f32 v5, v82, v83
    v_cvt_pk_bf16_f32 v124, v84, v85
    v_cvt_pk_bf16_f32 v125, v86, v87
    s_nop 0
    v_permlane32_swap_b32 v4, v124
    v_permlane32_swap_b32 v5, v125
    s_nop 0
    v_permlane16_swap_b32 v4, v124
    v_permlane16_swap_b32 v5, v125
    s_waitcnt lgkmcnt(0)
    v_mfma_f32_32x32x16_bf16 v[16:31], a[24:27], a[112:115], 0
    v_exp_f32 v48, v48
    v_exp_f32 v49, v49
    v_exp_f32 v50, v50
    v_exp_f32 v51, v51
    v_cvt_pk_bf16_f32 v64, v48, v49
    v_exp_f32 v52, v52
    v_exp_f32 v53, v53
    v_cvt_pk_bf16_f32 v65, v50, v51
    v_exp_f32 v54, v54
    v_exp_f32 v55, v55
    v_cvt_pk_bf16_f32 v66, v52, v53
    v_exp_f32 v56, v56
    v_exp_f32 v57, v57
    v_cvt_pk_bf16_f32 v67, v54, v55
    v_exp_f32 v58, v58
    v_exp_f32 v59, v59
    v_cvt_pk_bf16_f32 v68, v56, v57
    v_exp_f32 v60, v60
    v_exp_f32 v61, v61
    v_cvt_pk_bf16_f32 v69, v58, v59
    v_exp_f32 v62, v62
    v_exp_f32 v63, v63
    v_cvt_pk_bf16_f32 v70, v60, v61
    v_cvt_pk_bf16_f32 v71, v62, v63
    v_and_b32 v8, v64, v112
    v_and_b32 v9, v65, v113
    v_and_b32 v10, v66, v114
    v_and_b32 v11, v67, v115
    v_and_b32 v12, v68, v116
    v_and_b32 v13, v69, v117
    v_and_b32 v14, v70, v118
    v_and_b32 v15, v71, v119
    v_xor_b32 v64, v64, v8
    v_xor_b32 v65, v65, v9
    v_xor_b32 v66, v66, v10
    v_xor_b32 v67, v67, v11
    v_xor_b32 v68, v68, v12
    v_xor_b32 v69, v69, v13
    v_xor_b32 v70, v70, v14
    v_xor_b32 v71, v71, v15
    s_cmp_gt_u32 s53, 7
    s_cbranch_scc1 L_at1_x7
    v_mfma_f32_32x32x16_bf16 v[48:63], a[20:23], a[112:115], 0
    v_exp_f32 v32, v32
    v_exp_f32 v33, v33
    v_exp_f32 v34, v34
    v_exp_f32 v35, v35
    v_mfma_f32_32x32x16_bf16 v[80:95], a[100:103], v[8:11], 0
    v_cvt_pk_bf16_f32 v72, v32, v33
    v_exp_f32 v36, v36
    v_exp_f32 v37, v37
    v_cvt_pk_bf16_f32 v73, v34, v35
    v_mfma_f32_32x32x16_bf16 v[80:95], a[104:107], v[12:15], v[80:95]
    v_exp_f32 v38, v38
    v_exp_f32 v39, v39
    v_cvt_pk_bf16_f32 v74, v36, v37
    v_exp_f32 v40, v40
    v_mfma_f32_32x32x16_bf16 v[80:95], a[36:39], v[64:67], v[80:95]
    v_exp_f32 v41, v41
    v_cvt_pk_bf16_f32 v75, v38, v39
    v_exp_f32 v42, v42
    v_exp_f32 v43, v43
    v_mfma_f32_32x32x16_bf16 v[80:95], a[40:43], v[68:71], v[80:95]
    v_cvt_pk_bf16_f32 v76, v40, v41
    v_exp_f32 v44, v44
    v_exp_f32 v45, v45
    v_cvt_pk_bf16_f32 v77, v42, v43
    v_exp_f32 v46, v46
    v_exp_f32 v47, v47
    v_cvt_pk_bf16_f32 v78, v44, v45
    v_cvt_pk_bf16_f32 v79, v46, v47
    s_cmp_gt_u32 s53, 6
    s_cbranch_scc1 L_at1_x6
    v_mfma_f32_32x32x16_bf16 v[32:47], a[16:19], a[112:115], 0
    v_exp_f32 v16, v16
    v_exp_f32 v17, v17
    v_exp_f32 v18, v18
    v_exp_f32 v19, v19
    v_cvt_pk_bf16_f32 v64, v16, v17
    v_exp_f32 v20, v20
    v_exp_f32 v21, v21
    v_mfma_f32_32x32x16_bf16 v[80:95], a[92:95], v[72:75], v[80:95]
    v_cvt_pk_bf16_f32 v65, v18, v19
    v_exp_f32 v22, v22
    v_exp_f32 v23, v23
    v_cvt_pk_bf16_f32 v66, v20, v21
    v_exp_f32 v24, v24
    v_exp_f32 v25, v25
    v_cvt_pk_bf16_f32 v67, v22, v23
    v_mfma_f32_32x32x16_bf16 v[80:95], a[96:99], v[76:79], v[80:95]
    v_exp_f32 v26, v26
    v_exp_f32 v27, v27
    v_cvt_pk_bf16_f32 v68, v24, v25
    v_exp_f32 v28, v28
    v_exp_f32 v29, v29
    v_cvt_pk_bf16_f32 v69, v26, v27
    v_exp_f32 v30, v30
    v_exp_f32 v31, v31
    v_cvt_pk_bf16_f32 v70, v28, v29
    v_cvt_pk_bf16_f32 v71, v30, v31
    s_cmp_gt_u32 s53, 5
    s_cbranch_scc1 L_at1_x5
    v_mfma_f32_32x32x16_bf16 v[16:31], a[12:15], a[112:115], 0
    v_exp_f32 v48, v48
    v_exp_f32 v49, v49
    v_exp_f32 v50, v50
    v_exp_f32 v51, v51
    v_cvt_pk_bf16_f32 v72, v48, v49
    v_exp_f32 v52, v52
    v_exp_f32 v53, v53
    v_mfma_f32_32x32x16_bf16 v[80:95], a[84:87], v[64:67], v[80:95]
    v_cvt_pk_bf16_f32 v73, v50, v51
    v_exp_f32 v54, v54
    v_exp_f32 v55, v55
    v_cvt_pk_bf16_f32 v74, v52, v53
    v_exp_f32 v56, v56
    v_exp_f32 v57, v57
    v_cvt_pk_bf16_f32 v75, v54, v55
    v_mfma_f32_32x32x16_bf16 v[80:95], a[88:91], v[68:71], v[80:95]
    v_exp_f32 v58, v58
    v_exp_f32 v59, v59
    v_cvt_pk_bf16_f32 v76, v56, v57
    v_exp_f32 v60, v60
    v_exp_f32 v61, v61
    v_cvt_pk_bf16_f32 v77, v58, v59
    v_exp_f32 v62, v62
    v_exp_f32 v63, v63
    v_cvt_pk_bf16_f32 v78, v60, v61
    v_cvt_pk_bf16_f32 v79, v62, v63
    s_cmp_gt_u32 s53, 4
    s_cbranch_scc1 L_at1_x4
    v_mfma_f32_32x32x16_bf16 v[48:63], a[8:11], a[112:115], 0
    v_exp_f32 v32, v32
    v_exp_f32 v33, v33
    v_exp_f32 v34, v34
    v_exp_f32 v35, v35
    v_cvt_pk_bf16_f32 v64, v32, v33
    v_exp_f32 v36, v36
    v_exp_f32 v37, v37
    v_mfma_f32_32x32x16_bf16 v[80:95], a[76:79], v[72:75], v[80:95]
    v_cvt_pk_bf16_f32 v65, v34, v35
    v_exp_f32 v38, v38
    v_exp_f32 v39, v39
    v_cvt_pk_bf16_f32 v66, v36, v37
    v_exp_f32 v40, v40
    v_exp_f32 v41, v41
    v_cvt_pk_bf16_f32 v67, v38, v39
    v_mfma_f32_32x32x16_bf16 v[80:95], a[80:83], v[76:79], v[80:95]
    v_exp_f32 v42, v42
    v_exp_f32 v43, v43
    v_cvt_pk_bf16_f32 v68, v40, v41
    v_exp_f32 v44, v44
    v_exp_f32 v45, v45
    v_cvt_pk_bf16_f32 v69, v42, v43
    v_exp_f32 v46, v46
    v_exp_f32 v47, v47
    v_cvt_pk_bf16_f32 v70, v44, v45
    v_cvt_pk_bf16_f32 v71, v46, v47
    s_cmp_gt_u32 s53, 3
    s_cbranch_scc1 L_at1_x3
    v_mfma_f32_32x32x16_bf16 v[32:47], a[4:7], a[112:115], 0
    v_exp_f32 v16, v16
    v_exp_f32 v17, v17
    v_exp_f32 v18, v18
    v_exp_f32 v19, v19
    v_cvt_pk_bf16_f32 v72, v16, v17
    v_exp_f32 v20, v20
    v_exp_f32 v21, v21
    v_mfma_f32_32x32x16_bf16 v[80:95], a[68:71], v[64:67], v[80:95]
    v_cvt_pk_bf16_f32 v73, v18, v19
    v_exp_f32 v22, v22
    v_exp_f32 v23, v23
    v_cvt_pk_bf16_f32 v74, v20, v21
    v_exp_f32 v24, v24
    v_exp_f32 v25, v25
    v_cvt_pk_bf16_f32 v75, v22, v23
    v_mfma_f32_32x32x16_bf16 v[80:95], a[72:75], v[68:71], v[80:95]
    v_exp_f32 v26, v26
    v_exp_f32 v27, v27
    v_cvt_pk_bf16_f32 v76, v24, v25
    v_exp_f32 v28, v28
    v_exp_f32 v29, v29
    v_cvt_pk_bf16_f32 v77, v26, v27
    v_exp_f32 v30, v30
    v_exp_f32 v31, v31
    v_cvt_pk_bf16_f32 v78, v28, v29
    v_cvt_pk_bf16_f32 v79, v30, v31
    s_cmp_gt_u32 s53, 2
    s_cbranch_scc1 L_at1_x2
    v_mfma_f32_32x32x16_bf16 v[80:95], a[60:63], v[72:75], v[80:95]
    v_exp_f32 v48, v48
    v_exp_f32 v49, v49
    v_exp_f32 v50, v50
    v_exp_f32 v51, v51
    v_cvt_pk_bf16_f32 v64, v48, v49
    v_exp_f32 v52, v52
    v_exp_f32 v53, v53
    v_cvt_pk_bf16_f32 v65, v50, v51
    v_exp_f32 v54, v54
    v_exp_f32 v55, v55
    v_cvt_pk_bf16_f32 v66, v52, v53
    v_mfma_f32_32x32x16_bf16 v[80:95], a[64:67], v[76:79], v[80:95]
    v_exp_f32 v56, v56
    v_exp_f32 v57, v57
    v_cvt_pk_bf16_f32 v67, v54, v55
    v_exp_f32 v58, v58
    v_exp_f32 v59, v59
    v_cvt_pk_bf16_f32 v68, v56, v57
    v_exp_f32 v60, v60
    v_exp_f32 v61, v61
    v_cvt_pk_bf16_f32 v69, v58, v59
    v_exp_f32 v62, v62
    v_exp_f32 v63, v63
    v_cvt_pk_bf16_f32 v70, v60, v61
    v_cvt_pk_bf16_f32 v71, v62, v63
    s_cmp_gt_u32 s53, 1
    s_cbranch_scc1 L_at1_x1
    v_mfma_f32_32x32x16_bf16 v[80:95], a[52:55], v[64:67], v[80:95]
    v_exp_f32 v32, v32
    v_exp_f32 v33, v33
    v_exp_f32 v34, v34
    v_exp_f32 v35, v35
    v_cvt_pk_bf16_f32 v72, v32, v33
    v_exp_f32 v36, v36
    v_exp_f32 v37, v37
    v_cvt_pk_bf16_f32 v73, v34, v35
    v_exp_f32 v38, v38
    v_exp_f32 v39, v39
    v_cvt_pk_bf16_f32 v74, v36, v37
    v_mfma_f32_32x32x16_bf16 v[80:95], a[56:59], v[68:71], v[80:95]
    v_exp_f32 v40, v40
    v_exp_f32 v41, v41
    v_cvt_pk_bf16_f32 v75, v38, v39
    v_exp_f32 v42, v42
    v_exp_f32 v43, v43
    v_cvt_pk_bf16_f32 v76, v40, v41
    v_exp_f32 v44, v44
    v_exp_f32 v45, v45
    v_cvt_pk_bf16_f32 v77, v42, v43
    v_exp_f32 v46, v46
    v_exp_f32 v47, v47
    v_cvt_pk_bf16_f32 v78, v44, v45
    v_cvt_pk_bf16_f32 v79, v46, v47
    v_mfma_f32_32x32x16_bf16 v[80:95], a[44:47], v[72:75], v[80:95]
    s_nop 0
    v_mfma_f32_32x32x16_bf16 v[80:95], a[48:51], v[76:79], v[80:95]
    s_nop 7
    s_nop 3
L_at1_fin:
    v_mov_b32 v9, 0x53800000
    v_cmp_nle_f32 vcc, 0x2b800000, v88
    v_cmp_nle_f32 s[56:57], v88, v9
    v_rcp_f32 v8, v88
    s_or_b64 vcc, vcc, s[56:57]
    s_cbranch_scc1 L_at1_slow
L_at1_back:
    s_mul_i32 s55, s7, 118
    s_lshl1_add_u32 s54, s50, s55
    v_mul_f32 v8, v8, v120
    s_add_u32 s55, s54, 86
    s_lshl_b32 s55, s55, 10
    s_setprio 3
    v_mul_f32 v80, v80, v8
    v_mul_f32 v81, v81, v8
    v_mul_f32 v82, v82, v8
    v_mul_f32 v83, v83, v8
    v_mul_f32 v84, v84, v8
    v_mul_f32 v85, v85, v8
    v_mul_f32 v86, v86, v8
    v_mul_f32 v87, v87, v8
    v_cvt_pk_bf16_f32 v6, v80, v81
    v_cvt_pk_bf16_f32 v7, v82, v83
    v_cvt_pk_bf16_f32 v126, v84, v85
    v_cvt_pk_bf16_f32 v127, v86, v87
    s_nop 0
    v_permlane32_swap_b32 v6, v126
    v_permlane32_swap_b32 v7, v127
    s_nop 0
    v_permlane16_swap_b32 v6, v126
    v_permlane16_swap_b32 v7, v127
    buffer_store_dwordx4 v[4:7], v121, s[32:35], s55 offen sc1
    buffer_store_dwordx4 v[124:127], v121, s[32:35], s55 offen offset:1024 sc1
    s_add_u32 s61, s61, 128
    s_waitcnt vmcnt(0)
    v_mov_b32 v2, s100
    s_mov_b64 exec, 1
    buffer_store_dword v2, off, s[32:35], s61 sc1
    s_mov_b64 exec, -1
    s_branch L_join
L_g1_A:
    v_and_b32 v10, 15, v0
    v_lshl_add_u32 v10, v10, 7, s3
    v_bfe_u32 v11, v0, 1, 3
    v_lshrrev_b32 v12, 4, v0
    v_xor_b32 v11, v11, v12
    v_bfe_u32 v13, v11, 1, 1
    v_and_b32 v14, 1, v11
    v_and_or_b32 v11, v11, 4, v13
    v_lshl_or_b32 v11, v14, 1, v11
    v_lshl_add_u32 v44, v11, 4, v10
    v_xor_b32 v45, 64, v44
    v_bfe_u32 v40, v0, 4, 1
    v_lshrrev_b32 v13, 5, v0
    v_lshl_add_u32 v14, v40, 1, v13
    v_lshlrev_b32 v14, 4, v14
    v_add_u32 v46, 154368, v14
    v_bfe_u32 v14, v0, 2, 2
    v_lshl_add_u32 v41, v13, 3, v14
    v_and_b32 v42, 3, v0
    v_lshlrev_b32 v106, 2, v42
    v_add_u32 v106, 153344, v106
    v_lshlrev_b32 v42, 3, v42
    v_mul_u32_u24 v10, 1056, v40
    v_lshl_add_u32 v11, v41, 6, v42
    v_add_u32 v10, 73856, v10
    v_add_u32 v3, v10, v11
    v_mul_u32_u24 v10, 2080, v40
    v_lshl_add_u32 v11, v41, 7, v42
    v_add_u32 v10, 65536, v10
    v_bfe_u32 v12, v0, 3, 1
    v_lshl_add_u32 v11, v12, 6, v11
    v_add_u32 v1, v10, v11
    v_xor_b32 v2, 64, v1
    s_mov_b32 s101, 0
    s_mov_b32 s42, 400000
    s_setprio 2
    s_bitcmp1_b32 s50, 0
    s_cbranch_scc1 L_q_odd
    s_waitcnt lgkmcnt(0)
    s_waitcnt vmcnt(7)
    ds_read_b32 v107, v106 offset:0
    s_waitcnt lgkmcnt(0)
    v_cmp_ne_u32 vcc, 0, v107
    s_nop 0
    s_cbranch_vccz L_gated_mix__sliding_block__swiglu_ffn__prompt_kernel_c_4b
L_gated_mix__sliding_block__swiglu_ffn__prompt_kernel_c_4l:
    ds_read_b32 v107, v106 offset:0
    s_add_u32 s101, s101, 1
    s_cmp_gt_u32 s101, s42
    s_cbranch_scc1 L_gated_mix__sliding_block__swiglu_ffn__prompt_kernel_c_4b
    s_waitcnt lgkmcnt(0)
    v_cmp_ne_u32 vcc, 0, v107
    s_nop 0
    s_cbranch_vccnz L_gated_mix__sliding_block__swiglu_ffn__prompt_kernel_c_4l
L_gated_mix__sliding_block__swiglu_ffn__prompt_kernel_c_4b:
    ds_read_b32 v107, v106 offset:16
    s_waitcnt lgkmcnt(0)
    v_cmp_ne_u32 vcc, 0, v107
    s_nop 0
    s_cbranch_vccz L_gated_mix__sliding_block__swiglu_ffn__prompt_kernel_c_5b
L_gated_mix__sliding_block__swiglu_ffn__prompt_kernel_c_5l:
    ds_read_b32 v107, v106 offset:16
    s_add_u32 s101, s101, 1
    s_cmp_gt_u32 s101, s42
    s_cbranch_scc1 L_gated_mix__sliding_block__swiglu_ffn__prompt_kernel_c_5b
    s_waitcnt lgkmcnt(0)
    v_cmp_ne_u32 vcc, 0, v107
    s_nop 0
    s_cbranch_vccnz L_gated_mix__sliding_block__swiglu_ffn__prompt_kernel_c_5l
L_gated_mix__sliding_block__swiglu_ffn__prompt_kernel_c_5b:
    ds_read_b128 a[0:3], v44 offset:0
    ds_read_b128 a[4:7], v44 offset:2048
    ds_read_b128 v[108:111], v46 offset:0
    ds_read_b64_tr_b16 v[112:113], v1 offset:0
    ds_read_b64_tr_b16 v[114:115], v1 offset:512
    ds_read_b64_tr_b16 v[116:117], v1 offset:32
    ds_read_b64_tr_b16 v[118:119], v1 offset:544
    ds_read_b64_tr_b16 v[120:121], v2 offset:0
    ds_read_b64_tr_b16 v[122:123], v2 offset:512
    ds_read_b64_tr_b16 v[124:125], v2 offset:32
    s_waitcnt lgkmcnt(3)
    v_mfma_f32_16x16x32_bf16 v[48:51], v[108:111], a[0:3], 0
    ds_read_b64_tr_b16 v[126:127], v2 offset:544
    s_mov_b32 s18, 1409024
    v_mfma_f32_16x16x32_bf16 v[52:55], v[108:111], a[4:7], 0
    ds_read_b64_tr_b16 v[108:109], v3 offset:0
    s_mov_b32 s19, 0x20000
    v_mfma_f32_16x16x32_bf16 v[56:59], v[112:115], a[0:3], 0
    ds_read_b64_tr_b16 v[110:111], v3 offset:256
    s_mov_b32 s34, 268435456
    v_mfma_f32_16x16x32_bf16 v[60:63], v[112:115], a[4:7], 0
    ds_read_b64_tr_b16 v[112:113], v3 offset:32
    s_mov_b32 s35, 0x20000
    v_mfma_f32_16x16x32_bf16 v[64:67], v[116:119], a[0:3], 0
    ds_read_b64_tr_b16 v[114:115], v3 offset:288
    s_mov_b32 s46, 256
    v_mfma_f32_16x16x32_bf16 v[68:71], v[116:119], a[4:7], 0
    ds_read_b128 a[8:11], v45 offset:0
    ds_read_b128 a[12:15], v45 offset:2048
    s_mov_b32 s47, 0x20000
    s_waitcnt lgkmcnt(4)
    v_mfma_f32_16x16x32_bf16 v[72:75], v[120:123], a[0:3], 0
    ds_read_b128 v[116:119], v46 offset:64
    s_mov_b32 s22, 1409024
    v_mfma_f32_16x16x32_bf16 v[76:79], v[120:123], a[4:7], 0
    ds_read_b64_tr_b16 v[120:121], v1 offset:4160
    s_mov_b32 s23, 0x20000
    v_mfma_f32_16x16x32_bf16 v[80:83], v[124:127], a[0:3], 0
    ds_read_b64_tr_b16 v[122:123], v1 offset:4672
    s_mov_b32 s26, 1409024
    v_mfma_f32_16x16x32_bf16 v[84:87], v[124:127], a[4:7], 0
    ds_read_b64_tr_b16 v[124:125], v1 offset:4192
    s_mov_b32 s27, 0x20000
    v_mfma_f32_16x16x32_bf16 v[88:91], v[108:111], a[0:3], 0
    ds_read_b64_tr_b16 v[126:127], v1 offset:4704
    s_mov_b32 s30, 524288
    v_mfma_f32_16x16x32_bf16 v[92:95], v[108:111], a[4:7], 0
    ds_read_b64_tr_b16 v[108:109], v2 offset:4160
    s_mov_b32 s31, 0x20000
    s_waitcnt lgkmcnt(3)
    v_mfma_f32_16x16x32_bf16 v[96:99], v[112:115], a[0:3], 0
    ds_read_b64_tr_b16 v[110:111], v2 offset:4672
    s_mov_b32 s38, 2097152
    v_mfma_f32_16x16x32_bf16 v[100:103], v[112:115], a[4:7], 0
    ds_read_b32 v107, v106 offset:48
    ds_read_b64_tr_b16 v[112:113], v2 offset:4192
    s_mov_b32 s39, 0x20000
    v_mfma_f32_16x16x32_bf16 v[48:51], v[116:119], a[8:11], v[48:51]
    ds_read_b64_tr_b16 v[114:115], v2 offset:4704
    s_bfe_u32 s53, s2, 0x20001
    v_mfma_f32_16x16x32_bf16 v[52:55], v[116:119], a[12:15], v[52:55]
    ds_read_b64_tr_b16 v[116:117], v3 offset:2112
    s_bfe_u32 s57, s2, 0x30003
    v_mfma_f32_16x16x32_bf16 v[56:59], v[120:123], a[8:11], v[56:59]
    ds_read_b64_tr_b16 v[118:119], v3 offset:2368
    s_lshl3_add_u32 s96, s53, s57
    v_mfma_f32_16x16x32_bf16 v[60:63], v[120:123], a[12:15], v[60:63]
    ds_read_b64_tr_b16 v[120:121], v3 offset:2144
    s_and_b32 s53, s2, 1
    s_waitcnt lgkmcnt(3)
    v_mfma_f32_16x16x32_bf16 v[64:67], v[124:127], a[8:11], v[64:67]
    ds_read_b64_tr_b16 v[122:123], v3 offset:2400
    v_cmp_ne_u32 vcc, 0, v107
    s_lshr_b32 s97, s2, 6
    v_mfma_f32_16x16x32_bf16 v[68:71], v[124:127], a[12:15], v[68:71]
    s_cbranch_vccz L_gated_mix__sliding_block__swiglu_ffn__prompt_kernel_c_6b
L_gated_mix__sliding_block__swiglu_ffn__prompt_kernel_c_6l:
    ds_read_b32 v107, v106 offset:48
    s_add_u32 s101, s101, 1
    s_cmp_gt_u32 s101, s42
    s_cbranch_scc1 L_gated_mix__sliding_block__swiglu_ffn__prompt_kernel_c_6b
    s_waitcnt lgkmcnt(0)
    v_cmp_ne_u32 vcc, 0, v107
    s_nop 0
    s_cbranch_vccnz L_gated_mix__sliding_block__swiglu_ffn__prompt_kernel_c_6l
L_gated_mix__sliding_block__swiglu_ffn__prompt_kernel_c_6b:
    ds_read_b32 v107, v106 offset:32
    s_waitcnt lgkmcnt(0)
    v_cmp_ne_u32 vcc, 0, v107
    s_nop 0
    s_cbranch_vccz L_gated_mix__sliding_block__swiglu_ffn__prompt_kernel_c_7b
L_gated_mix__sliding_block__swiglu_ffn__prompt_kernel_c_7l:
    ds_read_b32 v107, v106 offset:32
    s_add_u32 s101, s101, 1
    s_cmp_gt_u32 s101, s42
    s_cbranch_scc1 L_gated_mix__sliding_block__swiglu_ffn__prompt_kernel_c_7b
    s_waitcnt lgkmcnt(0)
    v_cmp_ne_u32 vcc, 0, v107
    s_nop 0
    s_cbranch_vccnz L_gated_mix__sliding_block__swiglu_ffn__prompt_kernel_c_7l
L_gated_mix__sliding_block__swiglu_ffn__prompt_kernel_c_7b:
    ds_read_b128 a[16:19], v44 offset:16384
    ds_read_b128 a[20:23], v44 offset:18432
    s_lshl2_add_u32 s97, s53, s97
    v_mfma_f32_16x16x32_bf16 v[72:75], v[108:111], a[8:11], v[72:75]
    ds_read_b128 v[124:127], v46 offset:128
    s_lshr_b32 s55, s50, 2
    v_mfma_f32_16x16x32_bf16 v[76:79], v[108:111], a[12:15], v[76:79]
    ds_read_b64_tr_b16 v[108:109], v1 offset:12544
    s_and_b32 s56, s50, 3
    v_mfma_f32_16x16x32_bf16 v[80:83], v[112:115], a[8:11], v[80:83]
    ds_read_b64_tr_b16 v[110:111], v1 offset:13056
    s_mul_i32 s55, s55, 11
    v_mfma_f32_16x16x32_bf16 v[84:87], v[112:115], a[12:15], v[84:87]
    ds_read_b64_tr_b16 v[112:113], v1 offset:12576
    s_mul_i32 s56, s56, 3
    s_waitcnt lgkmcnt(3)
    v_mfma_f32_16x16x32_bf16 v[88:91], v[116:119], a[8:11], v[88:91]
    ds_read_b64_tr_b16 v[114:115], v1 offset:13088
    s_add_u32 s62, s55, s56
    v_mfma_f32_16x16x32_bf16 v[92:95], v[116:119], a[12:15], v[92:95]
    ds_read_b64_tr_b16 v[116:117], v2 offset:12544
    s_sub_u32 s63, 11, s56
    v_mfma_f32_16x16x32_bf16 v[96:99], v[120:123], a[8:11], v[96:99]
    ds_read_b64_tr_b16 v[118:119], v2 offset:13056
    s_min_u32 s63, s63, 3
    v_mfma_f32_16x16x32_bf16 v[100:103], v[120:123], a[12:15], v[100:103]
    ds_read_b64_tr_b16 v[120:121], v2 offset:12576
    s_sub_u32 s55, 43, s62
    v_mfma_f32_16x16x32_bf16 v[48:51], v[124:127], a[16:19], v[48:51]
    ds_read_b64_tr_b16 v[122:123], v2 offset:13088
    s_min_u32 s63, s63, s55
    v_mfma_f32_16x16x32_bf16 v[52:55], v[124:127], a[20:23], v[52:55]
    ds_read_b64_tr_b16 v[124:125], v3 offset:12544
    s_mul_i32 s4, s52, 3104
    s_waitcnt lgkmcnt(3)
    v_mfma_f32_16x16x32_bf16 v[56:59], v[108:111], a[16:19], v[56:59]
    ds_read_b64_tr_b16 v[126:127], v3 offset:12800
    s_lshl2_add_u32 s7, s49, s52
    v_mfma_f32_16x16x32_bf16 v[60:63], v[108:111], a[20:23], v[60:63]
    ds_read_b64_tr_b16 v[108:109], v3 offset:12576
    v_mul_u32_u24 v40, 3104, v40
    v_mfma_f32_16x16x32_bf16 v[64:67], v[112:115], a[16:19], v[64:67]
    ds_read_b64_tr_b16 v[110:111], v3 offset:12832
    s_and_b32 s55, s62, 1
    v_mfma_f32_16x16x32_bf16 v[68:71], v[112:115], a[20:23], v[68:71]
    ds_read_b128 a[24:27], v45 offset:16384
    ds_read_b128 a[28:31], v45 offset:18432
    v_xor_b32 v41, s55, v41
    v_mfma_f32_16x16x32_bf16 v[72:75], v[116:119], a[16:19], v[72:75]
    ds_read_b128 v[112:115], v46 offset:192
    v_mul_u32_u24 v41, 192, v41
    v_mfma_f32_16x16x32_bf16 v[76:79], v[116:119], a[20:23], v[76:79]
    ds_read_b64_tr_b16 v[116:117], v1 offset:16704
    v_add3_u32 v7, v40, v41, v42
    s_waitcnt lgkmcnt(4)
    v_mfma_f32_16x16x32_bf16 v[80:83], v[120:123], a[16:19], v[80:83]
    ds_read_b64_tr_b16 v[118:119], v1 offset:17216
    v_add_u32 v5, 65536, v7
    v_mfma_f32_16x16x32_bf16 v[84:87], v[120:123], a[20:23], v[84:87]
    ds_read_b64_tr_b16 v[120:121], v1 offset:16736
    v_add_u32 v6, 115712, v7
    v_mfma_f32_16x16x32_bf16 v[88:91], v[124:127], a[16:19], v[88:91]
    ds_read_b64_tr_b16 v[122:123], v1 offset:17248
    s_lshr_b32 s55, s50, 1
    v_mfma_f32_16x16x32_bf16 v[92:95], v[124:127], a[20:23], v[92:95]
    ds_read_b64_tr_b16 v[124:125], v2 offset:16704
    s_lshl_b32 s55, s55, 18
    v_mfma_f32_16x16x32_bf16 v[96:99], v[108:111], a[16:19], v[96:99]
    ds_read_b64_tr_b16 v[126:127], v2 offset:17216
    s_lshl_b32 s56, s7, 10
    v_mfma_f32_16x16x32_bf16 v[100:103], v[108:111], a[20:23], v[100:103]
    ds_read_b32 v107, v106 offset:64
    ds_read_b64_tr_b16 v[108:109], v2 offset:16736
    s_add_u32 s55, s55, s56
    s_waitcnt lgkmcnt(4)
    v_mfma_f32_16x16x32_bf16 v[48:51], v[112:115], a[24:27], v[48:51]
    ds_read_b64_tr_b16 v[110:111], v2 offset:17248
    s_add_u32 s53, s55, s56
    v_mfma_f32_16x16x32_bf16 v[52:55], v[112:115], a[28:31], v[52:55]
    s_barrier
    ds_read_b64_tr_b16 v[112:113], v3 offset:14656
    s_add_u32 s55, s55, 10485760
    v_mfma_f32_16x16x32_bf16 v[56:59], v[116:119], a[24:27], v[56:59]
    ds_read_b64_tr_b16 v[114:115], v3 offset:14912
    s_add_u32 s53, s53, 12582912
    v_mfma_f32_16x16x32_bf16 v[60:63], v[116:119], a[28:31], v[60:63]
    ds_read_b64_tr_b16 v[116:117], v3 offset:14688
    s_lshl_b32 s61, s50, 6
    v_mfma_f32_16x16x32_bf16 v[64:67], v[120:123], a[24:27], v[64:67]
    ds_read_b64_tr_b16 v[118:119], v3 offset:14944
    s_waitcnt lgkmcnt(6)
    v_cmp_ne_u32 vcc, 0, v107
    s_add_u32 s61, s61, s7
    v_mfma_f32_16x16x32_bf16 v[68:71], v[120:123], a[28:31], v[68:71]
    s_cbranch_vccz L_gated_mix__sliding_block__swiglu_ffn__prompt_kernel_c_8b
L_gated_mix__sliding_block__swiglu_ffn__prompt_kernel_c_8l:
    ds_read_b32 v107, v106 offset:64
    s_add_u32 s101, s101, 1
    s_cmp_gt_u32 s101, s42
    s_cbranch_scc1 L_gated_mix__sliding_block__swiglu_ffn__prompt_kernel_c_8b
    s_waitcnt lgkmcnt(0)
    v_cmp_ne_u32 vcc, 0, v107
    s_nop 0
    s_cbranch_vccnz L_gated_mix__sliding_block__swiglu_ffn__prompt_kernel_c_8l
L_gated_mix__sliding_block__swiglu_ffn__prompt_kernel_c_8b:
    ds_read_b128 a[32:35], v44 offset:32768
    ds_read_b128 a[36:39], v44 offset:34816
    s_lshl_b32 s61, s61, 7
    s_waitcnt lgkmcnt(4)
    v_mfma_f32_16x16x32_bf16 v[72:75], v[124:127], a[24:27], v[72:75]
    ds_read_b128 v[120:123], v46 offset:256
    s_add_u32 s61, s61, 14680064
    v_mfma_f32_16x16x32_bf16 v[76:79], v[124:127], a[28:31], v[76:79]
    ds_read_b64_tr_b16 v[124:125], v1 offset:25088
    s_lshl_b32 s54, s52, 11
    v_mfma_f32_16x16x32_bf16 v[80:83], v[108:111], a[24:27], v[80:83]
    ds_read_b64_tr_b16 v[126:127], v1 offset:25600
    s_add_u32 s54, s54, 154368
    v_mfma_f32_16x16x32_bf16 v[84:87], v[108:111], a[28:31], v[84:87]
    ds_read_b64_tr_b16 v[108:109], v1 offset:25120
    s_lshl_b32 s57, s52, 8
    v_mfma_f32_16x16x32_bf16 v[88:91], v[112:115], a[24:27], v[88:91]
    ds_read_b64_tr_b16 v[110:111], v1 offset:25632
    s_add_u32 s57, s57, 162560
    v_mfma_f32_16x16x32_bf16 v[92:95], v[112:115], a[28:31], v[92:95]
    ds_read_b64_tr_b16 v[112:113], v2 offset:25088
    s_mul_i32 s60, s7, 120832
    s_waitcnt lgkmcnt(3)
    v_mfma_f32_16x16x32_bf16 v[96:99], v[116:119], a[24:27], v[96:99]
    ds_read_b64_tr_b16 v[114:115], v2 offset:25600
    s_lshl_b32 s56, s62, 11
    v_mfma_f32_16x16x32_bf16 v[100:103], v[116:119], a[28:31], v[100:103]
    ds_read_b64_tr_b16 v[116:117], v2 offset:25120
    s_add_u32 s60, s60, s56
    v_mfma_f32_16x16x32_bf16 v[48:51], v[120:123], a[32:35], v[48:51]
    ds_read_b64_tr_b16 v[118:119], v2 offset:25632
    s_add_u32 s60, s60, 0
    v_mfma_f32_16x16x32_bf16 v[52:55], v[120:123], a[36:39], v[52:55]
    ds_read_b64_tr_b16 v[120:121], v3 offset:25088
    s_lshl_b32 s59, s7, 4
    v_mfma_f32_16x16x32_bf16 v[56:59], v[124:127], a[32:35], v[56:59]
    ds_read_b64_tr_b16 v[122:123], v3 offset:25344
    s_add_u32 s59, s59, s50
    v_mfma_f32_16x16x32_bf16 v[60:63], v[124:127], a[36:39], v[60:63]
    ds_read_b64_tr_b16 v[124:125], v3 offset:25120
    s_lshl_b32 s59, s59, 8
    s_waitcnt lgkmcnt(3)
    v_mfma_f32_16x16x32_bf16 v[64:67], v[108:111], a[32:35], v[64:67]
    ds_read_b64_tr_b16 v[126:127], v3 offset:25376
    s_add_u32 s59, s59, 14811136
    v_mfma_f32_16x16x32_bf16 v[68:71], v[108:111], a[36:39], v[68:71]
    ds_read_b128 a[40:43], v45 offset:32768
    ds_read_b128 a[44:47], v45 offset:34816
    s_mov_b32 s58, 0xbfb8aa3b
    v_mfma_f32_16x16x32_bf16 v[72:75], v[112:115], a[32:35], v[72:75]
    ds_read_b128 v[108:111], v46 offset:320
    v_mfma_f32_16x16x32_bf16 v[76:79], v[112:115], a[36:39], v[76:79]
    ds_read_b64_tr_b16 v[112:113], v1 offset:29248
    v_mfma_f32_16x16x32_bf16 v[80:83], v[116:119], a[32:35], v[80:83]
    ds_read_b64_tr_b16 v[114:115], v1 offset:29760
    v_mfma_f32_16x16x32_bf16 v[84:87], v[116:119], a[36:39], v[84:87]
    ds_read_b64_tr_b16 v[116:117], v1 offset:29280
    s_waitcnt lgkmcnt(3)
    v_mfma_f32_16x16x32_bf16 v[88:91], v[120:123], a[32:35], v[88:91]
    ds_read_b64_tr_b16 v[118:119], v1 offset:29792
    v_mfma_f32_16x16x32_bf16 v[92:95], v[120:123], a[36:39], v[92:95]
    ds_read_b64_tr_b16 v[120:121], v2 offset:29248
    v_mfma_f32_16x16x32_bf16 v[96:99], v[124:127], a[32:35], v[96:99]
    ds_read_b64_tr_b16 v[122:123], v2 offset:29760
    v_mfma_f32_16x16x32_bf16 v[100:103], v[124:127], a[36:39], v[100:103]
    ds_read_b32 v107, v106 offset:80
    ds_read_b64_tr_b16 v[124:125], v2 offset:29280
    v_mfma_f32_16x16x32_bf16 v[48:51], v[108:111], a[40:43], v[48:51]
    ds_read_b64_tr_b16 v[126:127], v2 offset:29792
    v_mfma_f32_16x16x32_bf16 v[52:55], v[108:111], a[44:47], v[52:55]
    s_barrier
    ds_read_b64_tr_b16 v[108:109], v3 offset:27200
    s_waitcnt lgkmcnt(4)
    v_mfma_f32_16x16x32_bf16 v[56:59], v[112:115], a[40:43], v[56:59]
    ds_read_b64_tr_b16 v[110:111], v3 offset:27456
    v_mfma_f32_16x16x32_bf16 v[60:63], v[112:115], a[44:47], v[60:63]
    ds_read_b64_tr_b16 v[112:113], v3 offset:27232
    v_mfma_f32_16x16x32_bf16 v[64:67], v[116:119], a[40:43], v[64:67]
    ds_read_b64_tr_b16 v[114:115], v3 offset:27488
    s_waitcnt lgkmcnt(6)
    v_cmp_ne_u32 vcc, 0, v107
    v_mfma_f32_16x16x32_bf16 v[68:71], v[116:119], a[44:47], v[68:71]
    s_cbranch_vccz L_gated_mix__sliding_block__swiglu_ffn__prompt_kernel_c_9b
L_gated_mix__sliding_block__swiglu_ffn__prompt_kernel_c_9l:
    ds_read_b32 v107, v106 offset:80
    s_add_u32 s101, s101, 1
    s_cmp_gt_u32 s101, s42
    s_cbranch_scc1 L_gated_mix__sliding_block__swiglu_ffn__prompt_kernel_c_9b
    s_waitcnt lgkmcnt(0)
    v_cmp_ne_u32 vcc, 0, v107
    s_nop 0
    s_cbranch_vccnz L_gated_mix__sliding_block__swiglu_ffn__prompt_kernel_c_9l
L_gated_mix__sliding_block__swiglu_ffn__prompt_kernel_c_9b:
    ds_read_b128 a[48:51], v44 offset:49152
    ds_read_b128 a[52:55], v44 offset:51200
    v_mfma_f32_16x16x32_bf16 v[72:75], v[120:123], a[40:43], v[72:75]
    ds_read_b128 v[116:119], v46 offset:384
    v_mfma_f32_16x16x32_bf16 v[76:79], v[120:123], a[44:47], v[76:79]
    ds_read_b64_tr_b16 v[120:121], v1 offset:37632
    s_waitcnt lgkmcnt(4)
    v_mfma_f32_16x16x32_bf16 v[80:83], v[124:127], a[40:43], v[80:83]
    ds_read_b64_tr_b16 v[122:123], v1 offset:38144
    v_mfma_f32_16x16x32_bf16 v[84:87], v[124:127], a[44:47], v[84:87]
    ds_read_b64_tr_b16 v[124:125], v1 offset:37664
    v_mfma_f32_16x16x32_bf16 v[88:91], v[108:111], a[40:43], v[88:91]
    ds_read_b64_tr_b16 v[126:127], v1 offset:38176
    v_mfma_f32_16x16x32_bf16 v[92:95], v[108:111], a[44:47], v[92:95]
    ds_read_b64_tr_b16 v[108:109], v2 offset:37632
    v_mfma_f32_16x16x32_bf16 v[96:99], v[112:115], a[40:43], v[96:99]
    ds_read_b64_tr_b16 v[110:111], v2 offset:38144
    v_mfma_f32_16x16x32_bf16 v[100:103], v[112:115], a[44:47], v[100:103]
    ds_read_b64_tr_b16 v[112:113], v2 offset:37664
    s_waitcnt lgkmcnt(3)
    v_mfma_f32_16x16x32_bf16 v[48:51], v[116:119], a[48:51], v[48:51]
    ds_read_b64_tr_b16 v[114:115], v2 offset:38176
    v_mfma_f32_16x16x32_bf16 v[52:55], v[116:119], a[52:55], v[52:55]
    ds_read_b64_tr_b16 v[116:117], v3 offset:37632
    v_mfma_f32_16x16x32_bf16 v[56:59], v[120:123], a[48:51], v[56:59]
    ds_read_b64_tr_b16 v[118:119], v3 offset:37888
    v_mfma_f32_16x16x32_bf16 v[60:63], v[120:123], a[52:55], v[60:63]
    ds_read_b64_tr_b16 v[120:121], v3 offset:37664
    v_mfma_f32_16x16x32_bf16 v[64:67], v[124:127], a[48:51], v[64:67]
    ds_read_b64_tr_b16 v[122:123], v3 offset:37920
    v_mfma_f32_16x16x32_bf16 v[68:71], v[124:127], a[52:55], v[68:71]
    ds_read_b128 a[56:59], v45 offset:49152
    ds_read_b128 a[60:63], v45 offset:51200
    s_waitcnt lgkmcnt(4)
    v_mfma_f32_16x16x32_bf16 v[72:75], v[108:111], a[48:51], v[72:75]
    ds_read_b128 v[124:127], v46 offset:448
    v_mfma_f32_16x16x32_bf16 v[76:79], v[108:111], a[52:55], v[76:79]
    ds_read_b64_tr_b16 v[108:109], v1 offset:41792
    v_mfma_f32_16x16x32_bf16 v[80:83], v[112:115], a[48:51], v[80:83]
    ds_read_b64_tr_b16 v[110:111], v1 offset:42304
    v_mfma_f32_16x16x32_bf16 v[84:87], v[112:115], a[52:55], v[84:87]
    ds_read_b64_tr_b16 v[112:113], v1 offset:41824
    v_mfma_f32_16x16x32_bf16 v[88:91], v[116:119], a[48:51], v[88:91]
    ds_read_b64_tr_b16 v[114:115], v1 offset:42336
    v_mfma_f32_16x16x32_bf16 v[92:95], v[116:119], a[52:55], v[92:95]
    ds_read_b64_tr_b16 v[116:117], v2 offset:41792
    s_waitcnt lgkmcnt(3)
    v_mfma_f32_16x16x32_bf16 v[96:99], v[120:123], a[48:51], v[96:99]
    ds_read_b64_tr_b16 v[118:119], v2 offset:42304
    v_mfma_f32_16x16x32_bf16 v[100:103], v[120:123], a[52:55], v[100:103]
    ds_read_b32 v107, v106 offset:96
    ds_read_b64_tr_b16 v[120:121], v2 offset:41824
    v_mfma_f32_16x16x32_bf16 v[48:51], v[124:127], a[56:59], v[48:51]
    ds_read_b64_tr_b16 v[122:123], v2 offset:42336
    v_mfma_f32_16x16x32_bf16 v[52:55], v[124:127], a[60:63], v[52:55]
    s_barrier
    ds_read_b64_tr_b16 v[124:125], v3 offset:39744
    v_mfma_f32_16x16x32_bf16 v[56:59], v[108:111], a[56:59], v[56:59]
    ds_read_b64_tr_b16 v[126:127], v3 offset:40000
    v_mfma_f32_16x16x32_bf16 v[60:63], v[108:111], a[60:63], v[60:63]
    ds_read_b64_tr_b16 v[108:109], v3 offset:39776
    s_waitcnt lgkmcnt(3)
    v_mfma_f32_16x16x32_bf16 v[64:67], v[112:115], a[56:59], v[64:67]
    ds_read_b64_tr_b16 v[110:111], v3 offset:40032
    v_cmp_ne_u32 vcc, 0, v107
    v_mfma_f32_16x16x32_bf16 v[68:71], v[112:115], a[60:63], v[68:71]
    s_cbranch_vccz L_gated_mix__sliding_block__swiglu_ffn__prompt_kernel_c_10b
L_gated_mix__sliding_block__swiglu_ffn__prompt_kernel_c_10l:
    ds_read_b32 v107, v106 offset:96
    s_add_u32 s101, s101, 1
    s_cmp_gt_u32 s101, s42
    s_cbranch_scc1 L_gated_mix__sliding_block__swiglu_ffn__prompt_kernel_c_10b
    s_waitcnt lgkmcnt(0)
    v_cmp_ne_u32 vcc, 0, v107
    s_nop 0
    s_cbranch_vccnz L_gated_mix__sliding_block__swiglu_ffn__prompt_kernel_c_10l
L_gated_mix__sliding_block__swiglu_ffn__prompt_kernel_c_10b:
    ds_read_b128 a[64:67], v44 offset:0
    ds_read_b128 a[68:71], v44 offset:2048
    v_mfma_f32_16x16x32_bf16 v[72:75], v[116:119], a[56:59], v[72:75]
    ds_read_b128 v[112:115], v46 offset:512
    v_mfma_f32_16x16x32_bf16 v[76:79], v[116:119], a[60:63], v[76:79]
    ds_read_b64_tr_b16 v[116:117], v1 offset:0
    v_mfma_f32_16x16x32_bf16 v[80:83], v[120:123], a[56:59], v[80:83]
    ds_read_b64_tr_b16 v[118:119], v1 offset:512
    v_mfma_f32_16x16x32_bf16 v[84:87], v[120:123], a[60:63], v[84:87]
    ds_read_b64_tr_b16 v[120:121], v1 offset:32
    s_waitcnt lgkmcnt(3)
    v_mfma_f32_16x16x32_bf16 v[88:91], v[124:127], a[56:59], v[88:91]
    ds_read_b64_tr_b16 v[122:123], v1 offset:544
    v_mfma_f32_16x16x32_bf16 v[92:95], v[124:127], a[60:63], v[92:95]
    ds_read_b64_tr_b16 v[124:125], v2 offset:0
    v_mfma_f32_16x16x32_bf16 v[96:99], v[108:111], a[56:59], v[96:99]
    ds_read_b64_tr_b16 v[126:127], v2 offset:512
    v_mfma_f32_16x16x32_bf16 v[100:103], v[108:111], a[60:63], v[100:103]
    ds_read_b64_tr_b16 v[108:109], v2 offset:32
    v_mfma_f32_16x16x32_bf16 v[48:51], v[112:115], a[64:67], v[48:51]
    ds_read_b64_tr_b16 v[110:111], v2 offset:544
    v_mfma_f32_16x16x32_bf16 v[52:55], v[112:115], a[68:71], v[52:55]
    ds_read_b64_tr_b16 v[112:113], v3 offset:0
    s_waitcnt lgkmcnt(3)
    v_mfma_f32_16x16x32_bf16 v[56:59], v[116:119], a[64:67], v[56:59]
    ds_read_b64_tr_b16 v[114:115], v3 offset:256
    v_mfma_f32_16x16x32_bf16 v[60:63], v[116:119], a[68:71], v[60:63]
    ds_read_b64_tr_b16 v[116:117], v3 offset:32
    v_mfma_f32_16x16x32_bf16 v[64:67], v[120:123], a[64:67], v[64:67]
    ds_read_b64_tr_b16 v[118:119], v3 offset:288
    v_mfma_f32_16x16x32_bf16 v[68:71], v[120:123], a[68:71], v[68:71]
    ds_read_b128 a[72:75], v45 offset:0
    ds_read_b128 a[76:79], v45 offset:2048
    v_mfma_f32_16x16x32_bf16 v[72:75], v[124:127], a[64:67], v[72:75]
    ds_read_b128 v[120:123], v46 offset:576
    v_mfma_f32_16x16x32_bf16 v[76:79], v[124:127], a[68:71], v[76:79]
    ds_read_b64_tr_b16 v[124:125], v1 offset:4160
    s_waitcnt lgkmcnt(4)
    v_mfma_f32_16x16x32_bf16 v[80:83], v[108:111], a[64:67], v[80:83]
    ds_read_b64_tr_b16 v[126:127], v1 offset:4672
    v_mfma_f32_16x16x32_bf16 v[84:87], v[108:111], a[68:71], v[84:87]
    ds_read_b64_tr_b16 v[108:109], v1 offset:4192
    v_mfma_f32_16x16x32_bf16 v[88:91], v[112:115], a[64:67], v[88:91]
    ds_read_b64_tr_b16 v[110:111], v1 offset:4704
    v_mfma_f32_16x16x32_bf16 v[92:95], v[112:115], a[68:71], v[92:95]
    ds_read_b64_tr_b16 v[112:113], v2 offset:4160
    v_mfma_f32_16x16x32_bf16 v[96:99], v[116:119], a[64:67], v[96:99]
    ds_read_b64_tr_b16 v[114:115], v2 offset:4672
    v_mfma_f32_16x16x32_bf16 v[100:103], v[116:119], a[68:71], v[100:103]
    ds_read_b32 v107, v106 offset:112
    ds_read_b64_tr_b16 v[116:117], v2 offset:4192
    s_waitcnt lgkmcnt(4)
    v_mfma_f32_16x16x32_bf16 v[48:51], v[120:123], a[72:75], v[48:51]
    ds_read_b64_tr_b16 v[118:119], v2 offset:4704
    v_mfma_f32_16x16x32_bf16 v[52:55], v[120:123], a[76:79], v[52:55]
    s_barrier
    ds_read_b64_tr_b16 v[120:121], v3 offset:2112
    v_mfma_f32_16x16x32_bf16 v[56:59], v[124:127], a[72:75], v[56:59]
    ds_read_b64_tr_b16 v[122:123], v3 offset:2368
    v_mfma_f32_16x16x32_bf16 v[60:63], v[124:127], a[76:79], v[60:63]
    ds_read_b64_tr_b16 v[124:125], v3 offset:2144
    v_mfma_f32_16x16x32_bf16 v[64:67], v[108:111], a[72:75], v[64:67]
    ds_read_b64_tr_b16 v[126:127], v3 offset:2400
    s_waitcnt lgkmcnt(6)
    v_cmp_ne_u32 vcc, 0, v107
    v_mfma_f32_16x16x32_bf16 v[68:71], v[108:111], a[76:79], v[68:71]
    s_cbranch_vccz L_gated_mix__sliding_block__swiglu_ffn__prompt_kernel_c_11b
L_gated_mix__sliding_block__swiglu_ffn__prompt_kernel_c_11l:
    ds_read_b32 v107, v106 offset:112
    s_add_u32 s101, s101, 1
    s_cmp_gt_u32 s101, s42
    s_cbranch_scc1 L_gated_mix__sliding_block__swiglu_ffn__prompt_kernel_c_11b
    s_waitcnt lgkmcnt(0)
    v_cmp_ne_u32 vcc, 0, v107
    s_nop 0
    s_cbranch_vccnz L_gated_mix__sliding_block__swiglu_ffn__prompt_kernel_c_11l
L_gated_mix__sliding_block__swiglu_ffn__prompt_kernel_c_11b:
    ds_read_b128 a[80:83], v44 offset:16384
    ds_read_b128 a[84:87], v44 offset:18432
    s_waitcnt lgkmcnt(4)
    v_mfma_f32_16x16x32_bf16 v[72:75], v[112:115], a[72:75], v[72:75]
    ds_read_b128 v[108:111], v46 offset:640
    v_mfma_f32_16x16x32_bf16 v[76:79], v[112:115], a[76:79], v[76:79]
    ds_read_b64_tr_b16 v[112:113], v1 offset:12544
    v_mfma_f32_16x16x32_bf16 v[80:83], v[116:119], a[72:75], v[80:83]
    ds_read_b64_tr_b16 v[114:115], v1 offset:13056
    v_mfma_f32_16x16x32_bf16 v[84:87], v[116:119], a[76:79], v[84:87]
    ds_read_b64_tr_b16 v[116:117], v1 offset:12576
    v_mfma_f32_16x16x32_bf16 v[88:91], v[120:123], a[72:75], v[88:91]
    ds_read_b64_tr_b16 v[118:119], v1 offset:13088
    v_mfma_f32_16x16x32_bf16 v[92:95], v[120:123], a[76:79], v[92:95]
    ds_read_b64_tr_b16 v[120:121], v2 offset:12544
    s_waitcnt lgkmcnt(3)
    v_mfma_f32_16x16x32_bf16 v[96:99], v[124:127], a[72:75], v[96:99]
    ds_read_b64_tr_b16 v[122:123], v2 offset:13056
    v_mfma_f32_16x16x32_bf16 v[100:103], v[124:127], a[76:79], v[100:103]
    ds_read_b64_tr_b16 v[124:125], v2 offset:12576
    v_mfma_f32_16x16x32_bf16 v[48:51], v[108:111], a[80:83], v[48:51]
    ds_read_b64_tr_b16 v[126:127], v2 offset:13088
    v_mfma_f32_16x16x32_bf16 v[52:55], v[108:111], a[84:87], v[52:55]
    ds_read_b64_tr_b16 v[108:109], v3 offset:12544
    s_waitcnt vmcnt(0)
    v_mfma_f32_16x16x32_bf16 v[56:59], v[112:115], a[80:83], v[56:59]
    ds_read_b64_tr_b16 v[110:111], v3 offset:12800
    v_mfma_f32_16x16x32_bf16 v[60:63], v[112:115], a[84:87], v[60:63]
    ds_read_b64_tr_b16 v[112:113], v3 offset:12576
    s_waitcnt lgkmcnt(3)
    v_mfma_f32_16x16x32_bf16 v[64:67], v[116:119], a[80:83], v[64:67]
    ds_read_b64_tr_b16 v[114:115], v3 offset:12832
    v_mfma_f32_16x16x32_bf16 v[68:71], v[116:119], a[84:87], v[68:71]
    ds_read_b128 a[88:91], v45 offset:16384
    ds_read_b128 a[92:95], v45 offset:18432
    v_mfma_f32_16x16x32_bf16 v[72:75], v[120:123], a[80:83], v[72:75]
    ds_read_b128 v[116:119], v46 offset:704
    v_mfma_f32_16x16x32_bf16 v[76:79], v[120:123], a[84:87], v[76:79]
    ds_read_b64_tr_b16 v[120:121], v1 offset:16704
    v_mfma_f32_16x16x32_bf16 v[80:83], v[124:127], a[80:83], v[80:83]
    ds_read_b64_tr_b16 v[122:123], v1 offset:17216
    v_mfma_f32_16x16x32_bf16 v[84:87], v[124:127], a[84:87], v[84:87]
    ds_read_b64_tr_b16 v[124:125], v1 offset:16736
    s_waitcnt lgkmcnt(3)
    v_mfma_f32_16x16x32_bf16 v[88:91], v[108:111], a[80:83], v[88:91]
    ds_read_b64_tr_b16 v[126:127], v1 offset:17248
    v_mfma_f32_16x16x32_bf16 v[92:95], v[108:111], a[84:87], v[92:95]
    ds_read_b64_tr_b16 v[108:109], v2 offset:16704
    v_mfma_f32_16x16x32_bf16 v[96:99], v[112:115], a[80:83], v[96:99]
    ds_read_b64_tr_b16 v[110:111], v2 offset:17216
    v_mfma_f32_16x16x32_bf16 v[100:103], v[112:115], a[84:87], v[100:103]
    ds_read_b32 v107, v106 offset:128
    ds_read_b64_tr_b16 v[112:113], v2 offset:16736
    v_mfma_f32_16x16x32_bf16 v[48:51], v[116:119], a[88:91], v[48:51]
    ds_read_b64_tr_b16 v[114:115], v2 offset:17248
    v_mfma_f32_16x16x32_bf16 v[52:55], v[116:119], a[92:95], v[52:55]
    ds_read_b64_tr_b16 v[116:117], v3 offset:14656
    s_waitcnt lgkmcnt(4)
    v_mfma_f32_16x16x32_bf16 v[56:59], v[120:123], a[88:91], v[56:59]
    ds_read_b64_tr_b16 v[118:119], v3 offset:14912
    v_mfma_f32_16x16x32_bf16 v[60:63], v[120:123], a[92:95], v[60:63]
    ds_read_b64_tr_b16 v[120:121], v3 offset:14688
    v_mfma_f32_16x16x32_bf16 v[64:67], v[124:127], a[88:91], v[64:67]
    ds_read_b64_tr_b16 v[122:123], v3 offset:14944
    s_waitcnt lgkmcnt(6)
    v_cmp_ne_u32 vcc, 0, v107
    v_mfma_f32_16x16x32_bf16 v[68:71], v[124:127], a[92:95], v[68:71]
    s_cbranch_vccz L_gated_mix__sliding_block__swiglu_ffn__prompt_kernel_c_12b
L_gated_mix__sliding_block__swiglu_ffn__prompt_kernel_c_12l:
    ds_read_b32 v107, v106 offset:128
    s_add_u32 s101, s101, 1
    s_cmp_gt_u32 s101, s42
    s_cbranch_scc1 L_gated_mix__sliding_block__swiglu_ffn__prompt_kernel_c_12b
    s_waitcnt lgkmcnt(0)
    v_cmp_ne_u32 vcc, 0, v107
    s_nop 0
    s_cbranch_vccnz L_gated_mix__sliding_block__swiglu_ffn__prompt_kernel_c_12l
L_gated_mix__sliding_block__swiglu_ffn__prompt_kernel_c_12b:
    ds_read_b128 a[96:99], v44 offset:32768
    ds_read_b128 a[100:103], v44 offset:34816
    v_mfma_f32_16x16x32_bf16 v[72:75], v[108:111], a[88:91], v[72:75]
    ds_read_b128 v[124:127], v46 offset:768
    v_mfma_f32_16x16x32_bf16 v[76:79], v[108:111], a[92:95], v[76:79]
    ds_read_b64_tr_b16 v[108:109], v1 offset:25088
    s_waitcnt lgkmcnt(4)
    v_mfma_f32_16x16x32_bf16 v[80:83], v[112:115], a[88:91], v[80:83]
    ds_read_b64_tr_b16 v[110:111], v1 offset:25600
    v_mfma_f32_16x16x32_bf16 v[84:87], v[112:115], a[92:95], v[84:87]
    ds_read_b64_tr_b16 v[112:113], v1 offset:25120
    v_mfma_f32_16x16x32_bf16 v[88:91], v[116:119], a[88:91], v[88:91]
    ds_read_b64_tr_b16 v[114:115], v1 offset:25632
    v_mfma_f32_16x16x32_bf16 v[92:95], v[116:119], a[92:95], v[92:95]
    ds_read_b64_tr_b16 v[116:117], v2 offset:25088
    buffer_load_dword v47, off, s[44:47], 0 sc1
    v_mfma_f32_16x16x32_bf16 v[96:99], v[120:123], a[88:91], v[96:99]
    ds_read_b64_tr_b16 v[118:119], v2 offset:25600
    v_mfma_f32_16x16x32_bf16 v[100:103], v[120:123], a[92:95], v[100:103]
    ds_read_b64_tr_b16 v[120:121], v2 offset:25120
    s_waitcnt lgkmcnt(3)
    v_mfma_f32_16x16x32_bf16 v[48:51], v[124:127], a[96:99], v[48:51]
    ds_read_b64_tr_b16 v[122:123], v2 offset:25632
    v_mfma_f32_16x16x32_bf16 v[52:55], v[124:127], a[100:103], v[52:55]
    ds_read_b64_tr_b16 v[124:125], v3 offset:25088
    v_mfma_f32_16x16x32_bf16 v[56:59], v[108:111], a[96:99], v[56:59]
    ds_read_b64_tr_b16 v[126:127], v3 offset:25344
    v_mfma_f32_16x16x32_bf16 v[60:63], v[108:111], a[100:103], v[60:63]
    ds_read_b64_tr_b16 v[108:109], v3 offset:25120
    v_mfma_f32_16x16x32_bf16 v[64:67], v[112:115], a[96:99], v[64:67]
    ds_read_b64_tr_b16 v[110:111], v3 offset:25376
    v_mfma_f32_16x16x32_bf16 v[68:71], v[112:115], a[100:103], v[68:71]
    ds_read_b128 a[104:107], v45 offset:32768
    ds_read_b128 a[108:111], v45 offset:34816
    s_waitcnt lgkmcnt(4)
    v_mfma_f32_16x16x32_bf16 v[72:75], v[116:119], a[96:99], v[72:75]
    ds_read_b128 v[112:115], v46 offset:832
    v_mfma_f32_16x16x32_bf16 v[76:79], v[116:119], a[100:103], v[76:79]
    ds_read_b64_tr_b16 v[116:117], v1 offset:29248
    v_mfma_f32_16x16x32_bf16 v[80:83], v[120:123], a[96:99], v[80:83]
    ds_read_b64_tr_b16 v[118:119], v1 offset:29760
    v_mfma_f32_16x16x32_bf16 v[84:87], v[120:123], a[100:103], v[84:87]
    ds_read_b64_tr_b16 v[120:121], v1 offset:29280
    v_mfma_f32_16x16x32_bf16 v[88:91], v[124:127], a[96:99], v[88:91]
    ds_read_b64_tr_b16 v[122:123], v1 offset:29792
    v_mfma_f32_16x16x32_bf16 v[92:95], v[124:127], a[100:103], v[92:95]
    ds_read_b64_tr_b16 v[124:125], v2 offset:29248
    s_waitcnt lgkmcnt(3)
    v_mfma_f32_16x16x32_bf16 v[96:99], v[108:111], a[96:99], v[96:99]
    ds_read_b64_tr_b16 v[126:127], v2 offset:29760
    v_mfma_f32_16x16x32_bf16 v[100:103], v[108:111], a[100:103], v[100:103]
    ds_read_b32 v107, v106 offset:144
    ds_read_b64_tr_b16 v[108:109], v2 offset:29280
    v_mfma_f32_16x16x32_bf16 v[48:51], v[112:115], a[104:107], v[48:51]
    ds_read_b64_tr_b16 v[110:111], v2 offset:29792
    v_mfma_f32_16x16x32_bf16 v[52:55], v[112:115], a[108:111], v[52:55]
    ds_read_b64_tr_b16 v[112:113], v3 offset:27200
    v_mfma_f32_16x16x32_bf16 v[56:59], v[116:119], a[104:107], v[56:59]
    ds_read_b64_tr_b16 v[114:115], v3 offset:27456
    v_mfma_f32_16x16x32_bf16 v[60:63], v[116:119], a[108:111], v[60:63]
    ds_read_b64_tr_b16 v[116:117], v3 offset:27232
    s_waitcnt lgkmcnt(3)
    v_mfma_f32_16x16x32_bf16 v[64:67], v[120:123], a[104:107], v[64:67]
    ds_read_b64_tr_b16 v[118:119], v3 offset:27488
    v_cmp_ne_u32 vcc, 0, v107
    v_mfma_f32_16x16x32_bf16 v[68:71], v[120:123], a[108:111], v[68:71]
    s_barrier
    s_cbranch_vccz L_gated_mix__sliding_block__swiglu_ffn__prompt_kernel_c_13b
L_gated_mix__sliding_block__swiglu_ffn__prompt_kernel_c_13l:
    ds_read_b32 v107, v106 offset:144
    s_add_u32 s101, s101, 1
    s_cmp_gt_u32 s101, s42
    s_cbranch_scc1 L_gated_mix__sliding_block__swiglu_ffn__prompt_kernel_c_13b
    s_waitcnt lgkmcnt(0)
    v_cmp_ne_u32 vcc, 0, v107
    s_nop 0
    s_cbranch_vccnz L_gated_mix__sliding_block__swiglu_ffn__prompt_kernel_c_13l
L_gated_mix__sliding_block__swiglu_ffn__prompt_kernel_c_13b:
    ds_read_b128 a[112:115], v44 offset:49152
    ds_read_b128 a[116:119], v44 offset:51200
    v_mfma_f32_16x16x32_bf16 v[72:75], v[124:127], a[104:107], v[72:75]
    ds_read_b128 v[120:123], v46 offset:896
    v_mfma_f32_16x16x32_bf16 v[76:79], v[124:127], a[108:111], v[76:79]
    ds_read_b64_tr_b16 v[124:125], v1 offset:37632
    v_mfma_f32_16x16x32_bf16 v[80:83], v[108:111], a[104:107], v[80:83]
    ds_read_b64_tr_b16 v[126:127], v1 offset:38144
    v_mfma_f32_16x16x32_bf16 v[84:87], v[108:111], a[108:111], v[84:87]
    ds_read_b64_tr_b16 v[108:109], v1 offset:37664
    s_waitcnt lgkmcnt(3)
    v_mfma_f32_16x16x32_bf16 v[88:91], v[112:115], a[104:107], v[88:91]
    ds_read_b64_tr_b16 v[110:111], v1 offset:38176
    v_mfma_f32_16x16x32_bf16 v[92:95], v[112:115], a[108:111], v[92:95]
    ds_read_b64_tr_b16 v[112:113], v2 offset:37632
    v_mfma_f32_16x16x32_bf16 v[96:99], v[116:119], a[104:107], v[96:99]
    ds_read_b64_tr_b16 v[114:115], v2 offset:38144
    v_mfma_f32_16x16x32_bf16 v[100:103], v[116:119], a[108:111], v[100:103]
    ds_read_b64_tr_b16 v[116:117], v2 offset:37664
    v_mfma_f32_16x16x32_bf16 v[48:51], v[120:123], a[112:115], v[48:51]
    ds_read_b64_tr_b16 v[118:119], v2 offset:38176
    v_mfma_f32_16x16x32_bf16 v[52:55], v[120:123], a[116:119], v[52:55]
    ds_read_b64_tr_b16 v[120:121], v3 offset:37632
    s_waitcnt lgkmcnt(3)
    v_mfma_f32_16x16x32_bf16 v[56:59], v[124:127], a[112:115], v[56:59]
    ds_read_b64_tr_b16 v[122:123], v3 offset:37888
    v_mfma_f32_16x16x32_bf16 v[60:63], v[124:127], a[116:119], v[60:63]
    ds_read_b64_tr_b16 v[124:125], v3 offset:37664
    v_mfma_f32_16x16x32_bf16 v[64:67], v[108:111], a[112:115], v[64:67]
    ds_read_b64_tr_b16 v[126:127], v3 offset:37920
    v_mfma_f32_16x16x32_bf16 v[68:71], v[108:111], a[116:119], v[68:71]
    ds_read_b128 a[120:123], v45 offset:49152
    ds_read_b128 a[124:127], v45 offset:51200
    v_mfma_f32_16x16x32_bf16 v[72:75], v[112:115], a[112:115], v[72:75]
    ds_read_b128 v[108:111], v46 offset:960
    v_mfma_f32_16x16x32_bf16 v[76:79], v[112:115], a[116:119], v[76:79]
    ds_read_b64_tr_b16 v[112:113], v1 offset:41792
    s_waitcnt lgkmcnt(4)
    v_mfma_f32_16x16x32_bf16 v[80:83], v[116:119], a[112:115], v[80:83]
    ds_read_b64_tr_b16 v[114:115], v1 offset:42304
    v_mfma_f32_16x16x32_bf16 v[84:87], v[116:119], a[116:119], v[84:87]
    ds_read_b64_tr_b16 v[116:117], v1 offset:41824
    v_mfma_f32_16x16x32_bf16 v[88:91], v[120:123], a[112:115], v[88:91]
    ds_read_b64_tr_b16 v[118:119], v1 offset:42336
    v_mfma_f32_16x16x32_bf16 v[92:95], v[120:123], a[116:119], v[92:95]
    ds_read_b64_tr_b16 v[120:121], v2 offset:41792
    v_mfma_f32_16x16x32_bf16 v[96:99], v[124:127], a[112:115], v[96:99]
    ds_read_b64_tr_b16 v[122:123], v2 offset:42304
    v_mfma_f32_16x16x32_bf16 v[100:103], v[124:127], a[116:119], v[100:103]
    ds_read_b32 v107, v106 offset:160
    ds_read_b64_tr_b16 v[124:125], v2 offset:41824
    s_waitcnt lgkmcnt(4)
    v_mfma_f32_16x16x32_bf16 v[48:51], v[108:111], a[120:123], v[48:51]
    ds_read_b64_tr_b16 v[126:127], v2 offset:42336
    v_mfma_f32_16x16x32_bf16 v[52:55], v[108:111], a[124:127], v[52:55]
    ds_read_b64_tr_b16 v[108:109], v3 offset:39744
    v_mfma_f32_16x16x32_bf16 v[56:59], v[112:115], a[120:123], v[56:59]
    ds_read_b64_tr_b16 v[110:111], v3 offset:40000
    v_mfma_f32_16x16x32_bf16 v[60:63], v[112:115], a[124:127], v[60:63]
    ds_read_b64_tr_b16 v[112:113], v3 offset:39776
    v_mfma_f32_16x16x32_bf16 v[64:67], v[116:119], a[120:123], v[64:67]
    ds_read_b64_tr_b16 v[114:115], v3 offset:40032
    s_waitcnt lgkmcnt(6)
    v_cmp_ne_u32 vcc, 0, v107
    v_mfma_f32_16x16x32_bf16 v[68:71], v[116:119], a[124:127], v[68:71]
    s_cbranch_vccz L_gated_mix__sliding_block__swiglu_ffn__prompt_kernel_c_14b
L_gated_mix__sliding_block__swiglu_ffn__prompt_kernel_c_14l:
    ds_read_b32 v107, v106 offset:160
    s_add_u32 s101, s101, 1
    s_cmp_gt_u32 s101, s42
    s_cbranch_scc1 L_gated_mix__sliding_block__swiglu_ffn__prompt_kernel_c_14b
    s_waitcnt lgkmcnt(0)
    v_cmp_ne_u32 vcc, 0, v107
    s_nop 0
    s_cbranch_vccnz L_gated_mix__sliding_block__swiglu_ffn__prompt_kernel_c_14l
L_gated_mix__sliding_block__swiglu_ffn__prompt_kernel_c_14b:
    ds_read_b64_tr_b16 v[116:117], v6 offset:0
    s_waitcnt lgkmcnt(3)
    v_mfma_f32_16x16x32_bf16 v[72:75], v[120:123], a[120:123], v[72:75]
    ds_read_b64_tr_b16 v[118:119], v6 offset:768
    v_mfma_f32_16x16x32_bf16 v[76:79], v[120:123], a[124:127], v[76:79]
    ds_read_b64_tr_b16 v[120:121], v6 offset:64
    v_mfma_f32_16x16x32_bf16 v[80:83], v[124:127], a[120:123], v[80:83]
    ds_read_b64_tr_b16 v[122:123], v6 offset:832
    v_mul_f32 v4, 0x3fb8aa3b, v48
    v_mfma_f32_16x16x32_bf16 v[84:87], v[124:127], a[124:127], v[84:87]
    ds_read_b64_tr_b16 v[124:125], v6 offset:128
    v_mul_f32 v105, 0x3fb8aa3b, v52
    v_mfma_f32_16x16x32_bf16 v[88:91], v[108:111], a[120:123], v[88:91]
    ds_read_b64_tr_b16 v[126:127], v6 offset:896
    v_mfma_f32_16x16x32_bf16 v[92:95], v[108:111], a[124:127], v[92:95]
    ds_read_b64_tr_b16 v[108:109], v6 offset:32
    s_waitcnt vmcnt(0)
    v_readfirstlane_b32 s100, v47
    s_nop 0
    s_cmp_eq_u32 s100, 0
    s_cbranch_scc1 L_gated_mix__sliding_block__swiglu_ffn__prompt_kernel_non_15
L_gated_mix__sliding_block__swiglu_ffn__prompt_kernel_non_15b:
    s_waitcnt lgkmcnt(3)
    v_mfma_f32_16x16x32_bf16 v[96:99], v[112:115], a[120:123], v[96:99]
    ds_read_b64_tr_b16 v[110:111], v6 offset:800
    v_mfma_f32_16x16x32_bf16 v[100:103], v[112:115], a[124:127], v[100:103]
    ds_read_b64_tr_b16 v[112:113], v6 offset:96
    v_mfma_f32_16x16x32_bf16 v[8:11], v[116:119], a[0:3], 0
    ds_read_b64_tr_b16 v[114:115], v6 offset:864
    v_mfma_f32_16x16x32_bf16 v[16:19], v[116:119], a[4:7], 0
    ds_read_b64_tr_b16 v[116:117], v6 offset:160
    v_mfma_f32_16x16x32_bf16 v[24:27], v[120:123], a[0:3], 0
    ds_read_b64_tr_b16 v[118:119], v6 offset:928
    v_exp_f32 v4, v4
    v_mfma_f32_16x16x32_bf16 v[32:35], v[120:123], a[4:7], 0
    ds_read_b64_tr_b16 v[120:121], v6 offset:6208
    v_exp_f32 v105, v105
    s_waitcnt lgkmcnt(3)
    v_mfma_f32_16x16x32_bf16 v[40:43], v[124:127], a[0:3], 0
    ds_read_b64_tr_b16 v[122:123], v6 offset:6976
    v_add_f32 v4, 1.0, v4
    v_mfma_f32_16x16x32_bf16 v[48:51], v[124:127], a[4:7], 0
    s_barrier
    ds_read_b64_tr_b16 v[124:125], v6 offset:6272
    v_add_f32 v105, 1.0, v105
    v_mfma_f32_16x16x32_bf16 v[12:15], v[108:111], a[0:3], 0
    ds_read_b64_tr_b16 v[126:127], v6 offset:7040
    v_min_f32 v4, 0x7149f2ca, v4
    v_mfma_f32_16x16x32_bf16 v[20:23], v[108:111], a[4:7], 0
    ds_read_b64_tr_b16 v[108:109], v6 offset:6336
    v_min_f32 v105, 0x7149f2ca, v105
    v_mfma_f32_16x16x32_bf16 v[28:31], v[112:115], a[0:3], 0
    ds_read_b64_tr_b16 v[110:111], v6 offset:7104
    s_mov_b32 s0, 0xffff
    s_mov_b32 s1, 0xffff
    v_cndmask_b32 v104, v105, v4, s[0:1]
    v_mfma_f32_16x16x32_bf16 v[36:39], v[112:115], a[4:7], 0
    ds_read_b32 v107, v106 offset:176
    ds_read_b64_tr_b16 v[112:113], v6 offset:6240
    v_rcp_f32 v104, v104
    s_waitcnt lgkmcnt(4)
    v_mfma_f32_16x16x32_bf16 v[44:47], v[116:119], a[0:3], 0
    ds_read_b64_tr_b16 v[114:115], v6 offset:7008
    v_lshlrev_b32 v1, 4, v0
    v_mfma_f32_16x16x32_bf16 v[52:55], v[116:119], a[4:7], 0
    ds_read_b64_tr_b16 v[116:117], v6 offset:6304
    v_sub_f32 v104, 1.0, v104
    v_mfma_f32_16x16x32_bf16 v[8:11], v[120:123], a[8:11], v[8:11]
    ds_read_b64_tr_b16 v[118:119], v6 offset:7072
    v_lshl_add_u32 v2, v0, 2, s57
    v_mfma_f32_16x16x32_bf16 v[16:19], v[120:123], a[12:15], v[16:19]
    ds_read_b64_tr_b16 v[120:121], v6 offset:6368
    v_add_u32 v3, s54, v1
    v_mfma_f32_16x16x32_bf16 v[24:27], v[124:127], a[8:11], v[24:27]
    ds_read_b64_tr_b16 v[122:123], v6 offset:7136
    s_waitcnt lgkmcnt(6)
    v_cmp_ne_u32 vcc, 0, v107
    v_cvt_pk_bf16_f32 v56, v56, v57
    v_mfma_f32_16x16x32_bf16 v[32:35], v[124:127], a[12:15], v[32:35]
    s_cbranch_vccnz L_gated_mix__sliding_block__swiglu_ffn__prompt_kernel_c_16l
L_gated_mix__sliding_block__swiglu_ffn__prompt_kernel_c_16b:
    ds_read_b64_tr_b16 v[124:125], v6 offset:12544
    v_cvt_pk_bf16_f32 v57, v58, v59
    s_waitcnt lgkmcnt(3)
    v_mfma_f32_16x16x32_bf16 v[40:43], v[108:111], a[8:11], v[40:43]
    ds_read_b64_tr_b16 v[126:127], v6 offset:13312
    v_cvt_pk_bf16_f32 v58, v60, v61
    v_mfma_f32_16x16x32_bf16 v[48:51], v[108:111], a[12:15], v[48:51]
    ds_read_b64_tr_b16 v[108:109], v6 offset:12608
    v_cvt_pk_bf16_f32 v59, v62, v63
    v_mfma_f32_16x16x32_bf16 v[12:15], v[112:115], a[8:11], v[12:15]
    ds_read_b64_tr_b16 v[110:111], v6 offset:13376
    v_permlane16_swap_b32 v56, v58
    v_mfma_f32_16x16x32_bf16 v[20:23], v[112:115], a[12:15], v[20:23]
    ds_read_b64_tr_b16 v[112:113], v6 offset:12672
    v_permlane16_swap_b32 v57, v59
    v_mfma_f32_16x16x32_bf16 v[28:31], v[116:119], a[8:11], v[28:31]
    ds_read_b64_tr_b16 v[114:115], v6 offset:13440
    v_cvt_pk_bf16_f32 v64, v64, v65
    v_mfma_f32_16x16x32_bf16 v[36:39], v[116:119], a[12:15], v[36:39]
    ds_read_b64_tr_b16 v[116:117], v6 offset:12576
    v_cvt_pk_bf16_f32 v65, v66, v67
    s_waitcnt lgkmcnt(3)
    v_mfma_f32_16x16x32_bf16 v[44:47], v[120:123], a[8:11], v[44:47]
    ds_read_b64_tr_b16 v[118:119], v6 offset:13344
    v_cvt_pk_bf16_f32 v66, v68, v69
    v_mfma_f32_16x16x32_bf16 v[52:55], v[120:123], a[12:15], v[52:55]
    ds_read_b64_tr_b16 v[120:121], v6 offset:12640
    v_cvt_pk_bf16_f32 v67, v70, v71
    v_mfma_f32_16x16x32_bf16 v[8:11], v[124:127], a[16:19], v[8:11]
    ds_read_b64_tr_b16 v[122:123], v6 offset:13408
    v_permlane16_swap_b32 v64, v66
    v_mfma_f32_16x16x32_bf16 v[16:19], v[124:127], a[20:23], v[16:19]
    ds_read_b64_tr_b16 v[124:125], v6 offset:12704
    v_permlane16_swap_b32 v65, v67
    v_mfma_f32_16x16x32_bf16 v[24:27], v[108:111], a[16:19], v[24:27]
    ds_read_b64_tr_b16 v[126:127], v6 offset:13472
    v_cvt_pk_bf16_f32 v72, v72, v73
    v_mfma_f32_16x16x32_bf16 v[32:35], v[108:111], a[20:23], v[32:35]
    ds_read_b64_tr_b16 v[108:109], v6 offset:18752
    v_cvt_pk_bf16_f32 v73, v74, v75
    s_waitcnt lgkmcnt(3)
    v_mfma_f32_16x16x32_bf16 v[40:43], v[112:115], a[16:19], v[40:43]
    ds_read_b64_tr_b16 v[110:111], v6 offset:19520
    v_cvt_pk_bf16_f32 v74, v76, v77
    v_mfma_f32_16x16x32_bf16 v[48:51], v[112:115], a[20:23], v[48:51]
    ds_read_b64_tr_b16 v[112:113], v6 offset:18816
    v_cvt_pk_bf16_f32 v75, v78, v79
    v_mfma_f32_16x16x32_bf16 v[12:15], v[116:119], a[16:19], v[12:15]
    ds_read_b64_tr_b16 v[114:115], v6 offset:19584
    v_permlane16_swap_b32 v72, v74
    v_mfma_f32_16x16x32_bf16 v[20:23], v[116:119], a[20:23], v[20:23]
    ds_read_b64_tr_b16 v[116:117], v6 offset:18880
    v_permlane16_swap_b32 v73, v75
    v_mfma_f32_16x16x32_bf16 v[28:31], v[120:123], a[16:19], v[28:31]
    ds_read_b64_tr_b16 v[118:119], v6 offset:19648
    v_cvt_pk_bf16_f32 v80, v80, v81
    v_mfma_f32_16x16x32_bf16 v[36:39], v[120:123], a[20:23], v[36:39]
    ds_read_b32 v107, v106 offset:192
    ds_read_b64_tr_b16 v[120:121], v6 offset:18784
    v_cvt_pk_bf16_f32 v81, v82, v83
    s_waitcnt lgkmcnt(4)
    v_mfma_f32_16x16x32_bf16 v[44:47], v[124:127], a[16:19], v[44:47]
    ds_read_b64_tr_b16 v[122:123], v6 offset:19552
    v_cvt_pk_bf16_f32 v82, v84, v85
    v_mfma_f32_16x16x32_bf16 v[52:55], v[124:127], a[20:23], v[52:55]
    ds_read_b64_tr_b16 v[124:125], v6 offset:18848
    v_cvt_pk_bf16_f32 v83, v86, v87
    v_mfma_f32_16x16x32_bf16 v[8:11], v[108:111], a[24:27], v[8:11]
    ds_read_b64_tr_b16 v[126:127], v6 offset:19616
    v_permlane16_swap_b32 v80, v82
    v_mfma_f32_16x16x32_bf16 v[16:19], v[108:111], a[28:31], v[16:19]
    ds_read_b64_tr_b16 v[108:109], v6 offset:18912
    v_permlane16_swap_b32 v81, v83
    v_mfma_f32_16x16x32_bf16 v[24:27], v[112:115], a[24:27], v[24:27]
    ds_read_b64_tr_b16 v[110:111], v6 offset:19680
    s_waitcnt lgkmcnt(6)
    v_cmp_ne_u32 vcc, 0, v107
    v_mul_f32 v88, 0x3eb8aa3b, v88
    v_mfma_f32_16x16x32_bf16 v[32:35], v[112:115], a[28:31], v[32:35]
    s_cbranch_vccnz L_gated_mix__sliding_block__swiglu_ffn__prompt_kernel_c_17l
L_gated_mix__sliding_block__swiglu_ffn__prompt_kernel_c_17b:
    ds_read_b64_tr_b16 v[112:113], v6 offset:25088
    v_mul_f32 v89, 0x3eb8aa3b, v89
    s_waitcnt lgkmcnt(3)
    v_mfma_f32_16x16x32_bf16 v[40:43], v[116:119], a[24:27], v[40:43]
    ds_read_b64_tr_b16 v[114:115], v6 offset:25856
    v_mul_f32 v90, 0x3eb8aa3b, v90
    v_mfma_f32_16x16x32_bf16 v[48:51], v[116:119], a[28:31], v[48:51]
    ds_read_b64_tr_b16 v[116:117], v6 offset:25152
    v_mul_f32 v91, 0x3eb8aa3b, v91
    v_mfma_f32_16x16x32_bf16 v[12:15], v[120:123], a[24:27], v[12:15]
    ds_read_b64_tr_b16 v[118:119], v6 offset:25920
    v_mul_f32 v92, 0x3eb8aa3b, v92
    v_mfma_f32_16x16x32_bf16 v[20:23], v[120:123], a[28:31], v[20:23]
    ds_read_b64_tr_b16 v[120:121], v6 offset:25216
    v_mul_f32 v93, 0x3eb8aa3b, v93
    v_mfma_f32_16x16x32_bf16 v[28:31], v[124:127], a[24:27], v[28:31]
    ds_read_b64_tr_b16 v[122:123], v6 offset:25984
    v_mul_f32 v94, 0x3eb8aa3b, v94
    v_mfma_f32_16x16x32_bf16 v[36:39], v[124:127], a[28:31], v[36:39]
    ds_read_b64_tr_b16 v[124:125], v6 offset:25120
    v_mul_f32 v95, 0x3eb8aa3b, v95
    s_waitcnt lgkmcnt(3)
    v_mfma_f32_16x16x32_bf16 v[44:47], v[108:111], a[24:27], v[44:47]
    ds_read_b64_tr_b16 v[126:127], v6 offset:25888
    v_cvt_pk_bf16_f32 v88, v88, v89
    v_mfma_f32_16x16x32_bf16 v[52:55], v[108:111], a[28:31], v[52:55]
    ds_read_b64_tr_b16 v[108:109], v6 offset:25184
    v_cvt_pk_bf16_f32 v89, v90, v91
    v_mfma_f32_16x16x32_bf16 v[8:11], v[112:115], a[32:35], v[8:11]
    ds_read_b64_tr_b16 v[110:111], v6 offset:25952
    v_cvt_pk_bf16_f32 v90, v92, v93
    v_mfma_f32_16x16x32_bf16 v[16:19], v[112:115], a[36:39], v[16:19]
    ds_read_b64_tr_b16 v[112:113], v6 offset:25248
    v_cvt_pk_bf16_f32 v91, v94, v95
    v_mfma_f32_16x16x32_bf16 v[24:27], v[116:119], a[32:35], v[24:27]
    ds_read_b64_tr_b16 v[114:115], v6 offset:26016
    v_permlane16_swap_b32 v88, v90
    v_mfma_f32_16x16x32_bf16 v[32:35], v[116:119], a[36:39], v[32:35]
    ds_read_b64_tr_b16 v[116:117], v6 offset:31296
    v_permlane16_swap_b32 v89, v91
    s_waitcnt lgkmcnt(3)
    v_mfma_f32_16x16x32_bf16 v[40:43], v[120:123], a[32:35], v[40:43]
    ds_read_b64_tr_b16 v[118:119], v6 offset:32064
    v_mul_f32 v96, 0x3eb8aa3b, v96
    v_mfma_f32_16x16x32_bf16 v[48:51], v[120:123], a[36:39], v[48:51]
    ds_read_b64_tr_b16 v[120:121], v6 offset:31360
    v_mul_f32 v97, 0x3eb8aa3b, v97
    v_mfma_f32_16x16x32_bf16 v[12:15], v[124:127], a[32:35], v[12:15]
    ds_read_b64_tr_b16 v[122:123], v6 offset:32128
    v_mul_f32 v98, 0x3eb8aa3b, v98
    v_mfma_f32_16x16x32_bf16 v[20:23], v[124:127], a[36:39], v[20:23]
    ds_read_b64_tr_b16 v[124:125], v6 offset:31424
    v_mul_f32 v99, 0x3eb8aa3b, v99
    v_mfma_f32_16x16x32_bf16 v[28:31], v[108:111], a[32:35], v[28:31]
    ds_read_b64_tr_b16 v[126:127], v6 offset:32192
    v_mul_f32 v100, 0x3eb8aa3b, v100
    v_mfma_f32_16x16x32_bf16 v[36:39], v[108:111], a[36:39], v[36:39]
    ds_read_b64_tr_b16 v[108:109], v6 offset:31328
    v_mul_f32 v101, 0x3eb8aa3b, v101
    s_waitcnt lgkmcnt(3)
    v_mfma_f32_16x16x32_bf16 v[44:47], v[112:115], a[32:35], v[44:47]
    ds_read_b64_tr_b16 v[110:111], v6 offset:32096
    v_mul_f32 v102, 0x3eb8aa3b, v102
    v_mfma_f32_16x16x32_bf16 v[52:55], v[112:115], a[36:39], v[52:55]
    ds_read_b64_tr_b16 v[112:113], v6 offset:31392
    v_mul_f32 v103, 0x3eb8aa3b, v103
    v_mfma_f32_16x16x32_bf16 v[8:11], v[116:119], a[40:43], v[8:11]
    ds_read_b64_tr_b16 v[114:115], v6 offset:32160
    v_cvt_pk_bf16_f32 v96, v96, v97
    v_mfma_f32_16x16x32_bf16 v[16:19], v[116:119], a[44:47], v[16:19]
    ds_read_b64_tr_b16 v[116:117], v6 offset:31456
    v_cvt_pk_bf16_f32 v97, v98, v99
    v_mfma_f32_16x16x32_bf16 v[24:27], v[120:123], a[40:43], v[24:27]
    ds_read_b64_tr_b16 v[118:119], v6 offset:32224
    v_cvt_pk_bf16_f32 v98, v100, v101
    v_mfma_f32_16x16x32_bf16 v[32:35], v[120:123], a[44:47], v[32:35]
    ds_read_b64_tr_b16 v[120:121], v5 offset:0
    v_cvt_pk_bf16_f32 v99, v102, v103
    s_waitcnt lgkmcnt(3)
    v_mfma_f32_16x16x32_bf16 v[40:43], v[124:127], a[40:43], v[40:43]
    ds_read_b64_tr_b16 v[122:123], v5 offset:768
    v_permlane16_swap_b32 v96, v98
    v_mfma_f32_16x16x32_bf16 v[48:51], v[124:127], a[44:47], v[48:51]
    ds_read_b64_tr_b16 v[124:125], v5 offset:64
    v_permlane16_swap_b32 v97, v99
    buffer_store_dwordx4 v[56:59], v1, s[32:35], s55 offen sc1
    s_add_u32 s55, s55, 65536
    v_mfma_f32_16x16x32_bf16 v[12:15], v[108:111], a[40:43], v[12:15]
    ds_read_b64_tr_b16 v[126:127], v5 offset:832
    v_mfma_f32_16x16x32_bf16 v[20:23], v[108:111], a[44:47], v[20:23]
    ds_read_b64_tr_b16 v[108:109], v5 offset:128
    buffer_store_dwordx4 v[64:67], v1, s[32:35], s55 offen sc1
    s_add_u32 s55, s55, 65536
    v_mfma_f32_16x16x32_bf16 v[28:31], v[112:115], a[40:43], v[28:31]
    ds_read_b64_tr_b16 v[110:111], v5 offset:896
    v_mfma_f32_16x16x32_bf16 v[36:39], v[112:115], a[44:47], v[36:39]
    ds_read_b64_tr_b16 v[112:113], v5 offset:32
    buffer_store_dwordx4 v[72:75], v1, s[32:35], s55 offen sc1
    s_add_u32 s55, s55, 65536
    s_waitcnt lgkmcnt(3)
    v_mfma_f32_16x16x32_bf16 v[44:47], v[116:119], a[40:43], v[44:47]
    ds_read_b64_tr_b16 v[114:115], v5 offset:800
    v_mfma_f32_16x16x32_bf16 v[52:55], v[116:119], a[44:47], v[52:55]
    ds_read_b64_tr_b16 v[116:117], v5 offset:96
    buffer_store_dwordx4 v[80:83], v1, s[32:35], s55 offen sc1
    v_mfma_f32_16x16x32_bf16 v[8:11], v[120:123], a[48:51], v[8:11]
    ds_read_b64_tr_b16 v[118:119], v5 offset:864
    v_mfma_f32_16x16x32_bf16 v[16:19], v[120:123], a[52:55], v[16:19]
    ds_read_b64_tr_b16 v[120:121], v5 offset:160
    ds_write_b128 v3, v[88:91] offset:0
    v_mfma_f32_16x16x32_bf16 v[24:27], v[124:127], a[48:51], v[24:27]
    ds_read_b64_tr_b16 v[122:123], v5 offset:928
    v_mfma_f32_16x16x32_bf16 v[32:35], v[124:127], a[52:55], v[32:35]
    ds_read_b64_tr_b16 v[124:125], v5 offset:6208
    ds_write_b128 v3, v[96:99] offset:1024
    s_waitcnt lgkmcnt(5)
    v_mfma_f32_16x16x32_bf16 v[40:43], v[108:111], a[48:51], v[40:43]
    ds_read_b64_tr_b16 v[126:127], v5 offset:6976
    v_mfma_f32_16x16x32_bf16 v[48:51], v[108:111], a[52:55], v[48:51]
    ds_read_b64_tr_b16 v[108:109], v5 offset:6272
    ds_write_b32 v2, v104
    s_branch L_q_join
L_q_odd:
    s_waitcnt lgkmcnt(0)
    s_waitcnt vmcnt(7)
    ds_read_b32 v107, v106 offset:0
    s_waitcnt lgkmcnt(0)
    v_cmp_ne_u32 vcc, 0, v107
    s_nop 0
    s_cbranch_vccz L_gated_mix__sliding_block__swiglu_ffn__prompt_kernel_c_18b
L_gated_mix__sliding_block__swiglu_ffn__prompt_kernel_c_18l:
    ds_read_b32 v107, v106 offset:0
    s_add_u32 s101, s101, 1
    s_cmp_gt_u32 s101, s42
    s_cbranch_scc1 L_gated_mix__sliding_block__swiglu_ffn__prompt_kernel_c_18b
    s_waitcnt lgkmcnt(0)
    v_cmp_ne_u32 vcc, 0, v107
    s_nop 0
    s_cbranch_vccnz L_gated_mix__sliding_block__swiglu_ffn__prompt_kernel_c_18l
L_gated_mix__sliding_block__swiglu_ffn__prompt_kernel_c_18b:
    ds_read_b32 v107, v106 offset:16
    s_waitcnt lgkmcnt(0)
    v_cmp_ne_u32 vcc, 0, v107
    s_nop 0
    s_cbranch_vccz L_gated_mix__sliding_block__swiglu_ffn__prompt_kernel_c_19b
L_gated_mix__sliding_block__swiglu_ffn__prompt_kernel_c_19l:
    ds_read_b32 v107, v106 offset:16
    s_add_u32 s101, s101, 1
    s_cmp_gt_u32 s101, s42
    s_cbranch_scc1 L_gated_mix__sliding_block__swiglu_ffn__prompt_kernel_c_19b
    s_waitcnt lgkmcnt(0)
    v_cmp_ne_u32 vcc, 0, v107
    s_nop 0
    s_cbranch_vccnz L_gated_mix__sliding_block__swiglu_ffn__prompt_kernel_c_19l
L_gated_mix__sliding_block__swiglu_ffn__prompt_kernel_c_19b:
    ds_read_b128 a[0:3], v44 offset:0
    ds_read_b128 a[4:7], v44 offset:2048
    ds_read_b128 v[108:111], v46 offset:0
    ds_read_b64_tr_b16 v[112:113], v1 offset:0
    ds_read_b64_tr_b16 v[114:115], v1 offset:512
    ds_read_b64_tr_b16 v[116:117], v1 offset:32
    ds_read_b64_tr_b16 v[118:119], v1 offset:544
    ds_read_b64_tr_b16 v[120:121], v2 offset:0
    ds_read_b64_tr_b16 v[122:123], v2 offset:512
    ds_read_b64_tr_b16 v[124:125], v2 offset:32
    s_waitcnt lgkmcnt(3)
    v_mfma_f32_16x16x32_bf16 v[48:51], v[108:111], a[0:3], 0
    ds_read_b64_tr_b16 v[126:127], v2 offset:544
    s_mov_b32 s18, 1409024
    v_mfma_f32_16x16x32_bf16 v[52:55], v[108:111], a[4:7], 0
    ds_read_b64_tr_b16 v[108:109], v3 offset:0
    s_mov_b32 s19, 0x20000
    v_mfma_f32_16x16x32_bf16 v[56:59], a[0:3], v[112:115], 0
    ds_read_b64_tr_b16 v[110:111], v3 offset:256
    s_mov_b32 s34, 268435456
    v_mfma_f32_16x16x32_bf16 v[64:67], a[4:7], v[112:115], 0
    ds_read_b64_tr_b16 v[112:113], v3 offset:32
    s_mov_b32 s35, 0x20000
    v_mfma_f32_16x16x32_bf16 v[60:63], a[0:3], v[116:119], 0
    ds_read_b64_tr_b16 v[114:115], v3 offset:288
    s_mov_b32 s46, 256
    v_mfma_f32_16x16x32_bf16 v[68:71], a[4:7], v[116:119], 0
    ds_read_b128 a[8:11], v45 offset:0
    ds_read_b128 a[12:15], v45 offset:2048
    s_mov_b32 s47, 0x20000
    s_waitcnt lgkmcnt(4)
    v_mfma_f32_16x16x32_bf16 v[72:75], a[0:3], v[120:123], 0
    ds_read_b128 v[116:119], v46 offset:64
    s_mov_b32 s22, 1409024
    v_mfma_f32_16x16x32_bf16 v[80:83], a[4:7], v[120:123], 0
    ds_read_b64_tr_b16 v[120:121], v1 offset:4160
    s_mov_b32 s23, 0x20000
    v_mfma_f32_16x16x32_bf16 v[76:79], a[0:3], v[124:127], 0
    ds_read_b64_tr_b16 v[122:123], v1 offset:4672
    s_mov_b32 s26, 1409024
    v_mfma_f32_16x16x32_bf16 v[84:87], a[4:7], v[124:127], 0
    ds_read_b64_tr_b16 v[124:125], v1 offset:4192
    s_mov_b32 s27, 0x20000
    v_mfma_f32_16x16x32_bf16 v[88:91], v[108:111], a[0:3], 0
    ds_read_b64_tr_b16 v[126:127], v1 offset:4704
    s_mov_b32 s30, 524288
    v_mfma_f32_16x16x32_bf16 v[92:95], v[108:111], a[4:7], 0
    ds_read_b64_tr_b16 v[108:109], v2 offset:4160
    s_mov_b32 s31, 0x20000
    s_waitcnt lgkmcnt(3)
    v_mfma_f32_16x16x32_bf16 v[96:99], v[112:115], a[0:3], 0
    ds_read_b64_tr_b16 v[110:111], v2 offset:4672
    s_mov_b32 s38, 2097152
    v_mfma_f32_16x16x32_bf16 v[100:103], v[112:115], a[4:7], 0
    ds_read_b32 v107, v106 offset:48
    ds_read_b64_tr_b16 v[112:113], v2 offset:4192
    s_mov_b32 s39, 0x20000
    v_mfma_f32_16x16x32_bf16 v[48:51], v[116:119], a[8:11], v[48:51]
    ds_read_b64_tr_b16 v[114:115], v2 offset:4704
    s_bfe_u32 s53, s2, 0x20001
    v_mfma_f32_16x16x32_bf16 v[52:55], v[116:119], a[12:15], v[52:55]
    ds_read_b64_tr_b16 v[116:117], v3 offset:2112
    s_bfe_u32 s57, s2, 0x30003
    v_mfma_f32_16x16x32_bf16 v[56:59], a[8:11], v[120:123], v[56:59]
    ds_read_b64_tr_b16 v[118:119], v3 offset:2368
    s_lshl3_add_u32 s96, s53, s57
    v_mfma_f32_16x16x32_bf16 v[64:67], a[12:15], v[120:123], v[64:67]
    ds_read_b64_tr_b16 v[120:121], v3 offset:2144
    s_and_b32 s53, s2, 1
    s_waitcnt lgkmcnt(3)
    v_mfma_f32_16x16x32_bf16 v[60:63], a[8:11], v[124:127], v[60:63]
    ds_read_b64_tr_b16 v[122:123], v3 offset:2400
    v_cmp_ne_u32 vcc, 0, v107
    s_lshr_b32 s97, s2, 6
    v_mfma_f32_16x16x32_bf16 v[68:71], a[12:15], v[124:127], v[68:71]
    s_cbranch_vccz L_gated_mix__sliding_block__swiglu_ffn__prompt_kernel_c_20b
L_gated_mix__sliding_block__swiglu_ffn__prompt_kernel_c_20l:
    ds_read_b32 v107, v106 offset:48
    s_add_u32 s101, s101, 1
    s_cmp_gt_u32 s101, s42
    s_cbranch_scc1 L_gated_mix__sliding_block__swiglu_ffn__prompt_kernel_c_20b
    s_waitcnt lgkmcnt(0)
    v_cmp_ne_u32 vcc, 0, v107
    s_nop 0
    s_cbranch_vccnz L_gated_mix__sliding_block__swiglu_ffn__prompt_kernel_c_20l
L_gated_mix__sliding_block__swiglu_ffn__prompt_kernel_c_20b:
    ds_read_b32 v107, v106 offset:32
    s_waitcnt lgkmcnt(0)
    v_cmp_ne_u32 vcc, 0, v107
    s_nop 0
    s_cbranch_vccz L_gated_mix__sliding_block__swiglu_ffn__prompt_kernel_c_21b
L_gated_mix__sliding_block__swiglu_ffn__prompt_kernel_c_21l:
    ds_read_b32 v107, v106 offset:32
    s_add_u32 s101, s101, 1
    s_cmp_gt_u32 s101, s42
    s_cbranch_scc1 L_gated_mix__sliding_block__swiglu_ffn__prompt_kernel_c_21b
    s_waitcnt lgkmcnt(0)
    v_cmp_ne_u32 vcc, 0, v107
    s_nop 0
    s_cbranch_vccnz L_gated_mix__sliding_block__swiglu_ffn__prompt_kernel_c_21l
L_gated_mix__sliding_block__swiglu_ffn__prompt_kernel_c_21b:
    ds_read_b128 a[16:19], v44 offset:16384
    ds_read_b128 a[20:23], v44 offset:18432
    s_lshl2_add_u32 s97, s53, s97
    v_mfma_f32_16x16x32_bf16 v[72:75], a[8:11], v[108:111], v[72:75]
    ds_read_b128 v[124:127], v46 offset:128
    s_lshr_b32 s55, s50, 2
    v_mfma_f32_16x16x32_bf16 v[80:83], a[12:15], v[108:111], v[80:83]
    ds_read_b64_tr_b16 v[108:109], v1 offset:12544
    s_and_b32 s56, s50, 3
    v_mfma_f32_16x16x32_bf16 v[76:79], a[8:11], v[112:115], v[76:79]
    ds_read_b64_tr_b16 v[110:111], v1 offset:13056
    s_mul_i32 s55, s55, 11
    v_mfma_f32_16x16x32_bf16 v[84:87], a[12:15], v[112:115], v[84:87]
    ds_read_b64_tr_b16 v[112:113], v1 offset:12576
    s_mul_i32 s56, s56, 3
    s_waitcnt lgkmcnt(3)
    v_mfma_f32_16x16x32_bf16 v[88:91], v[116:119], a[8:11], v[88:91]
    ds_read_b64_tr_b16 v[114:115], v1 offset:13088
    s_add_u32 s62, s55, s56
    v_mfma_f32_16x16x32_bf16 v[92:95], v[116:119], a[12:15], v[92:95]
    ds_read_b64_tr_b16 v[116:117], v2 offset:12544
    s_sub_u32 s63, 11, s56
    v_mfma_f32_16x16x32_bf16 v[96:99], v[120:123], a[8:11], v[96:99]
    ds_read_b64_tr_b16 v[118:119], v2 offset:13056
    s_min_u32 s63, s63, 3
    v_mfma_f32_16x16x32_bf16 v[100:103], v[120:123], a[12:15], v[100:103]
    ds_read_b64_tr_b16 v[120:121], v2 offset:12576
    s_sub_u32 s55, 43, s62
    v_mfma_f32_16x16x32_bf16 v[48:51], v[124:127], a[16:19], v[48:51]
    ds_read_b64_tr_b16 v[122:123], v2 offset:13088
    s_min_u32 s63, s63, s55
    v_mfma_f32_16x16x32_bf16 v[52:55], v[124:127], a[20:23], v[52:55]
    ds_read_b64_tr_b16 v[124:125], v3 offset:12544
    s_mul_i32 s4, s52, 3104
    s_waitcnt lgkmcnt(3)
    v_mfma_f32_16x16x32_bf16 v[56:59], a[16:19], v[108:111], v[56:59]
    ds_read_b64_tr_b16 v[126:127], v3 offset:12800
    s_lshl2_add_u32 s7, s49, s52
    v_mfma_f32_16x16x32_bf16 v[64:67], a[20:23], v[108:111], v[64:67]
    ds_read_b64_tr_b16 v[108:109], v3 offset:12576
    v_mul_u32_u24 v40, 3104, v40
    v_mfma_f32_16x16x32_bf16 v[60:63], a[16:19], v[112:115], v[60:63]
    ds_read_b64_tr_b16 v[110:111], v3 offset:12832
    s_and_b32 s55, s62, 1
    v_mfma_f32_16x16x32_bf16 v[68:71], a[20:23], v[112:115], v[68:71]
    ds_read_b128 a[24:27], v45 offset:16384
    ds_read_b128 a[28:31], v45 offset:18432
    v_xor_b32 v41, s55, v41
    v_mfma_f32_16x16x32_bf16 v[72:75], a[16:19], v[116:119], v[72:75]
    ds_read_b128 v[112:115], v46 offset:192
    v_mul_u32_u24 v41, 192, v41
    v_mfma_f32_16x16x32_bf16 v[80:83], a[20:23], v[116:119], v[80:83]
    ds_read_b64_tr_b16 v[116:117], v1 offset:16704
    v_add3_u32 v7, v40, v41, v42
    s_waitcnt lgkmcnt(4)
    v_mfma_f32_16x16x32_bf16 v[76:79], a[16:19], v[120:123], v[76:79]
    ds_read_b64_tr_b16 v[118:119], v1 offset:17216
    v_add_u32 v5, 65536, v7
    v_mfma_f32_16x16x32_bf16 v[84:87], a[20:23], v[120:123], v[84:87]
    ds_read_b64_tr_b16 v[120:121], v1 offset:16736
    v_add_u32 v6, 115712, v7
    v_mfma_f32_16x16x32_bf16 v[88:91], v[124:127], a[16:19], v[88:91]
    ds_read_b64_tr_b16 v[122:123], v1 offset:17248
    s_lshr_b32 s55, s50, 1
    v_mfma_f32_16x16x32_bf16 v[92:95], v[124:127], a[20:23], v[92:95]
    ds_read_b64_tr_b16 v[124:125], v2 offset:16704
    s_lshl_b32 s55, s55, 18
    v_mfma_f32_16x16x32_bf16 v[96:99], v[108:111], a[16:19], v[96:99]
    ds_read_b64_tr_b16 v[126:127], v2 offset:17216
    s_lshl_b32 s56, s7, 10
    v_mfma_f32_16x16x32_bf16 v[100:103], v[108:111], a[20:23], v[100:103]
    ds_read_b32 v107, v106 offset:64
    ds_read_b64_tr_b16 v[108:109], v2 offset:16736
    s_add_u32 s55, s55, s56
    s_waitcnt lgkmcnt(4)
    v_mfma_f32_16x16x32_bf16 v[48:51], v[112:115], a[24:27], v[48:51]
    ds_read_b64_tr_b16 v[110:111], v2 offset:17248
    s_add_u32 s53, s55, s56
    v_mfma_f32_16x16x32_bf16 v[52:55], v[112:115], a[28:31], v[52:55]
    s_barrier
    ds_read_b64_tr_b16 v[112:113], v3 offset:14656
    s_add_u32 s55, s55, 10485760
    v_mfma_f32_16x16x32_bf16 v[56:59], a[24:27], v[116:119], v[56:59]
    ds_read_b64_tr_b16 v[114:115], v3 offset:14912
    s_add_u32 s53, s53, 12582912
    v_mfma_f32_16x16x32_bf16 v[64:67], a[28:31], v[116:119], v[64:67]
    ds_read_b64_tr_b16 v[116:117], v3 offset:14688
    s_lshl_b32 s61, s50, 6
    v_mfma_f32_16x16x32_bf16 v[60:63], a[24:27], v[120:123], v[60:63]
    ds_read_b64_tr_b16 v[118:119], v3 offset:14944
    s_waitcnt lgkmcnt(6)
    v_cmp_ne_u32 vcc, 0, v107
    s_add_u32 s61, s61, s7
    v_mfma_f32_16x16x32_bf16 v[68:71], a[28:31], v[120:123], v[68:71]
    s_cbranch_vccz L_gated_mix__sliding_block__swiglu_ffn__prompt_kernel_c_22b
L_gated_mix__sliding_block__swiglu_ffn__prompt_kernel_c_22l:
    ds_read_b32 v107, v106 offset:64
    s_add_u32 s101, s101, 1
    s_cmp_gt_u32 s101, s42
    s_cbranch_scc1 L_gated_mix__sliding_block__swiglu_ffn__prompt_kernel_c_22b
    s_waitcnt lgkmcnt(0)
    v_cmp_ne_u32 vcc, 0, v107
    s_nop 0
    s_cbranch_vccnz L_gated_mix__sliding_block__swiglu_ffn__prompt_kernel_c_22l
L_gated_mix__sliding_block__swiglu_ffn__prompt_kernel_c_22b:
    ds_read_b128 a[32:35], v44 offset:32768
    ds_read_b128 a[36:39], v44 offset:34816
    s_lshl_b32 s61, s61, 7
    s_waitcnt lgkmcnt(4)
    v_mfma_f32_16x16x32_bf16 v[72:75], a[24:27], v[124:127], v[72:75]
    ds_read_b128 v[120:123], v46 offset:256
    s_add_u32 s61, s61, 14680064
    v_mfma_f32_16x16x32_bf16 v[80:83], a[28:31], v[124:127], v[80:83]
    ds_read_b64_tr_b16 v[124:125], v1 offset:25088
    s_lshl_b32 s54, s52, 11
    v_mfma_f32_16x16x32_bf16 v[76:79], a[24:27], v[108:111], v[76:79]
    ds_read_b64_tr_b16 v[126:127], v1 offset:25600
    s_add_u32 s54, s54, 154368
    v_mfma_f32_16x16x32_bf16 v[84:87], a[28:31], v[108:111], v[84:87]
    ds_read_b64_tr_b16 v[108:109], v1 offset:25120
    s_lshl_b32 s57, s52, 8
    v_mfma_f32_16x16x32_bf16 v[88:91], v[112:115], a[24:27], v[88:91]
    ds_read_b64_tr_b16 v[110:111], v1 offset:25632
    s_add_u32 s57, s57, 162560
    v_mfma_f32_16x16x32_bf16 v[92:95], v[112:115], a[28:31], v[92:95]
    ds_read_b64_tr_b16 v[112:113], v2 offset:25088
    s_mul_i32 s60, s7, 120832
    s_waitcnt lgkmcnt(3)
    v_mfma_f32_16x16x32_bf16 v[96:99], v[116:119], a[24:27], v[96:99]
    ds_read_b64_tr_b16 v[114:115], v2 offset:25600
    s_lshl_b32 s56, s62, 11
    v_mfma_f32_16x16x32_bf16 v[100:103], v[116:119], a[28:31], v[100:103]
    ds_read_b64_tr_b16 v[116:117], v2 offset:25120
    s_add_u32 s60, s60, s56
    v_mfma_f32_16x16x32_bf16 v[48:51], v[120:123], a[32:35], v[48:51]
    ds_read_b64_tr_b16 v[118:119], v2 offset:25632
    s_add_u32 s60, s60, 0
    v_mfma_f32_16x16x32_bf16 v[52:55], v[120:123], a[36:39], v[52:55]
    ds_read_b64_tr_b16 v[120:121], v3 offset:25088
    s_lshl_b32 s59, s7, 4
    v_mfma_f32_16x16x32_bf16 v[56:59], a[32:35], v[124:127], v[56:59]
    ds_read_b64_tr_b16 v[122:123], v3 offset:25344
    s_add_u32 s59, s59, s50
    v_mfma_f32_16x16x32_bf16 v[64:67], a[36:39], v[124:127], v[64:67]
    ds_read_b64_tr_b16 v[124:125], v3 offset:25120
    s_lshl_b32 s59, s59, 8
    s_waitcnt lgkmcnt(3)
    v_mfma_f32_16x16x32_bf16 v[60:63], a[32:35], v[108:111], v[60:63]
    ds_read_b64_tr_b16 v[126:127], v3 offset:25376
    s_add_u32 s59, s59, 14811136
    v_mfma_f32_16x16x32_bf16 v[68:71], a[36:39], v[108:111], v[68:71]
    ds_read_b128 a[40:43], v45 offset:32768
    ds_read_b128 a[44:47], v45 offset:34816
    s_mov_b32 s58, 0xbfb8aa3b
    v_mfma_f32_16x16x32_bf16 v[72:75], a[32:35], v[112:115], v[72:75]
    ds_read_b128 v[108:111], v46 offset:320
    v_mfma_f32_16x16x32_bf16 v[80:83], a[36:39], v[112:115], v[80:83]
    ds_read_b64_tr_b16 v[112:113], v1 offset:29248
    v_mfma_f32_16x16x32_bf16 v[76:79], a[32:35], v[116:119], v[76:79]
    ds_read_b64_tr_b16 v[114:115], v1 offset:29760
    v_mfma_f32_16x16x32_bf16 v[84:87], a[36:39], v[116:119], v[84:87]
    ds_read_b64_tr_b16 v[116:117], v1 offset:29280
    s_waitcnt lgkmcnt(3)
    v_mfma_f32_16x16x32_bf16 v[88:91], v[120:123], a[32:35], v[88:91]
    ds_read_b64_tr_b16 v[118:119], v1 offset:29792
    v_mfma_f32_16x16x32_bf16 v[92:95], v[120:123], a[36:39], v[92:95]
    ds_read_b64_tr_b16 v[120:121], v2 offset:29248
    v_mfma_f32_16x16x32_bf16 v[96:99], v[124:127], a[32:35], v[96:99]
    ds_read_b64_tr_b16 v[122:123], v2 offset:29760
    v_mfma_f32_16x16x32_bf16 v[100:103], v[124:127], a[36:39], v[100:103]
    ds_read_b32 v107, v106 offset:80
    ds_read_b64_tr_b16 v[124:125], v2 offset:29280
    v_mfma_f32_16x16x32_bf16 v[48:51], v[108:111], a[40:43], v[48:51]
    ds_read_b64_tr_b16 v[126:127], v2 offset:29792
    v_mfma_f32_16x16x32_bf16 v[52:55], v[108:111], a[44:47], v[52:55]
    s_barrier
    ds_read_b64_tr_b16 v[108:109], v3 offset:27200
    s_waitcnt lgkmcnt(4)
    v_mfma_f32_16x16x32_bf16 v[56:59], a[40:43], v[112:115], v[56:59]
    ds_read_b64_tr_b16 v[110:111], v3 offset:27456
    v_mfma_f32_16x16x32_bf16 v[64:67], a[44:47], v[112:115], v[64:67]
    ds_read_b64_tr_b16 v[112:113], v3 offset:27232
    v_mfma_f32_16x16x32_bf16 v[60:63], a[40:43], v[116:119], v[60:63]
    ds_read_b64_tr_b16 v[114:115], v3 offset:27488
    s_waitcnt lgkmcnt(6)
    v_cmp_ne_u32 vcc, 0, v107
    v_mfma_f32_16x16x32_bf16 v[68:71], a[44:47], v[116:119], v[68:71]
    s_cbranch_vccz L_gated_mix__sliding_block__swiglu_ffn__prompt_kernel_c_23b
L_gated_mix__sliding_block__swiglu_ffn__prompt_kernel_c_23l:
    ds_read_b32 v107, v106 offset:80
    s_add_u32 s101, s101, 1
    s_cmp_gt_u32 s101, s42
    s_cbranch_scc1 L_gated_mix__sliding_block__swiglu_ffn__prompt_kernel_c_23b
    s_waitcnt lgkmcnt(0)
    v_cmp_ne_u32 vcc, 0, v107
    s_nop 0
    s_cbranch_vccnz L_gated_mix__sliding_block__swiglu_ffn__prompt_kernel_c_23l
L_gated_mix__sliding_block__swiglu_ffn__prompt_kernel_c_23b:
    ds_read_b128 a[48:51], v44 offset:49152
    ds_read_b128 a[52:55], v44 offset:51200
    v_mfma_f32_16x16x32_bf16 v[72:75], a[40:43], v[120:123], v[72:75]
    ds_read_b128 v[116:119], v46 offset:384
    v_mfma_f32_16x16x32_bf16 v[80:83], a[44:47], v[120:123], v[80:83]
    ds_read_b64_tr_b16 v[120:121], v1 offset:37632
    s_waitcnt lgkmcnt(4)
    v_mfma_f32_16x16x32_bf16 v[76:79], a[40:43], v[124:127], v[76:79]
    ds_read_b64_tr_b16 v[122:123], v1 offset:38144
    v_mfma_f32_16x16x32_bf16 v[84:87], a[44:47], v[124:127], v[84:87]
    ds_read_b64_tr_b16 v[124:125], v1 offset:37664
    v_mfma_f32_16x16x32_bf16 v[88:91], v[108:111], a[40:43], v[88:91]
    ds_read_b64_tr_b16 v[126:127], v1 offset:38176
    v_mfma_f32_16x16x32_bf16 v[92:95], v[108:111], a[44:47], v[92:95]
    ds_read_b64_tr_b16 v[108:109], v2 offset:37632
    v_mfma_f32_16x16x32_bf16 v[96:99], v[112:115], a[40:43], v[96:99]
    ds_read_b64_tr_b16 v[110:111], v2 offset:38144
    v_mfma_f32_16x16x32_bf16 v[100:103], v[112:115], a[44:47], v[100:103]
    ds_read_b64_tr_b16 v[112:113], v2 offset:37664
    s_waitcnt lgkmcnt(3)
    v_mfma_f32_16x16x32_bf16 v[48:51], v[116:119], a[48:51], v[48:51]
    ds_read_b64_tr_b16 v[114:115], v2 offset:38176
    v_mfma_f32_16x16x32_bf16 v[52:55], v[116:119], a[52:55], v[52:55]
    ds_read_b64_tr_b16 v[116:117], v3 offset:37632
    v_mfma_f32_16x16x32_bf16 v[56:59], a[48:51], v[120:123], v[56:59]
    ds_read_b64_tr_b16 v[118:119], v3 offset:37888
    v_mfma_f32_16x16x32_bf16 v[64:67], a[52:55], v[120:123], v[64:67]
    ds_read_b64_tr_b16 v[120:121], v3 offset:37664
    v_mfma_f32_16x16x32_bf16 v[60:63], a[48:51], v[124:127], v[60:63]
    ds_read_b64_tr_b16 v[122:123], v3 offset:37920
    v_mfma_f32_16x16x32_bf16 v[68:71], a[52:55], v[124:127], v[68:71]
    ds_read_b128 a[56:59], v45 offset:49152
    ds_read_b128 a[60:63], v45 offset:51200
    s_waitcnt lgkmcnt(4)
    v_mfma_f32_16x16x32_bf16 v[72:75], a[48:51], v[108:111], v[72:75]
    ds_read_b128 v[124:127], v46 offset:448
    v_mfma_f32_16x16x32_bf16 v[80:83], a[52:55], v[108:111], v[80:83]
    ds_read_b64_tr_b16 v[108:109], v1 offset:41792
    v_mfma_f32_16x16x32_bf16 v[76:79], a[48:51], v[112:115], v[76:79]
    ds_read_b64_tr_b16 v[110:111], v1 offset:42304
    v_mfma_f32_16x16x32_bf16 v[84:87], a[52:55], v[112:115], v[84:87]
    ds_read_b64_tr_b16 v[112:113], v1 offset:41824
    v_mfma_f32_16x16x32_bf16 v[88:91], v[116:119], a[48:51], v[88:91]
    ds_read_b64_tr_b16 v[114:115], v1 offset:42336
    v_mfma_f32_16x16x32_bf16 v[92:95], v[116:119], a[52:55], v[92:95]
    ds_read_b64_tr_b16 v[116:117], v2 offset:41792
    s_waitcnt lgkmcnt(3)
    v_mfma_f32_16x16x32_bf16 v[96:99], v[120:123], a[48:51], v[96:99]
    ds_read_b64_tr_b16 v[118:119], v2 offset:42304
    v_mfma_f32_16x16x32_bf16 v[100:103], v[120:123], a[52:55], v[100:103]
    ds_read_b32 v107, v106 offset:96
    ds_read_b64_tr_b16 v[120:121], v2 offset:41824
    v_mfma_f32_16x16x32_bf16 v[48:51], v[124:127], a[56:59], v[48:51]
    ds_read_b64_tr_b16 v[122:123], v2 offset:42336
    v_mfma_f32_16x16x32_bf16 v[52:55], v[124:127], a[60:63], v[52:55]
    s_barrier
    ds_read_b64_tr_b16 v[124:125], v3 offset:39744
    v_mfma_f32_16x16x32_bf16 v[56:59], a[56:59], v[108:111], v[56:59]
    ds_read_b64_tr_b16 v[126:127], v3 offset:40000
    v_mfma_f32_16x16x32_bf16 v[64:67], a[60:63], v[108:111], v[64:67]
    ds_read_b64_tr_b16 v[108:109], v3 offset:39776
    s_waitcnt lgkmcnt(3)
    v_mfma_f32_16x16x32_bf16 v[60:63], a[56:59], v[112:115], v[60:63]
    ds_read_b64_tr_b16 v[110:111], v3 offset:40032
    v_cmp_ne_u32 vcc, 0, v107
    v_mfma_f32_16x16x32_bf16 v[68:71], a[60:63], v[112:115], v[68:71]
    s_cbranch_vccz L_gated_mix__sliding_block__swiglu_ffn__prompt_kernel_c_24b
L_gated_mix__sliding_block__swiglu_ffn__prompt_kernel_c_24l:
    ds_read_b32 v107, v106 offset:96
    s_add_u32 s101, s101, 1
    s_cmp_gt_u32 s101, s42
    s_cbranch_scc1 L_gated_mix__sliding_block__swiglu_ffn__prompt_kernel_c_24b
    s_waitcnt lgkmcnt(0)
    v_cmp_ne_u32 vcc, 0, v107
    s_nop 0
    s_cbranch_vccnz L_gated_mix__sliding_block__swiglu_ffn__prompt_kernel_c_24l
L_gated_mix__sliding_block__swiglu_ffn__prompt_kernel_c_24b:
    ds_read_b128 a[64:67], v44 offset:0
    ds_read_b128 a[68:71], v44 offset:2048
    v_mfma_f32_16x16x32_bf16 v[72:75], a[56:59], v[116:119], v[72:75]
    ds_read_b128 v[112:115], v46 offset:512
    v_mfma_f32_16x16x32_bf16 v[80:83], a[60:63], v[116:119], v[80:83]
    ds_read_b64_tr_b16 v[116:117], v1 offset:0
    v_mfma_f32_16x16x32_bf16 v[76:79], a[56:59], v[120:123], v[76:79]
    ds_read_b64_tr_b16 v[118:119], v1 offset:512
    v_mfma_f32_16x16x32_bf16 v[84:87], a[60:63], v[120:123], v[84:87]
    ds_read_b64_tr_b16 v[120:121], v1 offset:32
    s_waitcnt lgkmcnt(3)
    v_mfma_f32_16x16x32_bf16 v[88:91], v[124:127], a[56:59], v[88:91]
    ds_read_b64_tr_b16 v[122:123], v1 offset:544
    v_mfma_f32_16x16x32_bf16 v[92:95], v[124:127], a[60:63], v[92:95]
    ds_read_b64_tr_b16 v[124:125], v2 offset:0
    v_mfma_f32_16x16x32_bf16 v[96:99], v[108:111], a[56:59], v[96:99]
    ds_read_b64_tr_b16 v[126:127], v2 offset:512
    v_mfma_f32_16x16x32_bf16 v[100:103], v[108:111], a[60:63], v[100:103]
    ds_read_b64_tr_b16 v[108:109], v2 offset:32
    v_mfma_f32_16x16x32_bf16 v[48:51], v[112:115], a[64:67], v[48:51]
    ds_read_b64_tr_b16 v[110:111], v2 offset:544
    v_mfma_f32_16x16x32_bf16 v[52:55], v[112:115], a[68:71], v[52:55]
    ds_read_b64_tr_b16 v[112:113], v3 offset:0
    s_waitcnt lgkmcnt(3)
    v_mfma_f32_16x16x32_bf16 v[56:59], a[64:67], v[116:119], v[56:59]
    ds_read_b64_tr_b16 v[114:115], v3 offset:256
    v_mfma_f32_16x16x32_bf16 v[64:67], a[68:71], v[116:119], v[64:67]
    ds_read_b64_tr_b16 v[116:117], v3 offset:32
    v_mfma_f32_16x16x32_bf16 v[60:63], a[64:67], v[120:123], v[60:63]
    ds_read_b64_tr_b16 v[118:119], v3 offset:288
    v_mfma_f32_16x16x32_bf16 v[68:71], a[68:71], v[120:123], v[68:71]
    ds_read_b128 a[72:75], v45 offset:0
    ds_read_b128 a[76:79], v45 offset:2048
    v_mfma_f32_16x16x32_bf16 v[72:75], a[64:67], v[124:127], v[72:75]
    ds_read_b128 v[120:123], v46 offset:576
    v_mfma_f32_16x16x32_bf16 v[80:83], a[68:71], v[124:127], v[80:83]
    ds_read_b64_tr_b16 v[124:125], v1 offset:4160
    s_waitcnt lgkmcnt(4)
    v_mfma_f32_16x16x32_bf16 v[76:79], a[64:67], v[108:111], v[76:79]
    ds_read_b64_tr_b16 v[126:127], v1 offset:4672
    v_mfma_f32_16x16x32_bf16 v[84:87], a[68:71], v[108:111], v[84:87]
    ds_read_b64_tr_b16 v[108:109], v1 offset:4192
    v_mfma_f32_16x16x32_bf16 v[88:91], v[112:115], a[64:67], v[88:91]
    ds_read_b64_tr_b16 v[110:111], v1 offset:4704
    v_mfma_f32_16x16x32_bf16 v[92:95], v[112:115], a[68:71], v[92:95]
    ds_read_b64_tr_b16 v[112:113], v2 offset:4160
    v_mfma_f32_16x16x32_bf16 v[96:99], v[116:119], a[64:67], v[96:99]
    ds_read_b64_tr_b16 v[114:115], v2 offset:4672
    v_mfma_f32_16x16x32_bf16 v[100:103], v[116:119], a[68:71], v[100:103]
    ds_read_b32 v107, v106 offset:112
    ds_read_b64_tr_b16 v[116:117], v2 offset:4192
    s_waitcnt lgkmcnt(4)
    v_mfma_f32_16x16x32_bf16 v[48:51], v[120:123], a[72:75], v[48:51]
    ds_read_b64_tr_b16 v[118:119], v2 offset:4704
    v_mfma_f32_16x16x32_bf16 v[52:55], v[120:123], a[76:79], v[52:55]
    s_barrier
    ds_read_b64_tr_b16 v[120:121], v3 offset:2112
    v_mfma_f32_16x16x32_bf16 v[56:59], a[72:75], v[124:127], v[56:59]
    ds_read_b64_tr_b16 v[122:123], v3 offset:2368
    v_mfma_f32_16x16x32_bf16 v[64:67], a[76:79], v[124:127], v[64:67]
    ds_read_b64_tr_b16 v[124:125], v3 offset:2144
    v_mfma_f32_16x16x32_bf16 v[60:63], a[72:75], v[108:111], v[60:63]
    ds_read_b64_tr_b16 v[126:127], v3 offset:2400
    s_waitcnt lgkmcnt(6)
    v_cmp_ne_u32 vcc, 0, v107
    v_mfma_f32_16x16x32_bf16 v[68:71], a[76:79], v[108:111], v[68:71]
    s_cbranch_vccz L_gated_mix__sliding_block__swiglu_ffn__prompt_kernel_c_25b
L_gated_mix__sliding_block__swiglu_ffn__prompt_kernel_c_25l:
    ds_read_b32 v107, v106 offset:112
    s_add_u32 s101, s101, 1
    s_cmp_gt_u32 s101, s42
    s_cbranch_scc1 L_gated_mix__sliding_block__swiglu_ffn__prompt_kernel_c_25b
    s_waitcnt lgkmcnt(0)
    v_cmp_ne_u32 vcc, 0, v107
    s_nop 0
    s_cbranch_vccnz L_gated_mix__sliding_block__swiglu_ffn__prompt_kernel_c_25l
L_gated_mix__sliding_block__swiglu_ffn__prompt_kernel_c_25b:
    ds_read_b128 a[80:83], v44 offset:16384
    ds_read_b128 a[84:87], v44 offset:18432
    s_waitcnt lgkmcnt(4)
    v_mfma_f32_16x16x32_bf16 v[72:75], a[72:75], v[112:115], v[72:75]
    ds_read_b128 v[108:111], v46 offset:640
    v_mfma_f32_16x16x32_bf16 v[80:83], a[76:79], v[112:115], v[80:83]
    ds_read_b64_tr_b16 v[112:113], v1 offset:12544
    v_mfma_f32_16x16x32_bf16 v[76:79], a[72:75], v[116:119], v[76:79]
    ds_read_b64_tr_b16 v[114:115], v1 offset:13056
    v_mfma_f32_16x16x32_bf16 v[84:87], a[76:79], v[116:119], v[84:87]
    ds_read_b64_tr_b16 v[116:117], v1 offset:12576
    v_mfma_f32_16x16x32_bf16 v[88:91], v[120:123], a[72:75], v[88:91]
    ds_read_b64_tr_b16 v[118:119], v1 offset:13088
    v_mfma_f32_16x16x32_bf16 v[92:95], v[120:123], a[76:79], v[92:95]
    ds_read_b64_tr_b16 v[120:121], v2 offset:12544
    s_waitcnt lgkmcnt(3)
    v_mfma_f32_16x16x32_bf16 v[96:99], v[124:127], a[72:75], v[96:99]
    ds_read_b64_tr_b16 v[122:123], v2 offset:13056
    v_mfma_f32_16x16x32_bf16 v[100:103], v[124:127], a[76:79], v[100:103]
    ds_read_b64_tr_b16 v[124:125], v2 offset:12576
    v_mfma_f32_16x16x32_bf16 v[48:51], v[108:111], a[80:83], v[48:51]
    ds_read_b64_tr_b16 v[126:127], v2 offset:13088
    v_mfma_f32_16x16x32_bf16 v[52:55], v[108:111], a[84:87], v[52:55]
    ds_read_b64_tr_b16 v[108:109], v3 offset:12544
    s_waitcnt vmcnt(0)
    v_mfma_f32_16x16x32_bf16 v[56:59], a[80:83], v[112:115], v[56:59]
    ds_read_b64_tr_b16 v[110:111], v3 offset:12800
    v_mfma_f32_16x16x32_bf16 v[64:67], a[84:87], v[112:115], v[64:67]
    ds_read_b64_tr_b16 v[112:113], v3 offset:12576
    s_waitcnt lgkmcnt(3)
    v_mfma_f32_16x16x32_bf16 v[60:63], a[80:83], v[116:119], v[60:63]
    ds_read_b64_tr_b16 v[114:115], v3 offset:12832
    v_mfma_f32_16x16x32_bf16 v[68:71], a[84:87], v[116:119], v[68:71]
    ds_read_b128 a[88:91], v45 offset:16384
    ds_read_b128 a[92:95], v45 offset:18432
    v_mfma_f32_16x16x32_bf16 v[72:75], a[80:83], v[120:123], v[72:75]
    ds_read_b128 v[116:119], v46 offset:704
    v_mfma_f32_16x16x32_bf16 v[80:83], a[84:87], v[120:123], v[80:83]
    ds_read_b64_tr_b16 v[120:121], v1 offset:16704
    v_mfma_f32_16x16x32_bf16 v[76:79], a[80:83], v[124:127], v[76:79]
    ds_read_b64_tr_b16 v[122:123], v1 offset:17216
    v_mfma_f32_16x16x32_bf16 v[84:87], a[84:87], v[124:127], v[84:87]
    ds_read_b64_tr_b16 v[124:125], v1 offset:16736
    s_waitcnt lgkmcnt(3)
    v_mfma_f32_16x16x32_bf16 v[88:91], v[108:111], a[80:83], v[88:91]
    ds_read_b64_tr_b16 v[126:127], v1 offset:17248
    v_mfma_f32_16x16x32_bf16 v[92:95], v[108:111], a[84:87], v[92:95]
    ds_read_b64_tr_b16 v[108:109], v2 offset:16704
    v_mfma_f32_16x16x32_bf16 v[96:99], v[112:115], a[80:83], v[96:99]
    ds_read_b64_tr_b16 v[110:111], v2 offset:17216
    v_mfma_f32_16x16x32_bf16 v[100:103], v[112:115], a[84:87], v[100:103]
    ds_read_b32 v107, v106 offset:128
    ds_read_b64_tr_b16 v[112:113], v2 offset:16736
    v_mfma_f32_16x16x32_bf16 v[48:51], v[116:119], a[88:91], v[48:51]
    ds_read_b64_tr_b16 v[114:115], v2 offset:17248
    v_mfma_f32_16x16x32_bf16 v[52:55], v[116:119], a[92:95], v[52:55]
    ds_read_b64_tr_b16 v[116:117], v3 offset:14656
    s_waitcnt lgkmcnt(4)
    v_mfma_f32_16x16x32_bf16 v[56:59], a[88:91], v[120:123], v[56:59]
    ds_read_b64_tr_b16 v[118:119], v3 offset:14912
    v_mfma_f32_16x16x32_bf16 v[64:67], a[92:95], v[120:123], v[64:67]
    ds_read_b64_tr_b16 v[120:121], v3 offset:14688
    v_mfma_f32_16x16x32_bf16 v[60:63], a[88:91], v[124:127], v[60:63]
    ds_read_b64_tr_b16 v[122:123], v3 offset:14944
    s_waitcnt lgkmcnt(6)
    v_cmp_ne_u32 vcc, 0, v107
    v_mfma_f32_16x16x32_bf16 v[68:71], a[92:95], v[124:127], v[68:71]
    s_cbranch_vccz L_gated_mix__sliding_block__swiglu_ffn__prompt_kernel_c_26b
L_gated_mix__sliding_block__swiglu_ffn__prompt_kernel_c_26l:
    ds_read_b32 v107, v106 offset:128
    s_add_u32 s101, s101, 1
    s_cmp_gt_u32 s101, s42
    s_cbranch_scc1 L_gated_mix__sliding_block__swiglu_ffn__prompt_kernel_c_26b
    s_waitcnt lgkmcnt(0)
    v_cmp_ne_u32 vcc, 0, v107
    s_nop 0
    s_cbranch_vccnz L_gated_mix__sliding_block__swiglu_ffn__prompt_kernel_c_26l
L_gated_mix__sliding_block__swiglu_ffn__prompt_kernel_c_26b:
    ds_read_b128 a[96:99], v44 offset:32768
    ds_read_b128 a[100:103], v44 offset:34816
    v_mfma_f32_16x16x32_bf16 v[72:75], a[88:91], v[108:111], v[72:75]
    ds_read_b128 v[124:127], v46 offset:768
    v_mfma_f32_16x16x32_bf16 v[80:83], a[92:95], v[108:111], v[80:83]
    ds_read_b64_tr_b16 v[108:109], v1 offset:25088
    s_waitcnt lgkmcnt(4)
    v_mfma_f32_16x16x32_bf16 v[76:79], a[88:91], v[112:115], v[76:79]
    ds_read_b64_tr_b16 v[110:111], v1 offset:25600
    v_mfma_f32_16x16x32_bf16 v[84:87], a[92:95], v[112:115], v[84:87]
    ds_read_b64_tr_b16 v[112:113], v1 offset:25120
    v_mfma_f32_16x16x32_bf16 v[88:91], v[116:119], a[88:91], v[88:91]
    ds_read_b64_tr_b16 v[114:115], v1 offset:25632
    v_mfma_f32_16x16x32_bf16 v[92:95], v[116:119], a[92:95], v[92:95]
    ds_read_b64_tr_b16 v[116:117], v2 offset:25088
    buffer_load_dword v47, off, s[44:47], 0 sc1
    v_mfma_f32_16x16x32_bf16 v[96:99], v[120:123], a[88:91], v[96:99]
    ds_read_b64_tr_b16 v[118:119], v2 offset:25600
    v_mfma_f32_16x16x32_bf16 v[100:103], v[120:123], a[92:95], v[100:103]
    ds_read_b64_tr_b16 v[120:121], v2 offset:25120
    s_waitcnt lgkmcnt(3)
    v_mfma_f32_16x16x32_bf16 v[48:51], v[124:127], a[96:99], v[48:51]
    ds_read_b64_tr_b16 v[122:123], v2 offset:25632
    v_mfma_f32_16x16x32_bf16 v[52:55], v[124:127], a[100:103], v[52:55]
    ds_read_b64_tr_b16 v[124:125], v3 offset:25088
    v_mfma_f32_16x16x32_bf16 v[56:59], a[96:99], v[108:111], v[56:59]
    ds_read_b64_tr_b16 v[126:127], v3 offset:25344
    v_mfma_f32_16x16x32_bf16 v[64:67], a[100:103], v[108:111], v[64:67]
    ds_read_b64_tr_b16 v[108:109], v3 offset:25120
    v_mfma_f32_16x16x32_bf16 v[60:63], a[96:99], v[112:115], v[60:63]
    ds_read_b64_tr_b16 v[110:111], v3 offset:25376
    v_mfma_f32_16x16x32_bf16 v[68:71], a[100:103], v[112:115], v[68:71]
    ds_read_b128 a[104:107], v45 offset:32768
    ds_read_b128 a[108:111], v45 offset:34816
    s_waitcnt lgkmcnt(4)
    v_mfma_f32_16x16x32_bf16 v[72:75], a[96:99], v[116:119], v[72:75]
    ds_read_b128 v[112:115], v46 offset:832
    v_mfma_f32_16x16x32_bf16 v[80:83], a[100:103], v[116:119], v[80:83]
    ds_read_b64_tr_b16 v[116:117], v1 offset:29248
    v_mfma_f32_16x16x32_bf16 v[76:79], a[96:99], v[120:123], v[76:79]
    ds_read_b64_tr_b16 v[118:119], v1 offset:29760
    v_mfma_f32_16x16x32_bf16 v[84:87], a[100:103], v[120:123], v[84:87]
    ds_read_b64_tr_b16 v[120:121], v1 offset:29280
    v_mfma_f32_16x16x32_bf16 v[88:91], v[124:127], a[96:99], v[88:91]
    ds_read_b64_tr_b16 v[122:123], v1 offset:29792
    v_mfma_f32_16x16x32_bf16 v[92:95], v[124:127], a[100:103], v[92:95]
    ds_read_b64_tr_b16 v[124:125], v2 offset:29248
    s_waitcnt lgkmcnt(3)
    v_mfma_f32_16x16x32_bf16 v[96:99], v[108:111], a[96:99], v[96:99]
    ds_read_b64_tr_b16 v[126:127], v2 offset:29760
    v_mfma_f32_16x16x32_bf16 v[100:103], v[108:111], a[100:103], v[100:103]
    ds_read_b32 v107, v106 offset:144
    ds_read_b64_tr_b16 v[108:109], v2 offset:29280
    v_mfma_f32_16x16x32_bf16 v[48:51], v[112:115], a[104:107], v[48:51]
    ds_read_b64_tr_b16 v[110:111], v2 offset:29792
    v_mfma_f32_16x16x32_bf16 v[52:55], v[112:115], a[108:111], v[52:55]
    ds_read_b64_tr_b16 v[112:113], v3 offset:27200
    v_mfma_f32_16x16x32_bf16 v[56:59], a[104:107], v[116:119], v[56:59]
    ds_read_b64_tr_b16 v[114:115], v3 offset:27456
    v_mfma_f32_16x16x32_bf16 v[64:67], a[108:111], v[116:119], v[64:67]
    ds_read_b64_tr_b16 v[116:117], v3 offset:27232
    s_waitcnt lgkmcnt(3)
    v_mfma_f32_16x16x32_bf16 v[60:63], a[104:107], v[120:123], v[60:63]
    ds_read_b64_tr_b16 v[118:119], v3 offset:27488
    v_cmp_ne_u32 vcc, 0, v107
    v_mfma_f32_16x16x32_bf16 v[68:71], a[108:111], v[120:123], v[68:71]
    s_barrier
    s_cbranch_vccz L_gated_mix__sliding_block__swiglu_ffn__prompt_kernel_c_27b
L_gated_mix__sliding_block__swiglu_ffn__prompt_kernel_c_27l:
    ds_read_b32 v107, v106 offset:144
    s_add_u32 s101, s101, 1
    s_cmp_gt_u32 s101, s42
    s_cbranch_scc1 L_gated_mix__sliding_block__swiglu_ffn__prompt_kernel_c_27b
    s_waitcnt lgkmcnt(0)
    v_cmp_ne_u32 vcc, 0, v107
    s_nop 0
    s_cbranch_vccnz L_gated_mix__sliding_block__swiglu_ffn__prompt_kernel_c_27l
L_gated_mix__sliding_block__swiglu_ffn__prompt_kernel_c_27b:
    ds_read_b128 a[112:115], v44 offset:49152
    ds_read_b128 a[116:119], v44 offset:51200
    v_mfma_f32_16x16x32_bf16 v[72:75], a[104:107], v[124:127], v[72:75]
    ds_read_b128 v[120:123], v46 offset:896
    v_mfma_f32_16x16x32_bf16 v[80:83], a[108:111], v[124:127], v[80:83]
    ds_read_b64_tr_b16 v[124:125], v1 offset:37632
    v_mfma_f32_16x16x32_bf16 v[76:79], a[104:107], v[108:111], v[76:79]
    ds_read_b64_tr_b16 v[126:127], v1 offset:38144
    v_mfma_f32_16x16x32_bf16 v[84:87], a[108:111], v[108:111], v[84:87]
    ds_read_b64_tr_b16 v[108:109], v1 offset:37664
    s_waitcnt lgkmcnt(3)
    v_mfma_f32_16x16x32_bf16 v[88:91], v[112:115], a[104:107], v[88:91]
    ds_read_b64_tr_b16 v[110:111], v1 offset:38176
    v_mfma_f32_16x16x32_bf16 v[92:95], v[112:115], a[108:111], v[92:95]
    ds_read_b64_tr_b16 v[112:113], v2 offset:37632
    v_mfma_f32_16x16x32_bf16 v[96:99], v[116:119], a[104:107], v[96:99]
    ds_read_b64_tr_b16 v[114:115], v2 offset:38144
    v_mfma_f32_16x16x32_bf16 v[100:103], v[116:119], a[108:111], v[100:103]
    ds_read_b64_tr_b16 v[116:117], v2 offset:37664
    v_mfma_f32_16x16x32_bf16 v[48:51], v[120:123], a[112:115], v[48:51]
    ds_read_b64_tr_b16 v[118:119], v2 offset:38176
    v_mfma_f32_16x16x32_bf16 v[52:55], v[120:123], a[116:119], v[52:55]
    ds_read_b64_tr_b16 v[120:121], v3 offset:37632
    s_waitcnt lgkmcnt(3)
    v_mfma_f32_16x16x32_bf16 v[56:59], a[112:115], v[124:127], v[56:59]
    ds_read_b64_tr_b16 v[122:123], v3 offset:37888
    v_mfma_f32_16x16x32_bf16 v[64:67], a[116:119], v[124:127], v[64:67]
    ds_read_b64_tr_b16 v[124:125], v3 offset:37664
    v_mfma_f32_16x16x32_bf16 v[60:63], a[112:115], v[108:111], v[60:63]
    ds_read_b64_tr_b16 v[126:127], v3 offset:37920
    v_mfma_f32_16x16x32_bf16 v[68:71], a[116:119], v[108:111], v[68:71]
    ds_read_b128 a[120:123], v45 offset:49152
    ds_read_b128 a[124:127], v45 offset:51200
    v_mfma_f32_16x16x32_bf16 v[72:75], a[112:115], v[112:115], v[72:75]
    ds_read_b128 v[108:111], v46 offset:960
    v_mfma_f32_16x16x32_bf16 v[80:83], a[116:119], v[112:115], v[80:83]
    ds_read_b64_tr_b16 v[112:113], v1 offset:41792
    s_waitcnt lgkmcnt(4)
    v_mfma_f32_16x16x32_bf16 v[76:79], a[112:115], v[116:119], v[76:79]
    ds_read_b64_tr_b16 v[114:115], v1 offset:42304
    v_mfma_f32_16x16x32_bf16 v[84:87], a[116:119], v[116:119], v[84:87]
    ds_read_b64_tr_b16 v[116:117], v1 offset:41824
    v_mfma_f32_16x16x32_bf16 v[88:91], v[120:123], a[112:115], v[88:91]
    ds_read_b64_tr_b16 v[118:119], v1 offset:42336
    v_mfma_f32_16x16x32_bf16 v[92:95], v[120:123], a[116:119], v[92:95]
    ds_read_b64_tr_b16 v[120:121], v2 offset:41792
    v_mfma_f32_16x16x32_bf16 v[96:99], v[124:127], a[112:115], v[96:99]
    ds_read_b64_tr_b16 v[122:123], v2 offset:42304
    v_mfma_f32_16x16x32_bf16 v[100:103], v[124:127], a[116:119], v[100:103]
    ds_read_b32 v107, v106 offset:160
    ds_read_b64_tr_b16 v[124:125], v2 offset:41824
    s_waitcnt lgkmcnt(4)
    v_mfma_f32_16x16x32_bf16 v[48:51], v[108:111], a[120:123], v[48:51]
    ds_read_b64_tr_b16 v[126:127], v2 offset:42336
    v_mfma_f32_16x16x32_bf16 v[52:55], v[108:111], a[124:127], v[52:55]
    ds_read_b64_tr_b16 v[108:109], v3 offset:39744
    v_mfma_f32_16x16x32_bf16 v[56:59], a[120:123], v[112:115], v[56:59]
    ds_read_b64_tr_b16 v[110:111], v3 offset:40000
    v_mfma_f32_16x16x32_bf16 v[64:67], a[124:127], v[112:115], v[64:67]
    ds_read_b64_tr_b16 v[112:113], v3 offset:39776
    v_mfma_f32_16x16x32_bf16 v[60:63], a[120:123], v[116:119], v[60:63]
    ds_read_b64_tr_b16 v[114:115], v3 offset:40032
    s_waitcnt lgkmcnt(6)
    v_cmp_ne_u32 vcc, 0, v107
    v_mfma_f32_16x16x32_bf16 v[68:71], a[124:127], v[116:119], v[68:71]
    s_cbranch_vccz L_gated_mix__sliding_block__swiglu_ffn__prompt_kernel_c_28b
L_gated_mix__sliding_block__swiglu_ffn__prompt_kernel_c_28l:
    ds_read_b32 v107, v106 offset:160
    s_add_u32 s101, s101, 1
    s_cmp_gt_u32 s101, s42
    s_cbranch_scc1 L_gated_mix__sliding_block__swiglu_ffn__prompt_kernel_c_28b
    s_waitcnt lgkmcnt(0)
    v_cmp_ne_u32 vcc, 0, v107
    s_nop 0
    s_cbranch_vccnz L_gated_mix__sliding_block__swiglu_ffn__prompt_kernel_c_28l
L_gated_mix__sliding_block__swiglu_ffn__prompt_kernel_c_28b:
    ds_read_b64_tr_b16 v[116:117], v6 offset:0
    s_waitcnt lgkmcnt(3)
    v_mfma_f32_16x16x32_bf16 v[72:75], a[120:123], v[120:123], v[72:75]
    ds_read_b64_tr_b16 v[118:119], v6 offset:768
    v_mfma_f32_16x16x32_bf16 v[80:83], a[124:127], v[120:123], v[80:83]
    ds_read_b64_tr_b16 v[120:121], v6 offset:64
    v_mfma_f32_16x16x32_bf16 v[76:79], a[120:123], v[124:127], v[76:79]
    ds_read_b64_tr_b16 v[122:123], v6 offset:832
    v_mul_f32 v4, 0x3fb8aa3b, v48
    v_mfma_f32_16x16x32_bf16 v[84:87], a[124:127], v[124:127], v[84:87]
    ds_read_b64_tr_b16 v[124:125], v6 offset:128
    v_mul_f32 v105, 0x3fb8aa3b, v52
    v_mfma_f32_16x16x32_bf16 v[88:91], v[108:111], a[120:123], v[88:91]
    ds_read_b64_tr_b16 v[126:127], v6 offset:896
    v_mfma_f32_16x16x32_bf16 v[92:95], v[108:111], a[124:127], v[92:95]
    ds_read_b64_tr_b16 v[108:109], v6 offset:32
    s_waitcnt vmcnt(0)
    v_readfirstlane_b32 s100, v47
    s_nop 0
    s_cmp_eq_u32 s100, 0
    s_cbranch_scc1 L_gated_mix__sliding_block__swiglu_ffn__prompt_kernel_non_29
L_gated_mix__sliding_block__swiglu_ffn__prompt_kernel_non_29b:
    s_waitcnt lgkmcnt(3)
    v_mfma_f32_16x16x32_bf16 v[96:99], v[112:115], a[120:123], v[96:99]
    ds_read_b64_tr_b16 v[110:111], v6 offset:800
    v_mfma_f32_16x16x32_bf16 v[100:103], v[112:115], a[124:127], v[100:103]
    ds_read_b64_tr_b16 v[112:113], v6 offset:96
    v_mfma_f32_16x16x32_bf16 v[8:11], v[116:119], a[0:3], 0
    ds_read_b64_tr_b16 v[114:115], v6 offset:864
    v_mfma_f32_16x16x32_bf16 v[16:19], v[116:119], a[4:7], 0
    ds_read_b64_tr_b16 v[116:117], v6 offset:160
    v_mfma_f32_16x16x32_bf16 v[24:27], v[120:123], a[0:3], 0
    ds_read_b64_tr_b16 v[118:119], v6 offset:928
    v_exp_f32 v4, v4
    v_mfma_f32_16x16x32_bf16 v[32:35], v[120:123], a[4:7], 0
    ds_read_b64_tr_b16 v[120:121], v6 offset:6208
    v_exp_f32 v105, v105
    s_waitcnt lgkmcnt(3)
    v_mfma_f32_16x16x32_bf16 v[40:43], v[124:127], a[0:3], 0
    ds_read_b64_tr_b16 v[122:123], v6 offset:6976
    v_add_f32 v4, 1.0, v4
    v_mfma_f32_16x16x32_bf16 v[48:51], v[124:127], a[4:7], 0
    s_barrier
    ds_read_b64_tr_b16 v[124:125], v6 offset:6272
    v_add_f32 v105, 1.0, v105
    v_mfma_f32_16x16x32_bf16 v[12:15], v[108:111], a[0:3], 0
    ds_read_b64_tr_b16 v[126:127], v6 offset:7040
    v_min_f32 v4, 0x7149f2ca, v4
    v_mfma_f32_16x16x32_bf16 v[20:23], v[108:111], a[4:7], 0
    ds_read_b64_tr_b16 v[108:109], v6 offset:6336
    v_min_f32 v105, 0x7149f2ca, v105
    v_mfma_f32_16x16x32_bf16 v[28:31], v[112:115], a[0:3], 0
    ds_read_b64_tr_b16 v[110:111], v6 offset:7104
    s_mov_b32 s0, 0xffff
    s_mov_b32 s1, 0xffff
    v_cndmask_b32 v104, v105, v4, s[0:1]
    v_mfma_f32_16x16x32_bf16 v[36:39], v[112:115], a[4:7], 0
    ds_read_b32 v107, v106 offset:176
    ds_read_b64_tr_b16 v[112:113], v6 offset:6240
    v_rcp_f32 v104, v104
    s_waitcnt lgkmcnt(4)
    v_mfma_f32_16x16x32_bf16 v[44:47], v[116:119], a[0:3], 0
    ds_read_b64_tr_b16 v[114:115], v6 offset:7008
    v_lshlrev_b32 v1, 4, v0
    v_mfma_f32_16x16x32_bf16 v[52:55], v[116:119], a[4:7], 0
    ds_read_b64_tr_b16 v[116:117], v6 offset:6304
    v_sub_f32 v104, 1.0, v104
    v_mfma_f32_16x16x32_bf16 v[8:11], v[120:123], a[8:11], v[8:11]
    ds_read_b64_tr_b16 v[118:119], v6 offset:7072
    v_lshl_add_u32 v2, v0, 2, s57
    v_mfma_f32_16x16x32_bf16 v[16:19], v[120:123], a[12:15], v[16:19]
    ds_read_b64_tr_b16 v[120:121], v6 offset:6368
    v_add_u32 v3, s54, v1
    v_mfma_f32_16x16x32_bf16 v[24:27], v[124:127], a[8:11], v[24:27]
    ds_read_b64_tr_b16 v[122:123], v6 offset:7136
    s_waitcnt lgkmcnt(6)
    v_cmp_ne_u32 vcc, 0, v107
    v_cvt_pk_bf16_f32 v56, v56, v57
    v_mfma_f32_16x16x32_bf16 v[32:35], v[124:127], a[12:15], v[32:35]
    s_cbranch_vccnz L_gated_mix__sliding_block__swiglu_ffn__prompt_kernel_c_30l
L_gated_mix__sliding_block__swiglu_ffn__prompt_kernel_c_30b:
    ds_read_b64_tr_b16 v[124:125], v6 offset:12544
    v_cvt_pk_bf16_f32 v57, v58, v59
    s_waitcnt lgkmcnt(3)
    v_mfma_f32_16x16x32_bf16 v[40:43], v[108:111], a[8:11], v[40:43]
    ds_read_b64_tr_b16 v[126:127], v6 offset:13312
    v_cvt_pk_bf16_f32 v58, v60, v61
    v_mfma_f32_16x16x32_bf16 v[48:51], v[108:111], a[12:15], v[48:51]
    ds_read_b64_tr_b16 v[108:109], v6 offset:12608
    v_cvt_pk_bf16_f32 v59, v62, v63
    v_mfma_f32_16x16x32_bf16 v[12:15], v[112:115], a[8:11], v[12:15]
    ds_read_b64_tr_b16 v[110:111], v6 offset:13376
    v_permlane16_swap_b32 v56, v58
    v_mfma_f32_16x16x32_bf16 v[20:23], v[112:115], a[12:15], v[20:23]
    ds_read_b64_tr_b16 v[112:113], v6 offset:12672
    v_permlane16_swap_b32 v57, v59
    v_mfma_f32_16x16x32_bf16 v[28:31], v[116:119], a[8:11], v[28:31]
    ds_read_b64_tr_b16 v[114:115], v6 offset:13440
    v_permlane32_swap_b32 v56, v58
    v_mfma_f32_16x16x32_bf16 v[36:39], v[116:119], a[12:15], v[36:39]
    ds_read_b64_tr_b16 v[116:117], v6 offset:12576
    v_permlane32_swap_b32 v57, v59
    s_waitcnt lgkmcnt(3)
    v_mfma_f32_16x16x32_bf16 v[44:47], v[120:123], a[8:11], v[44:47]
    ds_read_b64_tr_b16 v[118:119], v6 offset:13344
    v_cvt_pk_bf16_f32 v64, v64, v65
    v_mfma_f32_16x16x32_bf16 v[52:55], v[120:123], a[12:15], v[52:55]
    ds_read_b64_tr_b16 v[120:121], v6 offset:12640
    v_cvt_pk_bf16_f32 v65, v66, v67
    v_mfma_f32_16x16x32_bf16 v[8:11], v[124:127], a[16:19], v[8:11]
    ds_read_b64_tr_b16 v[122:123], v6 offset:13408
    v_cvt_pk_bf16_f32 v66, v68, v69
    v_mfma_f32_16x16x32_bf16 v[16:19], v[124:127], a[20:23], v[16:19]
    ds_read_b64_tr_b16 v[124:125], v6 offset:12704
    v_cvt_pk_bf16_f32 v67, v70, v71
    v_mfma_f32_16x16x32_bf16 v[24:27], v[108:111], a[16:19], v[24:27]
    ds_read_b64_tr_b16 v[126:127], v6 offset:13472
    v_permlane16_swap_b32 v64, v66
    v_mfma_f32_16x16x32_bf16 v[32:35], v[108:111], a[20:23], v[32:35]
    ds_read_b64_tr_b16 v[108:109], v6 offset:18752
    v_permlane16_swap_b32 v65, v67
    s_waitcnt lgkmcnt(3)
    v_mfma_f32_16x16x32_bf16 v[40:43], v[112:115], a[16:19], v[40:43]
    ds_read_b64_tr_b16 v[110:111], v6 offset:19520
    v_permlane32_swap_b32 v64, v66
    v_mfma_f32_16x16x32_bf16 v[48:51], v[112:115], a[20:23], v[48:51]
    ds_read_b64_tr_b16 v[112:113], v6 offset:18816
    v_permlane32_swap_b32 v65, v67
    v_mfma_f32_16x16x32_bf16 v[12:15], v[116:119], a[16:19], v[12:15]
    ds_read_b64_tr_b16 v[114:115], v6 offset:19584
    v_cvt_pk_bf16_f32 v72, v72, v73
    v_mfma_f32_16x16x32_bf16 v[20:23], v[116:119], a[20:23], v[20:23]
    ds_read_b64_tr_b16 v[116:117], v6 offset:18880
    v_cvt_pk_bf16_f32 v73, v74, v75
    v_mfma_f32_16x16x32_bf16 v[28:31], v[120:123], a[16:19], v[28:31]
    ds_read_b64_tr_b16 v[118:119], v6 offset:19648
    v_cvt_pk_bf16_f32 v74, v76, v77
    v_mfma_f32_16x16x32_bf16 v[36:39], v[120:123], a[20:23], v[36:39]
    ds_read_b32 v107, v106 offset:192
    ds_read_b64_tr_b16 v[120:121], v6 offset:18784
    v_cvt_pk_bf16_f32 v75, v78, v79
    s_waitcnt lgkmcnt(4)
    v_mfma_f32_16x16x32_bf16 v[44:47], v[124:127], a[16:19], v[44:47]
    ds_read_b64_tr_b16 v[122:123], v6 offset:19552
    v_permlane16_swap_b32 v72, v74
    v_mfma_f32_16x16x32_bf16 v[52:55], v[124:127], a[20:23], v[52:55]
    ds_read_b64_tr_b16 v[124:125], v6 offset:18848
    v_permlane16_swap_b32 v73, v75
    v_mfma_f32_16x16x32_bf16 v[8:11], v[108:111], a[24:27], v[8:11]
    ds_read_b64_tr_b16 v[126:127], v6 offset:19616
    v_permlane32_swap_b32 v72, v74
    v_mfma_f32_16x16x32_bf16 v[16:19], v[108:111], a[28:31], v[16:19]
    ds_read_b64_tr_b16 v[108:109], v6 offset:18912
    v_permlane32_swap_b32 v73, v75
    v_mfma_f32_16x16x32_bf16 v[24:27], v[112:115], a[24:27], v[24:27]
    ds_read_b64_tr_b16 v[110:111], v6 offset:19680
    s_waitcnt lgkmcnt(6)
    v_cmp_ne_u32 vcc, 0, v107
    v_cvt_pk_bf16_f32 v80, v80, v81
    v_mfma_f32_16x16x32_bf16 v[32:35], v[112:115], a[28:31], v[32:35]
    s_cbranch_vccnz L_gated_mix__sliding_block__swiglu_ffn__prompt_kernel_c_31l
L_gated_mix__sliding_block__swiglu_ffn__prompt_kernel_c_31b:
    ds_read_b64_tr_b16 v[112:113], v6 offset:25088
    v_cvt_pk_bf16_f32 v81, v82, v83
    s_waitcnt lgkmcnt(3)
    v_mfma_f32_16x16x32_bf16 v[40:43], v[116:119], a[24:27], v[40:43]
    ds_read_b64_tr_b16 v[114:115], v6 offset:25856
    v_cvt_pk_bf16_f32 v82, v84, v85
    v_mfma_f32_16x16x32_bf16 v[48:51], v[116:119], a[28:31], v[48:51]
    ds_read_b64_tr_b16 v[116:117], v6 offset:25152
    v_cvt_pk_bf16_f32 v83, v86, v87
    v_mfma_f32_16x16x32_bf16 v[12:15], v[120:123], a[24:27], v[12:15]
    ds_read_b64_tr_b16 v[118:119], v6 offset:25920
    v_permlane16_swap_b32 v80, v82
    v_mfma_f32_16x16x32_bf16 v[20:23], v[120:123], a[28:31], v[20:23]
    ds_read_b64_tr_b16 v[120:121], v6 offset:25216
    v_permlane16_swap_b32 v81, v83
    v_mfma_f32_16x16x32_bf16 v[28:31], v[124:127], a[24:27], v[28:31]
    ds_read_b64_tr_b16 v[122:123], v6 offset:25984
    v_permlane32_swap_b32 v80, v82
    v_mfma_f32_16x16x32_bf16 v[36:39], v[124:127], a[28:31], v[36:39]
    ds_read_b64_tr_b16 v[124:125], v6 offset:25120
    v_permlane32_swap_b32 v81, v83
    s_waitcnt lgkmcnt(3)
    v_mfma_f32_16x16x32_bf16 v[44:47], v[108:111], a[24:27], v[44:47]
    ds_read_b64_tr_b16 v[126:127], v6 offset:25888
    v_mul_f32 v88, 0x3eb8aa3b, v88
    v_mfma_f32_16x16x32_bf16 v[52:55], v[108:111], a[28:31], v[52:55]
    ds_read_b64_tr_b16 v[108:109], v6 offset:25184
    v_mul_f32 v89, 0x3eb8aa3b, v89
    v_mfma_f32_16x16x32_bf16 v[8:11], v[112:115], a[32:35], v[8:11]
    ds_read_b64_tr_b16 v[110:111], v6 offset:25952
    v_mul_f32 v90, 0x3eb8aa3b, v90
    v_mfma_f32_16x16x32_bf16 v[16:19], v[112:115], a[36:39], v[16:19]
    ds_read_b64_tr_b16 v[112:113], v6 offset:25248
    v_mul_f32 v91, 0x3eb8aa3b, v91
    v_mfma_f32_16x16x32_bf16 v[24:27], v[116:119], a[32:35], v[24:27]
    ds_read_b64_tr_b16 v[114:115], v6 offset:26016
    v_mul_f32 v92, 0x3eb8aa3b, v92
    v_mfma_f32_16x16x32_bf16 v[32:35], v[116:119], a[36:39], v[32:35]
    ds_read_b64_tr_b16 v[116:117], v6 offset:31296
    v_mul_f32 v93, 0x3eb8aa3b, v93
    s_waitcnt lgkmcnt(3)
    v_mfma_f32_16x16x32_bf16 v[40:43], v[120:123], a[32:35], v[40:43]
    ds_read_b64_tr_b16 v[118:119], v6 offset:32064
    v_mul_f32 v94, 0x3eb8aa3b, v94
    v_mfma_f32_16x16x32_bf16 v[48:51], v[120:123], a[36:39], v[48:51]
    ds_read_b64_tr_b16 v[120:121], v6 offset:31360
    v_mul_f32 v95, 0x3eb8aa3b, v95
    v_mfma_f32_16x16x32_bf16 v[12:15], v[124:127], a[32:35], v[12:15]
    ds_read_b64_tr_b16 v[122:123], v6 offset:32128
    v_cvt_pk_bf16_f32 v88, v88, v89
    v_mfma_f32_16x16x32_bf16 v[20:23], v[124:127], a[36:39], v[20:23]
    ds_read_b64_tr_b16 v[124:125], v6 offset:31424
    v_cvt_pk_bf16_f32 v89, v90, v91
    v_mfma_f32_16x16x32_bf16 v[28:31], v[108:111], a[32:35], v[28:31]
    ds_read_b64_tr_b16 v[126:127], v6 offset:32192
    v_cvt_pk_bf16_f32 v90, v92, v93
    v_mfma_f32_16x16x32_bf16 v[36:39], v[108:111], a[36:39], v[36:39]
    ds_read_b64_tr_b16 v[108:109], v6 offset:31328
    v_cvt_pk_bf16_f32 v91, v94, v95
    s_waitcnt lgkmcnt(3)
    v_mfma_f32_16x16x32_bf16 v[44:47], v[112:115], a[32:35], v[44:47]
    ds_read_b64_tr_b16 v[110:111], v6 offset:32096
    v_permlane16_swap_b32 v88, v90
    v_mfma_f32_16x16x32_bf16 v[52:55], v[112:115], a[36:39], v[52:55]
    ds_read_b64_tr_b16 v[112:113], v6 offset:31392
    v_permlane16_swap_b32 v89, v91
    v_mfma_f32_16x16x32_bf16 v[8:11], v[116:119], a[40:43], v[8:11]
    ds_read_b64_tr_b16 v[114:115], v6 offset:32160
    v_mul_f32 v96, 0x3eb8aa3b, v96
    v_mfma_f32_16x16x32_bf16 v[16:19], v[116:119], a[44:47], v[16:19]
    ds_read_b64_tr_b16 v[116:117], v6 offset:31456
    v_mul_f32 v97, 0x3eb8aa3b, v97
    v_mfma_f32_16x16x32_bf16 v[24:27], v[120:123], a[40:43], v[24:27]
    ds_read_b64_tr_b16 v[118:119], v6 offset:32224
    v_mul_f32 v98, 0x3eb8aa3b, v98
    v_mfma_f32_16x16x32_bf16 v[32:35], v[120:123], a[44:47], v[32:35]
    ds_read_b64_tr_b16 v[120:121], v5 offset:0
    v_mul_f32 v99, 0x3eb8aa3b, v99
    s_waitcnt lgkmcnt(3)
    v_mfma_f32_16x16x32_bf16 v[40:43], v[124:127], a[40:43], v[40:43]
    ds_read_b64_tr_b16 v[122:123], v5 offset:768
    v_mul_f32 v100, 0x3eb8aa3b, v100
    v_mfma_f32_16x16x32_bf16 v[48:51], v[124:127], a[44:47], v[48:51]
    ds_read_b64_tr_b16 v[124:125], v5 offset:64
    v_mul_f32 v101, 0x3eb8aa3b, v101
    buffer_store_dwordx4 v[56:59], v1, s[32:35], s53 offen offset:0 sc1
    v_mfma_f32_16x16x32_bf16 v[12:15], v[108:111], a[40:43], v[12:15]
    ds_read_b64_tr_b16 v[126:127], v5 offset:832
    v_mul_f32 v102, 0x3eb8aa3b, v102
    v_mfma_f32_16x16x32_bf16 v[20:23], v[108:111], a[44:47], v[20:23]
    ds_read_b64_tr_b16 v[108:109], v5 offset:128
    v_mul_f32 v103, 0x3eb8aa3b, v103
    buffer_store_dwordx4 v[64:67], v1, s[32:35], s53 offen offset:1024 sc1
    s_add_u32 s53, s53, 131072
    v_mfma_f32_16x16x32_bf16 v[28:31], v[112:115], a[40:43], v[28:31]
    ds_read_b64_tr_b16 v[110:111], v5 offset:896
    v_cvt_pk_bf16_f32 v96, v96, v97
    v_mfma_f32_16x16x32_bf16 v[36:39], v[112:115], a[44:47], v[36:39]
    ds_read_b64_tr_b16 v[112:113], v5 offset:32
    v_cvt_pk_bf16_f32 v97, v98, v99
    buffer_store_dwordx4 v[72:75], v1, s[32:35], s53 offen offset:0 sc1
    s_waitcnt lgkmcnt(3)
    v_mfma_f32_16x16x32_bf16 v[44:47], v[116:119], a[40:43], v[44:47]
    ds_read_b64_tr_b16 v[114:115], v5 offset:800
    v_cvt_pk_bf16_f32 v98, v100, v101
    v_mfma_f32_16x16x32_bf16 v[52:55], v[116:119], a[44:47], v[52:55]
    ds_read_b64_tr_b16 v[116:117], v5 offset:96
    v_cvt_pk_bf16_f32 v99, v102, v103
    buffer_store_dwordx4 v[80:83], v1, s[32:35], s53 offen offset:1024 sc1
    v_mfma_f32_16x16x32_bf16 v[8:11], v[120:123], a[48:51], v[8:11]
    ds_read_b64_tr_b16 v[118:119], v5 offset:864
    v_permlane16_swap_b32 v96, v98
    v_mfma_f32_16x16x32_bf16 v[16:19], v[120:123], a[52:55], v[16:19]
    ds_read_b64_tr_b16 v[120:121], v5 offset:160
    v_permlane16_swap_b32 v97, v99
    ds_write_b128 v3, v[88:91] offset:0
    v_mfma_f32_16x16x32_bf16 v[24:27], v[124:127], a[48:51], v[24:27]
    ds_read_b64_tr_b16 v[122:123], v5 offset:928
    v_mfma_f32_16x16x32_bf16 v[32:35], v[124:127], a[52:55], v[32:35]
    ds_read_b64_tr_b16 v[124:125], v5 offset:6208
    ds_write_b128 v3, v[96:99] offset:1024
    s_waitcnt lgkmcnt(5)
    v_mfma_f32_16x16x32_bf16 v[40:43], v[108:111], a[48:51], v[40:43]
    ds_read_b64_tr_b16 v[126:127], v5 offset:6976
    v_mfma_f32_16x16x32_bf16 v[48:51], v[108:111], a[52:55], v[48:51]
    ds_read_b64_tr_b16 v[108:109], v5 offset:6272
    ds_write_b32 v2, v104
L_q_join:
    v_mfma_f32_16x16x32_bf16 v[12:15], v[112:115], a[48:51], v[12:15]
    ds_read_b64_tr_b16 v[110:111], v5 offset:7040
    v_mfma_f32_16x16x32_bf16 v[20:23], v[112:115], a[52:55], v[20:23]
    s_barrier
    ds_read_b64_tr_b16 v[112:113], v5 offset:6336
    v_mfma_f32_16x16x32_bf16 v[28:31], v[116:119], a[48:51], v[28:31]
    ds_read_b64_tr_b16 v[114:115], v5 offset:7104
    v_mfma_f32_16x16x32_bf16 v[36:39], v[116:119], a[52:55], v[36:39]
    ds_read_b32 v107, v106 offset:208
    ds_read_b64_tr_b16 v[116:117], v5 offset:6240
    s_waitcnt lgkmcnt(4)
    v_mfma_f32_16x16x32_bf16 v[44:47], v[120:123], a[48:51], v[44:47]
    ds_read_b64_tr_b16 v[118:119], v5 offset:7008
    v_mfma_f32_16x16x32_bf16 v[52:55], v[120:123], a[52:55], v[52:55]
    ds_read_b64_tr_b16 v[120:121], v5 offset:6304
    v_mfma_f32_16x16x32_bf16 v[8:11], v[124:127], a[56:59], v[8:11]
    ds_read_b64_tr_b16 v[122:123], v5 offset:7072
    v_mfma_f32_16x16x32_bf16 v[16:19], v[124:127], a[60:63], v[16:19]
    ds_read_b64_tr_b16 v[124:125], v5 offset:6368
    v_mfma_f32_16x16x32_bf16 v[24:27], v[108:111], a[56:59], v[24:27]
    ds_read_b64_tr_b16 v[126:127], v5 offset:7136
    s_waitcnt lgkmcnt(6)
    v_cmp_ne_u32 vcc, 0, v107
    v_mfma_f32_16x16x32_bf16 v[32:35], v[108:111], a[60:63], v[32:35]
    s_cbranch_vccnz L_gated_mix__sliding_block__swiglu_ffn__prompt_kernel_c_32l
L_gated_mix__sliding_block__swiglu_ffn__prompt_kernel_c_32b:
    ds_read_b64_tr_b16 v[108:109], v7 offset:0
    s_waitcnt lgkmcnt(3)
    v_mfma_f32_16x16x32_bf16 v[40:43], v[112:115], a[56:59], v[40:43]
    ds_read_b64_tr_b16 v[110:111], v7 offset:768
    v_mfma_f32_16x16x32_bf16 v[48:51], v[112:115], a[60:63], v[48:51]
    ds_read_b64_tr_b16 v[112:113], v7 offset:32
    v_mfma_f32_16x16x32_bf16 v[12:15], v[116:119], a[56:59], v[12:15]
    ds_read_b64_tr_b16 v[114:115], v7 offset:800
    v_mfma_f32_16x16x32_bf16 v[20:23], v[116:119], a[60:63], v[20:23]
    ds_read_b64_tr_b16 v[116:117], v7 offset:6208
    v_mfma_f32_16x16x32_bf16 v[28:31], v[120:123], a[56:59], v[28:31]
    ds_read_b64_tr_b16 v[118:119], v7 offset:6976
    v_mfma_f32_16x16x32_bf16 v[36:39], v[120:123], a[60:63], v[36:39]
    ds_read_b64_tr_b16 v[120:121], v7 offset:6240
    s_waitcnt lgkmcnt(3)
    v_mfma_f32_16x16x32_bf16 v[44:47], v[124:127], a[56:59], v[44:47]
    ds_read_b64_tr_b16 v[122:123], v7 offset:7008
    v_mfma_f32_16x16x32_bf16 v[52:55], v[124:127], a[60:63], v[52:55]
    ds_read_b64_tr_b16 v[124:125], v7 offset:12416
    v_mfma_f32_16x16x32_bf16 v[8:11], v[108:111], a[64:67], v[8:11]
    ds_read_b64_tr_b16 v[126:127], v7 offset:13184
    v_mfma_f32_16x16x32_bf16 v[16:19], v[108:111], a[68:71], v[16:19]
    ds_read_b64_tr_b16 v[108:109], v7 offset:12448
    v_mfma_f32_16x16x32_bf16 v[12:15], v[112:115], a[64:67], v[12:15]
    ds_read_b64_tr_b16 v[110:111], v7 offset:13216
    v_mfma_f32_16x16x32_bf16 v[20:23], v[112:115], a[68:71], v[20:23]
    ds_read_b64_tr_b16 v[112:113], v7 offset:18624
    s_waitcnt lgkmcnt(3)
    v_mfma_f32_16x16x32_bf16 v[8:11], v[116:119], a[72:75], v[8:11]
    ds_read_b64_tr_b16 v[114:115], v7 offset:19392
    v_mfma_f32_16x16x32_bf16 v[16:19], v[116:119], a[76:79], v[16:19]
    ds_read_b64_tr_b16 v[116:117], v7 offset:18656
    v_mfma_f32_16x16x32_bf16 v[12:15], v[120:123], a[72:75], v[12:15]
    ds_read_b64_tr_b16 v[118:119], v7 offset:19424
    v_mfma_f32_16x16x32_bf16 v[20:23], v[120:123], a[76:79], v[20:23]
    ds_read_b64_tr_b16 v[120:121], v7 offset:24832
    v_mfma_f32_16x16x32_bf16 v[8:11], v[124:127], a[80:83], v[8:11]
    ds_read_b64_tr_b16 v[122:123], v7 offset:25600
    v_mfma_f32_16x16x32_bf16 v[16:19], v[124:127], a[84:87], v[16:19]
    ds_read_b64_tr_b16 v[124:125], v7 offset:24864
    s_waitcnt lgkmcnt(3)
    v_mfma_f32_16x16x32_bf16 v[12:15], v[108:111], a[80:83], v[12:15]
    ds_read_b64_tr_b16 v[126:127], v7 offset:25632
    v_mfma_f32_16x16x32_bf16 v[20:23], v[108:111], a[84:87], v[20:23]
    ds_read_b64_tr_b16 v[108:109], v7 offset:31040
    v_mfma_f32_16x16x32_bf16 v[8:11], v[112:115], a[88:91], v[8:11]
    ds_read_b64_tr_b16 v[110:111], v7 offset:31808
    v_mfma_f32_16x16x32_bf16 v[16:19], v[112:115], a[92:95], v[16:19]
    ds_read_b64_tr_b16 v[112:113], v7 offset:31072
    v_mfma_f32_16x16x32_bf16 v[12:15], v[116:119], a[88:91], v[12:15]
    ds_read_b64_tr_b16 v[114:115], v7 offset:31840
    v_mfma_f32_16x16x32_bf16 v[20:23], v[116:119], a[92:95], v[20:23]
    ds_read_b64_tr_b16 v[116:117], v7 offset:37248
    s_waitcnt lgkmcnt(3)
    v_mfma_f32_16x16x32_bf16 v[8:11], v[120:123], a[96:99], v[8:11]
    ds_read_b64_tr_b16 v[118:119], v7 offset:38016
    v_mfma_f32_16x16x32_bf16 v[16:19], v[120:123], a[100:103], v[16:19]
    ds_read_b64_tr_b16 v[120:121], v7 offset:37280
    v_mfma_f32_16x16x32_bf16 v[12:15], v[124:127], a[96:99], v[12:15]
    ds_read_b64_tr_b16 v[122:123], v7 offset:38048
    v_mfma_f32_16x16x32_bf16 v[20:23], v[124:127], a[100:103], v[20:23]
    ds_read_b64_tr_b16 v[124:125], v7 offset:43456
    v_mfma_f32_16x16x32_bf16 v[8:11], v[108:111], a[104:107], v[8:11]
    ds_read_b64_tr_b16 v[126:127], v7 offset:44224
    v_mfma_f32_16x16x32_bf16 v[16:19], v[108:111], a[108:111], v[16:19]
    ds_read_b64_tr_b16 v[108:109], v7 offset:43488
    s_waitcnt lgkmcnt(3)
    v_mfma_f32_16x16x32_bf16 v[12:15], v[112:115], a[104:107], v[12:15]
    ds_read_b64_tr_b16 v[110:111], v7 offset:44256
    v_mfma_f32_16x16x32_bf16 v[20:23], v[112:115], a[108:111], v[20:23]
    ds_read_b64_tr_b16 v[112:113], v7 offset:64
    v_mfma_f32_16x16x32_bf16 v[8:11], v[116:119], a[112:115], v[8:11]
    ds_read_b64_tr_b16 v[114:115], v7 offset:832
    v_mfma_f32_16x16x32_bf16 v[16:19], v[116:119], a[116:119], v[16:19]
    ds_read_b64_tr_b16 v[116:117], v7 offset:96
    v_mfma_f32_16x16x32_bf16 v[12:15], v[120:123], a[112:115], v[12:15]
    ds_read_b64_tr_b16 v[118:119], v7 offset:864
    v_mfma_f32_16x16x32_bf16 v[20:23], v[120:123], a[116:119], v[20:23]
    ds_read_b64_tr_b16 v[120:121], v7 offset:6272
    s_waitcnt lgkmcnt(3)
    v_mfma_f32_16x16x32_bf16 v[8:11], v[124:127], a[120:123], v[8:11]
    ds_read_b64_tr_b16 v[122:123], v7 offset:7040
    v_mfma_f32_16x16x32_bf16 v[16:19], v[124:127], a[124:127], v[16:19]
    ds_read_b64_tr_b16 v[124:125], v7 offset:6304
    v_mfma_f32_16x16x32_bf16 v[12:15], v[108:111], a[120:123], v[12:15]
    ds_read_b64_tr_b16 v[126:127], v7 offset:7072
    v_mfma_f32_16x16x32_bf16 v[20:23], v[108:111], a[124:127], v[20:23]
    ds_read_b64_tr_b16 v[108:109], v7 offset:12480
    v_mfma_f32_16x16x32_bf16 v[24:27], v[112:115], a[64:67], v[24:27]
    ds_read_b64_tr_b16 v[110:111], v7 offset:13248
    v_mfma_f32_16x16x32_bf16 v[32:35], v[112:115], a[68:71], v[32:35]
    ds_read_b64_tr_b16 v[112:113], v7 offset:12512
    s_waitcnt lgkmcnt(3)
    v_mfma_f32_16x16x32_bf16 v[28:31], v[116:119], a[64:67], v[28:31]
    ds_read_b64_tr_b16 v[114:115], v7 offset:13280
    v_mfma_f32_16x16x32_bf16 v[36:39], v[116:119], a[68:71], v[36:39]
    ds_read_b64_tr_b16 v[116:117], v7 offset:18688
    v_mfma_f32_16x16x32_bf16 v[24:27], v[120:123], a[72:75], v[24:27]
    ds_read_b64_tr_b16 v[118:119], v7 offset:19456
    v_mfma_f32_16x16x32_bf16 v[32:35], v[120:123], a[76:79], v[32:35]
    ds_read_b64_tr_b16 v[120:121], v7 offset:18720
    v_mul_f32 v1, s58, v8
    v_mfma_f32_16x16x32_bf16 v[28:31], v[124:127], a[72:75], v[28:31]
    ds_read_b64_tr_b16 v[122:123], v7 offset:19488
    v_mfma_f32_16x16x32_bf16 v[36:39], v[124:127], a[76:79], v[36:39]
    ds_read_b64_tr_b16 v[124:125], v7 offset:24896
    s_waitcnt lgkmcnt(3)
    v_mfma_f32_16x16x32_bf16 v[24:27], v[108:111], a[80:83], v[24:27]
    ds_read_b64_tr_b16 v[126:127], v7 offset:25664
    v_exp_f32 v1, v1
    v_mfma_f32_16x16x32_bf16 v[32:35], v[108:111], a[84:87], v[32:35]
    ds_read_b64_tr_b16 v[108:109], v7 offset:24928
    v_mul_f32 v2, s58, v9
    v_mfma_f32_16x16x32_bf16 v[28:31], v[112:115], a[80:83], v[28:31]
    ds_read_b64_tr_b16 v[110:111], v7 offset:25696
    v_mfma_f32_16x16x32_bf16 v[36:39], v[112:115], a[84:87], v[36:39]
    ds_read_b64_tr_b16 v[112:113], v7 offset:31104
    v_mfma_f32_16x16x32_bf16 v[24:27], v[116:119], a[88:91], v[24:27]
    ds_read_b64_tr_b16 v[114:115], v7 offset:31872
    v_exp_f32 v2, v2
    v_mfma_f32_16x16x32_bf16 v[32:35], v[116:119], a[92:95], v[32:35]
    ds_read_b64_tr_b16 v[116:117], v7 offset:31136
    v_mul_f32 v3, s58, v10
    s_waitcnt lgkmcnt(3)
    v_mfma_f32_16x16x32_bf16 v[28:31], v[120:123], a[88:91], v[28:31]
    ds_read_b64_tr_b16 v[118:119], v7 offset:31904
    v_mfma_f32_16x16x32_bf16 v[36:39], v[120:123], a[92:95], v[36:39]
    ds_read_b64_tr_b16 v[120:121], v7 offset:37312
    v_fma_f32 v1, v1, v4, v4
    v_mfma_f32_16x16x32_bf16 v[24:27], v[124:127], a[96:99], v[24:27]
    ds_read_b64_tr_b16 v[122:123], v7 offset:38080
    v_exp_f32 v3, v3
    v_mfma_f32_16x16x32_bf16 v[32:35], v[124:127], a[100:103], v[32:35]
    ds_read_b64_tr_b16 v[124:125], v7 offset:37344
    v_mul_f32 v104, s58, v11
    v_mfma_f32_16x16x32_bf16 v[28:31], v[108:111], a[96:99], v[28:31]
    ds_read_b64_tr_b16 v[126:127], v7 offset:38112
    v_rcp_f32 v1, v1
    v_mfma_f32_16x16x32_bf16 v[36:39], v[108:111], a[100:103], v[36:39]
    ds_read_b64_tr_b16 v[108:109], v7 offset:43520
    v_fma_f32 v2, v2, v4, v4
    s_waitcnt lgkmcnt(3)
    v_mfma_f32_16x16x32_bf16 v[24:27], v[112:115], a[104:107], v[24:27]
    ds_read_b64_tr_b16 v[110:111], v7 offset:44288
    v_exp_f32 v104, v104
    v_mfma_f32_16x16x32_bf16 v[32:35], v[112:115], a[108:111], v[32:35]
    ds_read_b64_tr_b16 v[112:113], v7 offset:43552
    v_mul_f32 v8, v8, v1
    v_mul_f32 v1, s58, v12
    v_mfma_f32_16x16x32_bf16 v[28:31], v[116:119], a[104:107], v[28:31]
    ds_read_b64_tr_b16 v[114:115], v7 offset:44320
    v_rcp_f32 v2, v2
    v_mfma_f32_16x16x32_bf16 v[36:39], v[116:119], a[108:111], v[36:39]
    ds_read_b64_tr_b16 v[116:117], v7 offset:128
    v_fma_f32 v3, v3, v4, v4
    v_mfma_f32_16x16x32_bf16 v[24:27], v[120:123], a[112:115], v[24:27]
    ds_read_b64_tr_b16 v[118:119], v7 offset:896
    v_exp_f32 v1, v1
    v_mfma_f32_16x16x32_bf16 v[32:35], v[120:123], a[116:119], v[32:35]
    ds_read_b64_tr_b16 v[120:121], v7 offset:160
    v_mul_f32 v9, v9, v2
    v_mul_f32 v2, s58, v13
    s_waitcnt lgkmcnt(3)
    v_mfma_f32_16x16x32_bf16 v[28:31], v[124:127], a[112:115], v[28:31]
    ds_read_b64_tr_b16 v[122:123], v7 offset:928
    v_rcp_f32 v3, v3
    v_mfma_f32_16x16x32_bf16 v[36:39], v[124:127], a[116:119], v[36:39]
    s_waitcnt vmcnt(0)
    s_barrier
    ds_read_b64_tr_b16 v[124:125], v7 offset:6336
    v_fma_f32 v104, v104, v4, v4
    v_mfma_f32_16x16x32_bf16 v[24:27], v[108:111], a[120:123], v[24:27]
    ds_read_b64_tr_b16 v[126:127], v7 offset:7104
    v_exp_f32 v2, v2
    v_mfma_f32_16x16x32_bf16 v[32:35], v[108:111], a[124:127], v[32:35]
    ds_read_b64_tr_b16 v[108:109], v7 offset:6368
    v_mul_f32 v10, v10, v3
    v_mul_f32 v3, s58, v14
    v_mfma_f32_16x16x32_bf16 v[28:31], v[112:115], a[120:123], v[28:31]
    ds_read_b64_tr_b16 v[110:111], v7 offset:7136
    v_rcp_f32 v104, v104
    v_mfma_f32_16x16x32_bf16 v[36:39], v[112:115], a[124:127], v[36:39]
    ds_read_b64_tr_b16 v[112:113], v7 offset:12544
    v_fma_f32 v1, v1, v4, v4
    s_waitcnt lgkmcnt(3)
    v_mfma_f32_16x16x32_bf16 v[40:43], v[116:119], a[64:67], v[40:43]
    ds_read_b64_tr_b16 v[114:115], v7 offset:13312
    v_exp_f32 v3, v3
    v_mfma_f32_16x16x32_bf16 v[48:51], v[116:119], a[68:71], v[48:51]
    ds_read_b64_tr_b16 v[116:117], v7 offset:12576
    v_mul_f32 v11, v11, v104
    v_mul_f32 v104, s58, v15
    v_mfma_f32_16x16x32_bf16 v[44:47], v[120:123], a[64:67], v[44:47]
    ds_read_b64_tr_b16 v[118:119], v7 offset:13344
    v_rcp_f32 v1, v1
    v_mfma_f32_16x16x32_bf16 v[52:55], v[120:123], a[68:71], v[52:55]
    ds_read_b64_tr_b16 v[120:121], v7 offset:18752
    v_fma_f32 v2, v2, v4, v4
    v_mfma_f32_16x16x32_bf16 v[40:43], v[124:127], a[72:75], v[40:43]
    ds_read_b64_tr_b16 v[122:123], v7 offset:19520
    v_exp_f32 v104, v104
    v_mfma_f32_16x16x32_bf16 v[48:51], v[124:127], a[76:79], v[48:51]
    ds_read_b64_tr_b16 v[124:125], v7 offset:18784
    v_mul_f32 v12, v12, v1
    v_mul_f32 v1, s58, v16
    s_waitcnt lgkmcnt(3)
    v_mfma_f32_16x16x32_bf16 v[44:47], v[108:111], a[72:75], v[44:47]
    ds_read_b64_tr_b16 v[126:127], v7 offset:19552
    v_rcp_f32 v2, v2
    v_mfma_f32_16x16x32_bf16 v[52:55], v[108:111], a[76:79], v[52:55]
    ds_read_b64_tr_b16 v[108:109], v7 offset:24960
    v_fma_f32 v3, v3, v4, v4
    v_mfma_f32_16x16x32_bf16 v[40:43], v[112:115], a[80:83], v[40:43]
    ds_read_b64_tr_b16 v[110:111], v7 offset:25728
    v_exp_f32 v1, v1
    v_mfma_f32_16x16x32_bf16 v[48:51], v[112:115], a[84:87], v[48:51]
    ds_read_b64_tr_b16 v[112:113], v7 offset:24992
    v_mul_f32 v13, v13, v2
    v_mul_f32 v2, s58, v17
    v_mfma_f32_16x16x32_bf16 v[44:47], v[116:119], a[80:83], v[44:47]
    ds_read_b64_tr_b16 v[114:115], v7 offset:25760
    v_rcp_f32 v3, v3
    v_mfma_f32_16x16x32_bf16 v[52:55], v[116:119], a[84:87], v[52:55]
    ds_read_b64_tr_b16 v[116:117], v7 offset:31168
    v_fma_f32 v104, v104, v4, v4
    s_waitcnt lgkmcnt(3)
    v_mfma_f32_16x16x32_bf16 v[40:43], v[120:123], a[88:91], v[40:43]
    ds_read_b64_tr_b16 v[118:119], v7 offset:31936
    v_exp_f32 v2, v2
    v_mfma_f32_16x16x32_bf16 v[48:51], v[120:123], a[92:95], v[48:51]
    ds_read_b64_tr_b16 v[120:121], v7 offset:31200
    v_mul_f32 v14, v14, v3
    v_mul_f32 v3, s58, v18
    v_mfma_f32_16x16x32_bf16 v[44:47], v[124:127], a[88:91], v[44:47]
    ds_read_b64_tr_b16 v[122:123], v7 offset:31968
    v_rcp_f32 v104, v104
    v_mfma_f32_16x16x32_bf16 v[52:55], v[124:127], a[92:95], v[52:55]
    ds_read_b64_tr_b16 v[124:125], v7 offset:37376
    v_fma_f32 v1, v1, v105, v105
    v_mfma_f32_16x16x32_bf16 v[40:43], v[108:111], a[96:99], v[40:43]
    ds_read_b64_tr_b16 v[126:127], v7 offset:38144
    v_exp_f32 v3, v3
    v_mfma_f32_16x16x32_bf16 v[48:51], v[108:111], a[100:103], v[48:51]
    ds_read_b32 v107, v106 offset:224
    ds_read_b64_tr_b16 v[108:109], v7 offset:37408
    v_mul_f32 v15, v15, v104
    v_mul_f32 v104, s58, v19
    s_waitcnt lgkmcnt(4)
    v_mfma_f32_16x16x32_bf16 v[44:47], v[112:115], a[96:99], v[44:47]
    ds_read_b64_tr_b16 v[110:111], v7 offset:38176
    v_rcp_f32 v1, v1
    v_mfma_f32_16x16x32_bf16 v[52:55], v[112:115], a[100:103], v[52:55]
    ds_read_b64_tr_b16 v[112:113], v7 offset:43584
    v_fma_f32 v2, v2, v105, v105
    v_mfma_f32_16x16x32_bf16 v[40:43], v[116:119], a[104:107], v[40:43]
    ds_read_b64_tr_b16 v[114:115], v7 offset:44352
    v_exp_f32 v104, v104
    v_mfma_f32_16x16x32_bf16 v[48:51], v[116:119], a[108:111], v[48:51]
    ds_read_b64_tr_b16 v[116:117], v7 offset:43616
    v_mul_f32 v16, v16, v1
    v_mul_f32 v1, s58, v20
    v_mfma_f32_16x16x32_bf16 v[44:47], v[120:123], a[104:107], v[44:47]
    ds_read_b64_tr_b16 v[118:119], v7 offset:44384
    s_waitcnt lgkmcnt(6)
    v_cmp_ne_u32 vcc, 0, v107
    v_rcp_f32 v2, v2
    v_mfma_f32_16x16x32_bf16 v[52:55], v[120:123], a[108:111], v[52:55]
    s_cbranch_vccnz L_gated_mix__sliding_block__swiglu_ffn__prompt_kernel_c_33l
L_gated_mix__sliding_block__swiglu_ffn__prompt_kernel_c_33b:
    ds_read_b64_tr_b16 v[120:121], v5 offset:12544
    v_fma_f32 v3, v3, v105, v105
    s_waitcnt lgkmcnt(3)
    v_mfma_f32_16x16x32_bf16 v[40:43], v[124:127], a[112:115], v[40:43]
    ds_read_b64_tr_b16 v[122:123], v5 offset:13312
    v_exp_f32 v1, v1
    v_mfma_f32_16x16x32_bf16 v[48:51], v[124:127], a[116:119], v[48:51]
    ds_read_b64_tr_b16 v[124:125], v5 offset:12608
    v_mul_f32 v17, v17, v2
    v_mul_f32 v2, s58, v21
    v_mfma_f32_16x16x32_bf16 v[44:47], v[108:111], a[112:115], v[44:47]
    ds_read_b64_tr_b16 v[126:127], v5 offset:13376
    v_rcp_f32 v3, v3
    v_mfma_f32_16x16x32_bf16 v[52:55], v[108:111], a[116:119], v[52:55]
    ds_read_b64_tr_b16 v[108:109], v5 offset:12672
    v_fma_f32 v104, v104, v105, v105
    v_mfma_f32_16x16x32_bf16 v[40:43], v[112:115], a[120:123], v[40:43]
    ds_read_b64_tr_b16 v[110:111], v5 offset:13440
    v_exp_f32 v2, v2
    v_mfma_f32_16x16x32_bf16 v[48:51], v[112:115], a[124:127], v[48:51]
    ds_read_b64_tr_b16 v[112:113], v5 offset:12576
    v_mul_f32 v18, v18, v3
    v_mul_f32 v3, s58, v22
    s_waitcnt lgkmcnt(3)
    v_mfma_f32_16x16x32_bf16 v[44:47], v[116:119], a[120:123], v[44:47]
    ds_read_b64_tr_b16 v[114:115], v5 offset:13344
    v_rcp_f32 v104, v104
    v_mfma_f32_16x16x32_bf16 v[52:55], v[116:119], a[124:127], v[52:55]
    ds_read_b64_tr_b16 v[116:117], v5 offset:12640
    v_fma_f32 v1, v1, v105, v105
    v_mfma_f32_16x16x32_bf16 v[56:59], v[120:123], a[0:3], 0
    ds_read_b64_tr_b16 v[118:119], v5 offset:13408
    v_exp_f32 v3, v3
    v_mfma_f32_16x16x32_bf16 v[64:67], v[120:123], a[4:7], 0
    ds_read_b64_tr_b16 v[120:121], v5 offset:12704
    v_mul_f32 v19, v19, v104
    v_mul_f32 v104, s58, v23
    v_mfma_f32_16x16x32_bf16 v[72:75], v[124:127], a[0:3], 0
    ds_read_b64_tr_b16 v[122:123], v5 offset:13472
    v_rcp_f32 v1, v1
    v_mfma_f32_16x16x32_bf16 v[80:83], v[124:127], a[4:7], 0
    ds_read_b64_tr_b16 v[124:125], v5 offset:18752
    v_fma_f32 v2, v2, v105, v105
    s_waitcnt lgkmcnt(3)
    v_mfma_f32_16x16x32_bf16 v[88:91], v[108:111], a[0:3], 0
    ds_read_b64_tr_b16 v[126:127], v5 offset:19520
    v_exp_f32 v104, v104
    v_mfma_f32_16x16x32_bf16 v[96:99], v[108:111], a[4:7], 0
    ds_read_b64_tr_b16 v[108:109], v5 offset:18816
    v_mul_f32 v20, v20, v1
    v_mul_f32 v1, s58, v24
    v_mfma_f32_16x16x32_bf16 v[60:63], v[112:115], a[0:3], 0
    ds_read_b64_tr_b16 v[110:111], v5 offset:19584
    v_rcp_f32 v2, v2
    v_mfma_f32_16x16x32_bf16 v[68:71], v[112:115], a[4:7], 0
    ds_read_b64_tr_b16 v[112:113], v5 offset:18880
    v_fma_f32 v3, v3, v105, v105
    v_mfma_f32_16x16x32_bf16 v[76:79], v[116:119], a[0:3], 0
    ds_read_b64_tr_b16 v[114:115], v5 offset:19648
    v_exp_f32 v1, v1
    v_mfma_f32_16x16x32_bf16 v[84:87], v[116:119], a[4:7], 0
    ds_read_b64_tr_b16 v[116:117], v5 offset:18784
    v_mul_f32 v21, v21, v2
    v_mul_f32 v2, s58, v25
    s_waitcnt lgkmcnt(3)
    v_mfma_f32_16x16x32_bf16 v[92:95], v[120:123], a[0:3], 0
    ds_read_b64_tr_b16 v[118:119], v5 offset:19552
    v_rcp_f32 v3, v3
    v_mfma_f32_16x16x32_bf16 v[100:103], v[120:123], a[4:7], 0
    ds_read_b64_tr_b16 v[120:121], v5 offset:18848
    v_fma_f32 v104, v104, v105, v105
    v_mfma_f32_16x16x32_bf16 v[56:59], v[124:127], a[8:11], v[56:59]
    ds_read_b64_tr_b16 v[122:123], v5 offset:19616
    v_exp_f32 v2, v2
    v_mfma_f32_16x16x32_bf16 v[64:67], v[124:127], a[12:15], v[64:67]
    ds_read_b64_tr_b16 v[124:125], v5 offset:18912
    v_mul_f32 v22, v22, v3
    v_mul_f32 v3, s58, v26
    v_mfma_f32_16x16x32_bf16 v[72:75], v[108:111], a[8:11], v[72:75]
    ds_read_b64_tr_b16 v[126:127], v5 offset:19680
    v_rcp_f32 v104, v104
    v_mfma_f32_16x16x32_bf16 v[80:83], v[108:111], a[12:15], v[80:83]
    ds_read_b64_tr_b16 v[108:109], v5 offset:25088
    v_fma_f32 v1, v1, v4, v4
    s_waitcnt lgkmcnt(3)
    v_mfma_f32_16x16x32_bf16 v[88:91], v[112:115], a[8:11], v[88:91]
    ds_read_b64_tr_b16 v[110:111], v5 offset:25856
    v_exp_f32 v3, v3
    v_mfma_f32_16x16x32_bf16 v[96:99], v[112:115], a[12:15], v[96:99]
    ds_read_b64_tr_b16 v[112:113], v5 offset:25152
    v_mul_f32 v23, v23, v104
    v_mul_f32 v104, s58, v27
    v_mfma_f32_16x16x32_bf16 v[60:63], v[116:119], a[8:11], v[60:63]
    ds_read_b64_tr_b16 v[114:115], v5 offset:25920
    v_rcp_f32 v1, v1
    v_mfma_f32_16x16x32_bf16 v[68:71], v[116:119], a[12:15], v[68:71]
    ds_read_b64_tr_b16 v[116:117], v5 offset:25216
    v_fma_f32 v2, v2, v4, v4
    v_mfma_f32_16x16x32_bf16 v[76:79], v[120:123], a[8:11], v[76:79]
    ds_read_b64_tr_b16 v[118:119], v5 offset:25984
    v_exp_f32 v104, v104
    v_mfma_f32_16x16x32_bf16 v[84:87], v[120:123], a[12:15], v[84:87]
    ds_read_b64_tr_b16 v[120:121], v5 offset:25120
    v_mul_f32 v24, v24, v1
    v_mul_f32 v1, s58, v28
    s_waitcnt lgkmcnt(3)
    v_mfma_f32_16x16x32_bf16 v[92:95], v[124:127], a[8:11], v[92:95]
    ds_read_b64_tr_b16 v[122:123], v5 offset:25888
    v_rcp_f32 v2, v2
    v_mfma_f32_16x16x32_bf16 v[100:103], v[124:127], a[12:15], v[100:103]
    ds_read_b64_tr_b16 v[124:125], v5 offset:25184
    v_fma_f32 v3, v3, v4, v4
    v_mfma_f32_16x16x32_bf16 v[56:59], v[108:111], a[16:19], v[56:59]
    ds_read_b64_tr_b16 v[126:127], v5 offset:25952
    v_exp_f32 v1, v1
    v_mfma_f32_16x16x32_bf16 v[64:67], v[108:111], a[20:23], v[64:67]
    ds_read_b64_tr_b16 v[108:109], v5 offset:25248
    v_mul_f32 v25, v25, v2
    v_mul_f32 v2, s58, v29
    v_mfma_f32_16x16x32_bf16 v[72:75], v[112:115], a[16:19], v[72:75]
    ds_read_b64_tr_b16 v[110:111], v5 offset:26016
    v_rcp_f32 v3, v3
    v_mfma_f32_16x16x32_bf16 v[80:83], v[112:115], a[20:23], v[80:83]
    ds_read_b64_tr_b16 v[112:113], v5 offset:31296
    v_fma_f32 v104, v104, v4, v4
    s_waitcnt lgkmcnt(3)
    v_mfma_f32_16x16x32_bf16 v[88:91], v[116:119], a[16:19], v[88:91]
    ds_read_b64_tr_b16 v[114:115], v5 offset:32064
    v_exp_f32 v2, v2
    v_mfma_f32_16x16x32_bf16 v[96:99], v[116:119], a[20:23], v[96:99]
    ds_read_b64_tr_b16 v[116:117], v5 offset:31360
    v_mul_f32 v26, v26, v3
    v_mul_f32 v3, s58, v30
    v_mfma_f32_16x16x32_bf16 v[60:63], v[120:123], a[16:19], v[60:63]
    ds_read_b64_tr_b16 v[118:119], v5 offset:32128
    v_rcp_f32 v104, v104
    v_mfma_f32_16x16x32_bf16 v[68:71], v[120:123], a[20:23], v[68:71]
    ds_read_b64_tr_b16 v[120:121], v5 offset:31424
    v_fma_f32 v1, v1, v4, v4
    v_mfma_f32_16x16x32_bf16 v[76:79], v[124:127], a[16:19], v[76:79]
    ds_read_b64_tr_b16 v[122:123], v5 offset:32192
    v_exp_f32 v3, v3
    v_mfma_f32_16x16x32_bf16 v[84:87], v[124:127], a[20:23], v[84:87]
    ds_read_b32 v107, v106 offset:240
    ds_read_b64_tr_b16 v[124:125], v5 offset:31328
    v_mul_f32 v27, v27, v104
    v_mul_f32 v104, s58, v31
    s_waitcnt lgkmcnt(4)
    v_mfma_f32_16x16x32_bf16 v[92:95], v[108:111], a[16:19], v[92:95]
    ds_read_b64_tr_b16 v[126:127], v5 offset:32096
    v_rcp_f32 v1, v1
    v_mfma_f32_16x16x32_bf16 v[100:103], v[108:111], a[20:23], v[100:103]
    ds_read_b64_tr_b16 v[108:109], v5 offset:31392
    v_fma_f32 v2, v2, v4, v4
    v_mfma_f32_16x16x32_bf16 v[56:59], v[112:115], a[24:27], v[56:59]
    ds_read_b64_tr_b16 v[110:111], v5 offset:32160
    v_exp_f32 v104, v104
    v_mfma_f32_16x16x32_bf16 v[64:67], v[112:115], a[28:31], v[64:67]
    ds_read_b64_tr_b16 v[112:113], v5 offset:31456
    v_mul_f32 v28, v28, v1
    v_mul_f32 v1, s58, v32
    v_mfma_f32_16x16x32_bf16 v[72:75], v[116:119], a[24:27], v[72:75]
    ds_read_b64_tr_b16 v[114:115], v5 offset:32224
    s_waitcnt lgkmcnt(6)
    v_cmp_ne_u32 vcc, 0, v107
    v_rcp_f32 v2, v2
    v_mfma_f32_16x16x32_bf16 v[80:83], v[116:119], a[28:31], v[80:83]
    s_cbranch_vccnz L_gated_mix__sliding_block__swiglu_ffn__prompt_kernel_c_34l
L_gated_mix__sliding_block__swiglu_ffn__prompt_kernel_c_34b:
    ds_read_b64_tr_b16 v[116:117], v5 offset:37632
    v_fma_f32 v3, v3, v4, v4
    s_waitcnt lgkmcnt(3)
    v_mfma_f32_16x16x32_bf16 v[88:91], v[120:123], a[24:27], v[88:91]
    ds_read_b64_tr_b16 v[118:119], v5 offset:38400
    v_exp_f32 v1, v1
    v_mfma_f32_16x16x32_bf16 v[96:99], v[120:123], a[28:31], v[96:99]
    ds_read_b64_tr_b16 v[120:121], v5 offset:37696
    v_mul_f32 v29, v29, v2
    v_mul_f32 v2, s58, v33
    v_mfma_f32_16x16x32_bf16 v[60:63], v[124:127], a[24:27], v[60:63]
    ds_read_b64_tr_b16 v[122:123], v5 offset:38464
    v_rcp_f32 v3, v3
    v_mfma_f32_16x16x32_bf16 v[68:71], v[124:127], a[28:31], v[68:71]
    s_barrier
    ds_read_b64_tr_b16 v[124:125], v5 offset:37760
    v_fma_f32 v104, v104, v4, v4
    v_mfma_f32_16x16x32_bf16 v[76:79], v[108:111], a[24:27], v[76:79]
    ds_read_b64_tr_b16 v[126:127], v5 offset:38528
    v_exp_f32 v2, v2
    v_mfma_f32_16x16x32_bf16 v[84:87], v[108:111], a[28:31], v[84:87]
    ds_read_b64_tr_b16 v[108:109], v5 offset:37664
    v_mul_f32 v30, v30, v3
    v_mul_f32 v3, s58, v34
    s_waitcnt lgkmcnt(3)
    v_mfma_f32_16x16x32_bf16 v[92:95], v[112:115], a[24:27], v[92:95]
    ds_read_b64_tr_b16 v[110:111], v5 offset:38432
    v_rcp_f32 v104, v104
    v_mfma_f32_16x16x32_bf16 v[100:103], v[112:115], a[28:31], v[100:103]
    ds_read_b64_tr_b16 v[112:113], v5 offset:37728
    v_fma_f32 v1, v1, v105, v105
    v_mfma_f32_16x16x32_bf16 v[56:59], v[116:119], a[32:35], v[56:59]
    ds_read_b64_tr_b16 v[114:115], v5 offset:38496
    v_exp_f32 v3, v3
    v_mfma_f32_16x16x32_bf16 v[64:67], v[116:119], a[36:39], v[64:67]
    ds_read_b64_tr_b16 v[116:117], v5 offset:37792
    v_mul_f32 v31, v31, v104
    v_mul_f32 v104, s58, v35
    v_mfma_f32_16x16x32_bf16 v[72:75], v[120:123], a[32:35], v[72:75]
    ds_read_b64_tr_b16 v[118:119], v5 offset:38560
    v_rcp_f32 v1, v1
    v_mfma_f32_16x16x32_bf16 v[80:83], v[120:123], a[36:39], v[80:83]
    ds_read_b64_tr_b16 v[120:121], v5 offset:43840
    v_fma_f32 v2, v2, v105, v105
    s_waitcnt lgkmcnt(3)
    v_mfma_f32_16x16x32_bf16 v[88:91], v[124:127], a[32:35], v[88:91]
    ds_read_b64_tr_b16 v[122:123], v5 offset:44608
    v_exp_f32 v104, v104
    v_mfma_f32_16x16x32_bf16 v[96:99], v[124:127], a[36:39], v[96:99]
    ds_read_b64_tr_b16 v[124:125], v5 offset:43904
    v_mul_f32 v32, v32, v1
    v_mul_f32 v1, s58, v36
    v_mfma_f32_16x16x32_bf16 v[60:63], v[108:111], a[32:35], v[60:63]
    ds_read_b64_tr_b16 v[126:127], v5 offset:44672
    v_rcp_f32 v2, v2
    v_mfma_f32_16x16x32_bf16 v[68:71], v[108:111], a[36:39], v[68:71]
    ds_read_b64_tr_b16 v[108:109], v5 offset:43968
    v_fma_f32 v3, v3, v105, v105
    v_mfma_f32_16x16x32_bf16 v[76:79], v[112:115], a[32:35], v[76:79]
    ds_read_b64_tr_b16 v[110:111], v5 offset:44736
    v_exp_f32 v1, v1
    v_mfma_f32_16x16x32_bf16 v[84:87], v[112:115], a[36:39], v[84:87]
    ds_read_b64_tr_b16 v[112:113], v5 offset:43872
    v_mul_f32 v33, v33, v2
    v_mul_f32 v2, s58, v37
    s_waitcnt lgkmcnt(3)
    v_mfma_f32_16x16x32_bf16 v[92:95], v[116:119], a[32:35], v[92:95]
    ds_read_b64_tr_b16 v[114:115], v5 offset:44640
    v_rcp_f32 v3, v3
    v_mfma_f32_16x16x32_bf16 v[100:103], v[116:119], a[36:39], v[100:103]
    ds_read_b64_tr_b16 v[116:117], v5 offset:43936
    v_fma_f32 v104, v104, v105, v105
    v_mfma_f32_16x16x32_bf16 v[56:59], v[120:123], a[40:43], v[56:59]
    ds_read_b64_tr_b16 v[118:119], v5 offset:44704
    v_exp_f32 v2, v2
    v_mfma_f32_16x16x32_bf16 v[64:67], v[120:123], a[44:47], v[64:67]
    ds_read_b64_tr_b16 v[120:121], v5 offset:44000
    v_mul_f32 v34, v34, v3
    v_mul_f32 v3, s58, v38
    v_mfma_f32_16x16x32_bf16 v[72:75], v[124:127], a[40:43], v[72:75]
    ds_read_b64_tr_b16 v[122:123], v5 offset:44768
    v_rcp_f32 v104, v104
    v_mfma_f32_16x16x32_bf16 v[80:83], v[124:127], a[44:47], v[80:83]
    ds_read_b64_tr_b16 v[124:125], v7 offset:49664
    v_fma_f32 v1, v1, v105, v105
    s_waitcnt lgkmcnt(3)
    v_mfma_f32_16x16x32_bf16 v[88:91], v[108:111], a[40:43], v[88:91]
    ds_read_b64_tr_b16 v[126:127], v7 offset:50432
    v_exp_f32 v3, v3
    v_mfma_f32_16x16x32_bf16 v[96:99], v[108:111], a[44:47], v[96:99]
    ds_read_b64_tr_b16 v[108:109], v7 offset:49728
    v_mul_f32 v35, v35, v104
    v_mul_f32 v104, s58, v39
    v_mfma_f32_16x16x32_bf16 v[60:63], v[112:115], a[40:43], v[60:63]
    ds_read_b64_tr_b16 v[110:111], v7 offset:50496
    v_rcp_f32 v1, v1
    v_mfma_f32_16x16x32_bf16 v[68:71], v[112:115], a[44:47], v[68:71]
    ds_read_b64_tr_b16 v[112:113], v7 offset:49792
    v_fma_f32 v2, v2, v105, v105
    v_mfma_f32_16x16x32_bf16 v[76:79], v[116:119], a[40:43], v[76:79]
    ds_read_b64_tr_b16 v[114:115], v7 offset:50560
    v_exp_f32 v104, v104
    v_mfma_f32_16x16x32_bf16 v[84:87], v[116:119], a[44:47], v[84:87]
    ds_read_b64_tr_b16 v[116:117], v7 offset:49696
    v_mul_f32 v36, v36, v1
    v_mul_f32 v1, s58, v40
    s_waitcnt lgkmcnt(3)
    v_mfma_f32_16x16x32_bf16 v[92:95], v[120:123], a[40:43], v[92:95]
    ds_read_b64_tr_b16 v[118:119], v7 offset:50464
    v_rcp_f32 v2, v2
    v_mfma_f32_16x16x32_bf16 v[100:103], v[120:123], a[44:47], v[100:103]
    ds_read_b64_tr_b16 v[120:121], v7 offset:49760
    v_fma_f32 v3, v3, v105, v105
    v_mfma_f32_16x16x32_bf16 v[56:59], v[124:127], a[48:51], v[56:59]
    ds_read_b64_tr_b16 v[122:123], v7 offset:50528
    v_exp_f32 v1, v1
    v_mfma_f32_16x16x32_bf16 v[64:67], v[124:127], a[52:55], v[64:67]
    ds_read_b64_tr_b16 v[124:125], v7 offset:49824
    v_mul_f32 v37, v37, v2
    v_mul_f32 v2, s58, v41
    v_mfma_f32_16x16x32_bf16 v[72:75], v[108:111], a[48:51], v[72:75]
    ds_read_b64_tr_b16 v[126:127], v7 offset:50592
    v_rcp_f32 v3, v3
    v_mfma_f32_16x16x32_bf16 v[80:83], v[108:111], a[52:55], v[80:83]
    ds_read_b64_tr_b16 v[108:109], v7 offset:55872
    v_fma_f32 v104, v104, v105, v105
    s_waitcnt lgkmcnt(3)
    v_mfma_f32_16x16x32_bf16 v[88:91], v[112:115], a[48:51], v[88:91]
    ds_read_b64_tr_b16 v[110:111], v7 offset:56640
    v_exp_f32 v2, v2
    v_mfma_f32_16x16x32_bf16 v[96:99], v[112:115], a[52:55], v[96:99]
    ds_read_b64_tr_b16 v[112:113], v7 offset:55936
    v_mul_f32 v38, v38, v3
    v_mul_f32 v3, s58, v42
    v_mfma_f32_16x16x32_bf16 v[60:63], v[116:119], a[48:51], v[60:63]
    ds_read_b64_tr_b16 v[114:115], v7 offset:56704
    v_rcp_f32 v104, v104
    v_mfma_f32_16x16x32_bf16 v[68:71], v[116:119], a[52:55], v[68:71]
    ds_read_b64_tr_b16 v[116:117], v7 offset:56000
    v_fma_f32 v1, v1, v4, v4
    v_mfma_f32_16x16x32_bf16 v[76:79], v[120:123], a[48:51], v[76:79]
    ds_read_b64_tr_b16 v[118:119], v7 offset:56768
    v_exp_f32 v3, v3
    v_mfma_f32_16x16x32_bf16 v[84:87], v[120:123], a[52:55], v[84:87]
    ds_read_b32 v107, v106 offset:256
    ds_read_b64_tr_b16 v[120:121], v7 offset:55904
    v_mul_f32 v39, v39, v104
    v_mul_f32 v104, s58, v43
    s_waitcnt lgkmcnt(4)
    v_mfma_f32_16x16x32_bf16 v[92:95], v[124:127], a[48:51], v[92:95]
    ds_read_b64_tr_b16 v[122:123], v7 offset:56672
    v_rcp_f32 v1, v1
    v_mfma_f32_16x16x32_bf16 v[100:103], v[124:127], a[52:55], v[100:103]
    ds_read_b64_tr_b16 v[124:125], v7 offset:55968
    v_fma_f32 v2, v2, v4, v4
    v_mfma_f32_16x16x32_bf16 v[56:59], v[108:111], a[56:59], v[56:59]
    ds_read_b64_tr_b16 v[126:127], v7 offset:56736
    v_exp_f32 v104, v104
    v_mfma_f32_16x16x32_bf16 v[64:67], v[108:111], a[60:63], v[64:67]
    ds_read_b64_tr_b16 v[108:109], v7 offset:56032
    v_mul_f32 v40, v40, v1
    v_mul_f32 v1, s58, v44
    v_mfma_f32_16x16x32_bf16 v[72:75], v[112:115], a[56:59], v[72:75]
    ds_read_b64_tr_b16 v[110:111], v7 offset:56800
    s_waitcnt lgkmcnt(6)
    v_cmp_ne_u32 vcc, 0, v107
    v_rcp_f32 v2, v2
    v_mfma_f32_16x16x32_bf16 v[80:83], v[112:115], a[60:63], v[80:83]
    s_cbranch_vccnz L_gated_mix__sliding_block__swiglu_ffn__prompt_kernel_c_35l
L_gated_mix__sliding_block__swiglu_ffn__prompt_kernel_c_35b:
    ds_read_b64_tr_b16 v[112:113], v5 offset:0
    v_fma_f32 v3, v3, v4, v4
    s_waitcnt lgkmcnt(3)
    v_mfma_f32_16x16x32_bf16 v[88:91], v[116:119], a[56:59], v[88:91]
    ds_read_b64_tr_b16 v[114:115], v5 offset:768
    v_exp_f32 v1, v1
    v_mfma_f32_16x16x32_bf16 v[96:99], v[116:119], a[60:63], v[96:99]
    ds_read_b64_tr_b16 v[116:117], v5 offset:32
    v_mul_f32 v41, v41, v2
    v_mul_f32 v2, s58, v45
    v_mfma_f32_16x16x32_bf16 v[60:63], v[120:123], a[56:59], v[60:63]
    ds_read_b64_tr_b16 v[118:119], v5 offset:800
    v_rcp_f32 v3, v3
    v_mfma_f32_16x16x32_bf16 v[68:71], v[120:123], a[60:63], v[68:71]
    ds_read_b64_tr_b16 v[120:121], v5 offset:6208
    v_fma_f32 v104, v104, v4, v4
    v_mfma_f32_16x16x32_bf16 v[76:79], v[124:127], a[56:59], v[76:79]
    ds_read_b64_tr_b16 v[122:123], v5 offset:6976
    v_exp_f32 v2, v2
    v_mfma_f32_16x16x32_bf16 v[84:87], v[124:127], a[60:63], v[84:87]
    ds_read_b64_tr_b16 v[124:125], v5 offset:6240
    v_mul_f32 v42, v42, v3
    v_mul_f32 v3, s58, v46
    s_waitcnt lgkmcnt(3)
    v_mfma_f32_16x16x32_bf16 v[92:95], v[108:111], a[56:59], v[92:95]
    ds_read_b64_tr_b16 v[126:127], v5 offset:7008
    v_rcp_f32 v104, v104
    v_mfma_f32_16x16x32_bf16 v[100:103], v[108:111], a[60:63], v[100:103]
    ds_read_b64_tr_b16 v[108:109], v6 offset:0
    v_fma_f32 v1, v1, v4, v4
    v_mfma_f32_16x16x32_bf16 v[56:59], v[112:115], a[64:67], v[56:59]
    ds_read_b64_tr_b16 v[110:111], v6 offset:768
    v_exp_f32 v3, v3
    v_mfma_f32_16x16x32_bf16 v[64:67], v[112:115], a[68:71], v[64:67]
    ds_read_b64_tr_b16 v[112:113], v6 offset:32
    v_mul_f32 v43, v43, v104
    v_mul_f32 v104, s58, v47
    v_mfma_f32_16x16x32_bf16 v[60:63], v[116:119], a[64:67], v[60:63]
    ds_read_b64_tr_b16 v[114:115], v6 offset:800
    v_rcp_f32 v1, v1
    v_mfma_f32_16x16x32_bf16 v[68:71], v[116:119], a[68:71], v[68:71]
    ds_read_b64_tr_b16 v[116:117], v6 offset:6208
    v_fma_f32 v2, v2, v4, v4
    s_waitcnt lgkmcnt(3)
    v_mfma_f32_16x16x32_bf16 v[56:59], v[120:123], a[72:75], v[56:59]
    ds_read_b64_tr_b16 v[118:119], v6 offset:6976
    v_exp_f32 v104, v104
    v_mfma_f32_16x16x32_bf16 v[64:67], v[120:123], a[76:79], v[64:67]
    ds_read_b64_tr_b16 v[120:121], v6 offset:6240
    v_mul_f32 v44, v44, v1
    v_mul_f32 v1, s58, v48
    v_mfma_f32_16x16x32_bf16 v[60:63], v[124:127], a[72:75], v[60:63]
    ds_read_b64_tr_b16 v[122:123], v6 offset:7008
    v_rcp_f32 v2, v2
    v_mfma_f32_16x16x32_bf16 v[68:71], v[124:127], a[76:79], v[68:71]
    ds_read_b64_tr_b16 v[124:125], v6 offset:12544
    v_fma_f32 v3, v3, v4, v4
    v_mfma_f32_16x16x32_bf16 v[56:59], v[108:111], a[80:83], v[56:59]
    ds_read_b64_tr_b16 v[126:127], v6 offset:13312
    v_exp_f32 v1, v1
    v_mfma_f32_16x16x32_bf16 v[64:67], v[108:111], a[84:87], v[64:67]
    ds_read_b64_tr_b16 v[108:109], v6 offset:12576
    v_mul_f32 v45, v45, v2
    v_mul_f32 v2, s58, v49
    s_waitcnt lgkmcnt(3)
    v_mfma_f32_16x16x32_bf16 v[60:63], v[112:115], a[80:83], v[60:63]
    ds_read_b64_tr_b16 v[110:111], v6 offset:13344
    v_rcp_f32 v3, v3
    v_mfma_f32_16x16x32_bf16 v[68:71], v[112:115], a[84:87], v[68:71]
    ds_read_b64_tr_b16 v[112:113], v6 offset:18752
    v_fma_f32 v104, v104, v4, v4
    v_mfma_f32_16x16x32_bf16 v[56:59], v[116:119], a[88:91], v[56:59]
    ds_read_b64_tr_b16 v[114:115], v6 offset:19520
    v_exp_f32 v2, v2
    v_mfma_f32_16x16x32_bf16 v[64:67], v[116:119], a[92:95], v[64:67]
    ds_read_b64_tr_b16 v[116:117], v6 offset:18784
    v_mul_f32 v46, v46, v3
    v_mul_f32 v3, s58, v50
    v_mfma_f32_16x16x32_bf16 v[60:63], v[120:123], a[88:91], v[60:63]
    ds_read_b64_tr_b16 v[118:119], v6 offset:19552
    v_rcp_f32 v104, v104
    v_mfma_f32_16x16x32_bf16 v[68:71], v[120:123], a[92:95], v[68:71]
    ds_read_b64_tr_b16 v[120:121], v6 offset:25088
    v_fma_f32 v1, v1, v105, v105
    s_waitcnt lgkmcnt(3)
    v_mfma_f32_16x16x32_bf16 v[56:59], v[124:127], a[96:99], v[56:59]
    ds_read_b64_tr_b16 v[122:123], v6 offset:25856
    v_exp_f32 v3, v3
    v_mfma_f32_16x16x32_bf16 v[64:67], v[124:127], a[100:103], v[64:67]
    ds_read_b64_tr_b16 v[124:125], v6 offset:25120
    v_mul_f32 v47, v47, v104
    v_mul_f32 v104, s58, v51
    v_mfma_f32_16x16x32_bf16 v[60:63], v[108:111], a[96:99], v[60:63]
    ds_read_b64_tr_b16 v[126:127], v6 offset:25888
    v_rcp_f32 v1, v1
    v_mfma_f32_16x16x32_bf16 v[68:71], v[108:111], a[100:103], v[68:71]
    ds_read_b64_tr_b16 v[108:109], v6 offset:31296
    v_fma_f32 v2, v2, v105, v105
    v_mfma_f32_16x16x32_bf16 v[56:59], v[112:115], a[104:107], v[56:59]
    ds_read_b64_tr_b16 v[110:111], v6 offset:32064
    v_exp_f32 v104, v104
    v_mfma_f32_16x16x32_bf16 v[64:67], v[112:115], a[108:111], v[64:67]
    ds_read_b64_tr_b16 v[112:113], v6 offset:31328
    v_mul_f32 v48, v48, v1
    v_mul_f32 v1, s58, v52
    s_waitcnt lgkmcnt(3)
    v_mfma_f32_16x16x32_bf16 v[60:63], v[116:119], a[104:107], v[60:63]
    ds_read_b64_tr_b16 v[114:115], v6 offset:32096
    v_rcp_f32 v2, v2
    v_mfma_f32_16x16x32_bf16 v[68:71], v[116:119], a[108:111], v[68:71]
    ds_read_b64_tr_b16 v[116:117], v5 offset:64
    v_fma_f32 v3, v3, v105, v105
    v_mfma_f32_16x16x32_bf16 v[56:59], v[120:123], a[112:115], v[56:59]
    ds_read_b64_tr_b16 v[118:119], v5 offset:832
    v_exp_f32 v1, v1
    v_mfma_f32_16x16x32_bf16 v[64:67], v[120:123], a[116:119], v[64:67]
    ds_read_b64_tr_b16 v[120:121], v5 offset:96
    v_mul_f32 v49, v49, v2
    v_mul_f32 v2, s58, v53
    v_mfma_f32_16x16x32_bf16 v[60:63], v[124:127], a[112:115], v[60:63]
    ds_read_b64_tr_b16 v[122:123], v5 offset:864
    v_rcp_f32 v3, v3
    v_mfma_f32_16x16x32_bf16 v[68:71], v[124:127], a[116:119], v[68:71]
    ds_read_b64_tr_b16 v[124:125], v5 offset:6272
    v_fma_f32 v104, v104, v105, v105
    s_waitcnt lgkmcnt(3)
    v_mfma_f32_16x16x32_bf16 v[56:59], v[108:111], a[120:123], v[56:59]
    ds_read_b64_tr_b16 v[126:127], v5 offset:7040
    v_exp_f32 v2, v2
    v_mfma_f32_16x16x32_bf16 v[64:67], v[108:111], a[124:127], v[64:67]
    ds_read_b64_tr_b16 v[108:109], v5 offset:6304
    v_mul_f32 v50, v50, v3
    v_mul_f32 v3, s58, v54
    v_mfma_f32_16x16x32_bf16 v[60:63], v[112:115], a[120:123], v[60:63]
    ds_read_b64_tr_b16 v[110:111], v5 offset:7072
    v_rcp_f32 v104, v104
    v_mfma_f32_16x16x32_bf16 v[68:71], v[112:115], a[124:127], v[68:71]
    s_barrier
    ds_read_b64_tr_b16 v[112:113], v6 offset:64
    v_fma_f32 v1, v1, v105, v105
    v_mfma_f32_16x16x32_bf16 v[72:75], v[116:119], a[64:67], v[72:75]
    ds_read_b64_tr_b16 v[114:115], v6 offset:832
    v_exp_f32 v3, v3
    v_mfma_f32_16x16x32_bf16 v[80:83], v[116:119], a[68:71], v[80:83]
    ds_read_b64_tr_b16 v[116:117], v6 offset:96
    v_mul_f32 v51, v51, v104
    v_mul_f32 v104, s58, v55
    s_waitcnt lgkmcnt(3)
    v_mfma_f32_16x16x32_bf16 v[76:79], v[120:123], a[64:67], v[76:79]
    ds_read_b64_tr_b16 v[118:119], v6 offset:864
    v_rcp_f32 v1, v1
    v_mfma_f32_16x16x32_bf16 v[84:87], v[120:123], a[68:71], v[84:87]
    ds_read_b64_tr_b16 v[120:121], v6 offset:6272
    v_fma_f32 v2, v2, v105, v105
    v_mfma_f32_16x16x32_bf16 v[72:75], v[124:127], a[72:75], v[72:75]
    ds_read_b64_tr_b16 v[122:123], v6 offset:7040
    v_mul_f32 v8, v8, v56
    v_mfma_f32_16x16x32_bf16 v[80:83], v[124:127], a[76:79], v[80:83]
    ds_read_b64_tr_b16 v[124:125], v6 offset:6304
    v_mul_f32 v9, v9, v57
    v_mul_f32 v10, v10, v58
    v_mfma_f32_16x16x32_bf16 v[76:79], v[108:111], a[72:75], v[76:79]
    ds_read_b64_tr_b16 v[126:127], v6 offset:7072
    v_mul_f32 v11, v11, v59
    v_mfma_f32_16x16x32_bf16 v[84:87], v[108:111], a[76:79], v[84:87]
    ds_read_b64_tr_b16 v[108:109], v6 offset:12608
    v_cvt_pk_bf16_f32 v56, v8, v9
    v_mul_f32 v12, v12, v60
    s_waitcnt lgkmcnt(3)
    v_mfma_f32_16x16x32_bf16 v[72:75], v[112:115], a[80:83], v[72:75]
    ds_read_b64_tr_b16 v[110:111], v6 offset:13376
    v_mul_f32 v13, v13, v61
    v_mfma_f32_16x16x32_bf16 v[80:83], v[112:115], a[84:87], v[80:83]
    ds_read_b64_tr_b16 v[112:113], v6 offset:12640
    v_cvt_pk_bf16_f32 v57, v10, v11
    v_mul_f32 v14, v14, v62
    v_mfma_f32_16x16x32_bf16 v[76:79], v[116:119], a[80:83], v[76:79]
    ds_read_b64_tr_b16 v[114:115], v6 offset:13408
    v_mul_f32 v15, v15, v63
    v_mfma_f32_16x16x32_bf16 v[84:87], v[116:119], a[84:87], v[84:87]
    ds_read_b64_tr_b16 v[116:117], v6 offset:18816
    v_cvt_pk_bf16_f32 v58, v12, v13
    v_mul_f32 v16, v16, v64
    v_mfma_f32_16x16x32_bf16 v[72:75], v[120:123], a[88:91], v[72:75]
    ds_read_b64_tr_b16 v[118:119], v6 offset:19584
    v_mul_f32 v17, v17, v65
    v_mfma_f32_16x16x32_bf16 v[80:83], v[120:123], a[92:95], v[80:83]
    ds_read_b64_tr_b16 v[120:121], v6 offset:18848
    v_cvt_pk_bf16_f32 v59, v14, v15
    v_mul_f32 v18, v18, v66
    s_waitcnt lgkmcnt(3)
    v_mfma_f32_16x16x32_bf16 v[76:79], v[124:127], a[88:91], v[76:79]
    ds_read_b64_tr_b16 v[122:123], v6 offset:19616
    v_mul_f32 v19, v19, v67
    v_mfma_f32_16x16x32_bf16 v[84:87], v[124:127], a[92:95], v[84:87]
    ds_read_b64_tr_b16 v[124:125], v6 offset:25152
    v_cvt_pk_bf16_f32 v60, v16, v17
    v_mul_f32 v20, v20, v68
    v_mfma_f32_16x16x32_bf16 v[72:75], v[108:111], a[96:99], v[72:75]
    ds_read_b64_tr_b16 v[126:127], v6 offset:25920
    v_mul_f32 v21, v21, v69
    v_mfma_f32_16x16x32_bf16 v[80:83], v[108:111], a[100:103], v[80:83]
    ds_read_b64_tr_b16 v[108:109], v6 offset:25184
    v_cvt_pk_bf16_f32 v61, v18, v19
    v_mul_f32 v22, v22, v70
    v_mfma_f32_16x16x32_bf16 v[76:79], v[112:115], a[96:99], v[76:79]
    ds_read_b64_tr_b16 v[110:111], v6 offset:25952
    v_mul_f32 v23, v23, v71
    v_mfma_f32_16x16x32_bf16 v[84:87], v[112:115], a[100:103], v[84:87]
    ds_read_b64_tr_b16 v[112:113], v6 offset:31360
    v_cvt_pk_bf16_f32 v62, v20, v21
    v_cvt_pk_bf16_f32 v63, v22, v23
    s_waitcnt lgkmcnt(3)
    v_mfma_f32_16x16x32_bf16 v[72:75], v[116:119], a[104:107], v[72:75]
    ds_read_b64_tr_b16 v[114:115], v6 offset:32128
    v_lshlrev_b32 v8, 4, v0
    v_mfma_f32_16x16x32_bf16 v[80:83], v[116:119], a[108:111], v[80:83]
    ds_read_b64_tr_b16 v[116:117], v6 offset:31392
    s_add_u32 s56, s60, 0
    s_cmp_le_u32 s63, 0
    s_cselect_b32 s56, 2147483632, s56
    buffer_store_dwordx4 v[56:59], v8, s[32:35], s56 offen sc1
    v_mfma_f32_16x16x32_bf16 v[76:79], v[120:123], a[104:107], v[76:79]
    ds_read_b64_tr_b16 v[118:119], v6 offset:32160
    buffer_store_dwordx4 v[60:63], v8, s[32:35], s56 offen offset:1024 sc1
    v_mfma_f32_16x16x32_bf16 v[84:87], v[120:123], a[108:111], v[84:87]
    ds_read_b64_tr_b16 v[120:121], v5 offset:128
    v_mfma_f32_16x16x32_bf16 v[72:75], v[124:127], a[112:115], v[72:75]
    ds_read_b64_tr_b16 v[122:123], v5 offset:896
    v_exp_f32 v104, v104
    v_mfma_f32_16x16x32_bf16 v[80:83], v[124:127], a[116:119], v[80:83]
    ds_read_b64_tr_b16 v[124:125], v5 offset:160
    v_mul_f32 v52, v52, v1
    s_waitcnt lgkmcnt(3)
    v_mfma_f32_16x16x32_bf16 v[76:79], v[108:111], a[112:115], v[76:79]
    ds_read_b64_tr_b16 v[126:127], v5 offset:928
    v_rcp_f32 v2, v2
    v_mfma_f32_16x16x32_bf16 v[84:87], v[108:111], a[116:119], v[84:87]
    ds_read_b64_tr_b16 v[108:109], v5 offset:6336
    v_fma_f32 v3, v3, v105, v105
    v_mfma_f32_16x16x32_bf16 v[72:75], v[112:115], a[120:123], v[72:75]
    ds_read_b64_tr_b16 v[110:111], v5 offset:7104
    v_mfma_f32_16x16x32_bf16 v[80:83], v[112:115], a[124:127], v[80:83]
    ds_read_b64_tr_b16 v[112:113], v5 offset:6368
    v_mul_f32 v53, v53, v2
    v_mfma_f32_16x16x32_bf16 v[76:79], v[116:119], a[120:123], v[76:79]
    ds_read_b64_tr_b16 v[114:115], v5 offset:7136
    v_rcp_f32 v3, v3
    v_mfma_f32_16x16x32_bf16 v[84:87], v[116:119], a[124:127], v[84:87]
    ds_read_b64_tr_b16 v[116:117], v6 offset:128
    v_fma_f32 v104, v104, v105, v105
    s_waitcnt lgkmcnt(3)
    v_mfma_f32_16x16x32_bf16 v[88:91], v[120:123], a[64:67], v[88:91]
    ds_read_b64_tr_b16 v[118:119], v6 offset:896
    v_mfma_f32_16x16x32_bf16 v[96:99], v[120:123], a[68:71], v[96:99]
    ds_read_b64_tr_b16 v[120:121], v6 offset:160
    v_mul_f32 v54, v54, v3
    v_mfma_f32_16x16x32_bf16 v[92:95], v[124:127], a[64:67], v[92:95]
    ds_read_b64_tr_b16 v[122:123], v6 offset:928
    v_rcp_f32 v104, v104
    v_mfma_f32_16x16x32_bf16 v[100:103], v[124:127], a[68:71], v[100:103]
    ds_read_b64_tr_b16 v[124:125], v6 offset:6336
    v_mfma_f32_16x16x32_bf16 v[88:91], v[108:111], a[72:75], v[88:91]
    ds_read_b64_tr_b16 v[126:127], v6 offset:7104
    v_mul_f32 v24, v24, v72
    v_mfma_f32_16x16x32_bf16 v[96:99], v[108:111], a[76:79], v[96:99]
    ds_read_b64_tr_b16 v[108:109], v6 offset:6368
    v_mul_f32 v25, v25, v73
    v_mul_f32 v26, v26, v74
    s_waitcnt lgkmcnt(3)
    v_mfma_f32_16x16x32_bf16 v[92:95], v[112:115], a[72:75], v[92:95]
    ds_read_b64_tr_b16 v[110:111], v6 offset:7136
    v_mul_f32 v27, v27, v75
    v_mfma_f32_16x16x32_bf16 v[100:103], v[112:115], a[76:79], v[100:103]
    ds_read_b64_tr_b16 v[112:113], v6 offset:12672
    v_cvt_pk_bf16_f32 v72, v24, v25
    v_mul_f32 v28, v28, v76
    v_mfma_f32_16x16x32_bf16 v[88:91], v[116:119], a[80:83], v[88:91]
    ds_read_b64_tr_b16 v[114:115], v6 offset:13440
    v_mul_f32 v29, v29, v77
    v_mfma_f32_16x16x32_bf16 v[96:99], v[116:119], a[84:87], v[96:99]
    ds_read_b64_tr_b16 v[116:117], v6 offset:12704
    v_cvt_pk_bf16_f32 v73, v26, v27
    v_mul_f32 v30, v30, v78
    v_mfma_f32_16x16x32_bf16 v[92:95], v[120:123], a[80:83], v[92:95]
    ds_read_b64_tr_b16 v[118:119], v6 offset:13472
    v_mul_f32 v31, v31, v79
    v_mfma_f32_16x16x32_bf16 v[100:103], v[120:123], a[84:87], v[100:103]
    ds_read_b64_tr_b16 v[120:121], v6 offset:18880
    v_cvt_pk_bf16_f32 v74, v28, v29
    v_mul_f32 v32, v32, v80
    s_waitcnt lgkmcnt(3)
    v_mfma_f32_16x16x32_bf16 v[88:91], v[124:127], a[88:91], v[88:91]
    ds_read_b64_tr_b16 v[122:123], v6 offset:19648
    v_mul_f32 v33, v33, v81
    v_mfma_f32_16x16x32_bf16 v[96:99], v[124:127], a[92:95], v[96:99]
    ds_read_b64_tr_b16 v[124:125], v6 offset:18912
    v_cvt_pk_bf16_f32 v75, v30, v31
    v_mul_f32 v34, v34, v82
    v_mfma_f32_16x16x32_bf16 v[92:95], v[108:111], a[88:91], v[92:95]
    ds_read_b64_tr_b16 v[126:127], v6 offset:19680
    v_mul_f32 v35, v35, v83
    v_mfma_f32_16x16x32_bf16 v[100:103], v[108:111], a[92:95], v[100:103]
    ds_read_b64_tr_b16 v[108:109], v6 offset:25216
    v_cvt_pk_bf16_f32 v76, v32, v33
    v_mul_f32 v36, v36, v84
    v_mfma_f32_16x16x32_bf16 v[88:91], v[112:115], a[96:99], v[88:91]
    ds_read_b64_tr_b16 v[110:111], v6 offset:25984
    v_mul_f32 v37, v37, v85
    v_mfma_f32_16x16x32_bf16 v[96:99], v[112:115], a[100:103], v[96:99]
    ds_read_b64_tr_b16 v[112:113], v6 offset:25248
    v_cvt_pk_bf16_f32 v77, v34, v35
    v_mul_f32 v38, v38, v86
    s_waitcnt lgkmcnt(3)
    v_mfma_f32_16x16x32_bf16 v[92:95], v[116:119], a[96:99], v[92:95]
    ds_read_b64_tr_b16 v[114:115], v6 offset:26016
    v_mul_f32 v39, v39, v87
    v_mfma_f32_16x16x32_bf16 v[100:103], v[116:119], a[100:103], v[100:103]
    ds_read_b64_tr_b16 v[116:117], v6 offset:31424
    v_cvt_pk_bf16_f32 v78, v36, v37
    v_cvt_pk_bf16_f32 v79, v38, v39
    v_mfma_f32_16x16x32_bf16 v[88:91], v[120:123], a[104:107], v[88:91]
    ds_read_b64_tr_b16 v[118:119], v6 offset:32192
    s_add_u32 s56, s60, 2048
    s_cmp_le_u32 s63, 1
    s_cselect_b32 s56, 2147483632, s56
    v_mfma_f32_16x16x32_bf16 v[96:99], v[120:123], a[108:111], v[96:99]
    ds_read_b64_tr_b16 v[120:121], v6 offset:31456
    buffer_store_dwordx4 v[72:75], v8, s[32:35], s56 offen sc1
    buffer_store_dwordx4 v[76:79], v8, s[32:35], s56 offen offset:1024 sc1
    v_mfma_f32_16x16x32_bf16 v[92:95], v[124:127], a[104:107], v[92:95]
    ds_read_b64_tr_b16 v[122:123], v6 offset:32224
    v_mfma_f32_16x16x32_bf16 v[100:103], v[124:127], a[108:111], v[100:103]
    v_mul_f32 v55, v55, v104
    s_waitcnt lgkmcnt(2)
    v_mfma_f32_16x16x32_bf16 v[88:91], v[108:111], a[112:115], v[88:91]
    v_mfma_f32_16x16x32_bf16 v[96:99], v[108:111], a[116:119], v[96:99]
    v_mfma_f32_16x16x32_bf16 v[92:95], v[112:115], a[112:115], v[92:95]
    v_mfma_f32_16x16x32_bf16 v[100:103], v[112:115], a[116:119], v[100:103]
    s_waitcnt lgkmcnt(0)
    s_barrier
    v_mfma_f32_16x16x32_bf16 v[88:91], v[116:119], a[120:123], v[88:91]
    v_mfma_f32_16x16x32_bf16 v[96:99], v[116:119], a[124:127], v[96:99]
    v_mfma_f32_16x16x32_bf16 v[92:95], v[120:123], a[120:123], v[92:95]
    v_mfma_f32_16x16x32_bf16 v[100:103], v[120:123], a[124:127], v[100:103]
    v_lshrrev_b32 v1, 3, v0
    v_lshlrev_b32 v1, 10, v1
    v_bfe_u32 v2, v0, 4, 1
    v_lshlrev_b32 v2, 2, v2
    v_and_b32 v3, 7, v0
    v_xor_b32 v2, v2, v3
    v_lshl_add_u32 v1, v2, 4, v1
    s_lshl_b32 s56, s97, 7
    v_add_u32 v122, s56, v1
    s_mul_i32 s3, s96, 241664
    s_lshl_b32 s4, s52, 12
    s_lshl_b32 s6, s52, 11
    s_mul_i32 s43, s6, 3
    s_mul_i32 s51, s6, 11
    s_lshl4_add_u32 s58, s43, 720896
    s_add_u32 m0, s4, 49152
    s_nop 0
    buffer_load_dwordx4 v122, s[24:27], s58 offen  lds
    v_pk_mul_f32 v[40:41], v[40:41], v[88:89]
    v_pk_mul_f32 v[42:43], v[42:43], v[90:91]
    v_cvt_pk_bf16_f32 v88, v40, v41
    v_pk_mul_f32 v[44:45], v[44:45], v[92:93]
    s_lshl4_add_u32 s58, s43, 729088
    s_add_u32 m0, s4, 50176
    s_nop 0
    buffer_load_dwordx4 v122, s[24:27], s58 offen  lds
    v_cvt_pk_bf16_f32 v89, v42, v43
    v_pk_mul_f32 v[46:47], v[46:47], v[94:95]
    v_cvt_pk_bf16_f32 v90, v44, v45
    v_pk_mul_f32 v[48:49], v[48:49], v[96:97]
    s_lshl4_add_u32 s58, s43, 737280
    s_add_u32 m0, s4, 51200
    s_nop 0
    buffer_load_dwordx4 v122, s[24:27], s58 offen  lds
    v_cvt_pk_bf16_f32 v91, v46, v47
    v_pk_mul_f32 v[50:51], v[50:51], v[98:99]
    v_cvt_pk_bf16_f32 v92, v48, v49
    v_pk_mul_f32 v[52:53], v[52:53], v[100:101]
    s_lshl4_add_u32 s58, s43, 745472
    s_add_u32 m0, s4, 52224
    s_nop 0
    buffer_load_dwordx4 v122, s[24:27], s58 offen  lds
    v_cvt_pk_bf16_f32 v93, v50, v51
    v_pk_mul_f32 v[54:55], v[54:55], v[102:103]
    v_cvt_pk_bf16_f32 v94, v52, v53
    v_cvt_pk_bf16_f32 v95, v54, v55
    s_add_u32 s56, s60, 4096
    s_cmp_le_u32 s63, 2
    s_cselect_b32 s56, 2147483632, s56
    buffer_store_dwordx4 v[88:91], v8, s[32:35], s56 offen sc1
    buffer_store_dwordx4 v[92:95], v8, s[32:35], s56 offen offset:1024 sc1
    v_mov_b32 v120, v106
    v_lshrrev_b32 v123, 2, v0
    v_lshl_add_u32 v123, v123, 7, s4
    v_bfe_u32 v124, v0, 3, 1
    v_lshl_add_u32 v123, v124, 6, v123
    v_and_b32 v124, 3, v0
    v_lshl_add_u32 v123, v124, 4, v123
    v_add_u32 v1, 49152, v123
    v_xor_b32 v2, 64, v1
    v_add_u32 v3, 65536, v1
    v_add_u32 v4, 65536, v2
    v_lshlrev_b32 v121, 4, v0
    s_xor_b32 s55, s52, 0
    s_lshr_b32 s56, s55, 1
    s_mul_i32 s56, s56, 118784
    s_lshl_b32 s55, s55, 10
    s_add_u32 s55, s55, s56
    s_add_u32 s12, s55, s3
    s_xor_b32 s55, s52, 1
    s_lshr_b32 s56, s55, 1
    s_mul_i32 s56, s56, 118784
    s_lshl_b32 s55, s55, 10
    s_add_u32 s55, s55, s56
    s_add_u32 s13, s55, s3
    s_xor_b32 s55, s52, 2
    s_lshr_b32 s56, s55, 1
    s_mul_i32 s56, s56, 118784
    s_lshl_b32 s55, s55, 10
    s_add_u32 s55, s55, s56
    s_add_u32 s14, s55, s3
    s_xor_b32 s55, s52, 3
    s_lshr_b32 s56, s55, 1
    s_mul_i32 s56, s56, 118784
    s_lshl_b32 s55, s55, 10
    s_add_u32 s55, s55, s56
    s_add_u32 s15, s55, s3
    s_setprio 0
    v_and_b32 v126, 7, v0
    v_lshl_add_u32 v126, v126, 2, s52
    v_lshlrev_b32 v126, 8, v126
    v_bfe_u32 v125, v0, 2, 1
    v_lshl_add_u32 v125, v125, 2, s52
    v_and_b32 v7, 3, v0
    v_min_u32 v7, 2, v7
    v_lshl_add_u32 v125, v125, 2, v7
    v_lshlrev_b32 v125, 8, v125
    s_waitcnt vmcnt(6)
    v_mov_b32 v6, s100
    s_mov_b64 exec, 1
    buffer_store_dword v6, off, s[32:35], s59 sc1
    s_mov_b64 exec, -1
    s_add_u32 s59, s59, 128
    s_lshl4_add_u32 s58, s43, 1081344
    s_add_u32 m0, s4, 65536
    s_nop 0
    buffer_load_dwordx4 v122, s[24:27], s58 offen  lds
    s_lshl4_add_u32 s58, s43, 1089536
    s_add_u32 m0, s4, 66560
    s_nop 0
    buffer_load_dwordx4 v122, s[24:27], s58 offen  lds
    s_lshl4_add_u32 s58, s43, 1097728
    s_add_u32 m0, s4, 67584
    s_nop 0
    buffer_load_dwordx4 v122, s[24:27], s58 offen  lds
    s_lshl4_add_u32 s58, s43, 1105920
    s_add_u32 m0, s4, 68608
    s_nop 0
    buffer_load_dwordx4 v122, s[24:27], s58 offen  lds
    s_lshl4_add_u32 s58, s43, 32768
    s_add_u32 m0, s4, 114688
    s_nop 0
    buffer_load_dwordx4 v122, s[24:27], s58 offen  lds
    s_lshl4_add_u32 s58, s43, 40960
    s_add_u32 m0, s4, 115712
    s_nop 0
    buffer_load_dwordx4 v122, s[24:27], s58 offen  lds
    s_lshl4_add_u32 s58, s43, 49152
    s_add_u32 m0, s4, 116736
    s_nop 0
    buffer_load_dwordx4 v122, s[24:27], s58 offen  lds
    s_lshl4_add_u32 s58, s43, 57344
    s_add_u32 m0, s4, 117760
    s_nop 0
    buffer_load_dwordx4 v122, s[24:27], s58 offen  lds
    s_waitcnt vmcnt(9)
    v_mov_b32 v6, s100
    s_mov_b64 exec, 1
    buffer_store_dword v6, off, s[32:35], s59 sc1
    s_mov_b64 exec, -1
    s_lshl4_add_u32 s58, s43, 393216
    s_add_u32 m0, s4, 131072
    s_nop 0
    buffer_load_dwordx4 v122, s[24:27], s58 offen  lds
    ds_read_b32 v5, v120 offset:288
    s_waitcnt lgkmcnt(0)
    v_cmp_ne_u32 vcc, 0, v5
    s_nop 0
    s_cbranch_vccz L_gated_mix__sliding_block__swiglu_ffn__prompt_kernel_c_36b
L_gated_mix__sliding_block__swiglu_ffn__prompt_kernel_c_36l:
    ds_read_b32 v5, v120 offset:288
    s_add_u32 s101, s101, 1
    s_cmp_gt_u32 s101, s42
    s_cbranch_scc1 L_gated_mix__sliding_block__swiglu_ffn__prompt_kernel_c_36b
    s_waitcnt lgkmcnt(0)
    v_cmp_ne_u32 vcc, 0, v5
    s_nop 0
    s_cbranch_vccnz L_gated_mix__sliding_block__swiglu_ffn__prompt_kernel_c_36l
L_gated_mix__sliding_block__swiglu_ffn__prompt_kernel_c_36b:
    ds_read_b64_tr_b16 a[0:1], v1 offset:32768
    ds_read_b64_tr_b16 a[2:3], v1 offset:34816
    ds_read_b64_tr_b16 a[4:5], v1 offset:32776
    ds_read_b64_tr_b16 a[6:7], v1 offset:34824
    ds_read_b64_tr_b16 a[8:9], v2 offset:32768
    ds_read_b64_tr_b16 a[10:11], v2 offset:34816
    ds_read_b64_tr_b16 a[12:13], v2 offset:32776
    ds_read_b64_tr_b16 a[14:15], v2 offset:34824
    s_lshl4_add_u32 s58, s43, 401408
    s_add_u32 m0, s4, 132096
    s_nop 0
    buffer_load_dwordx4 v122, s[24:27], s58 offen  lds
    s_lshl4_add_u32 s58, s43, 409600
    s_add_u32 m0, s4, 133120
    s_nop 0
    buffer_load_dwordx4 v122, s[24:27], s58 offen  lds
    s_lshl4_add_u32 s58, s43, 417792
    s_add_u32 m0, s4, 134144
    s_nop 0
    buffer_load_dwordx4 v122, s[24:27], s58 offen  lds
    s_waitcnt lgkmcnt(0)
    s_lshl4_add_u32 s58, s43, 753664
    s_add_u32 m0, s4, 81920
    s_nop 0
    buffer_load_dwordx4 v122, s[24:27], s58 offen  lds
    ds_read_b32 v5, v120 offset:304
    s_waitcnt lgkmcnt(0)
    v_cmp_ne_u32 vcc, 0, v5
    s_nop 0
    s_cbranch_vccz L_gated_mix__sliding_block__swiglu_ffn__prompt_kernel_c_37b
L_gated_mix__sliding_block__swiglu_ffn__prompt_kernel_c_37l:
    ds_read_b32 v5, v120 offset:304
    s_add_u32 s101, s101, 1
    s_cmp_gt_u32 s101, s42
    s_cbranch_scc1 L_gated_mix__sliding_block__swiglu_ffn__prompt_kernel_c_37b
    s_waitcnt lgkmcnt(0)
    v_cmp_ne_u32 vcc, 0, v5
    s_nop 0
    s_cbranch_vccnz L_gated_mix__sliding_block__swiglu_ffn__prompt_kernel_c_37l
L_gated_mix__sliding_block__swiglu_ffn__prompt_kernel_c_37b:
    ds_read_b64_tr_b16 a[16:17], v1 offset:49152
    ds_read_b64_tr_b16 a[18:19], v1 offset:51200
    ds_read_b64_tr_b16 a[20:21], v1 offset:49160
    ds_read_b64_tr_b16 a[22:23], v1 offset:51208
    ds_read_b64_tr_b16 a[24:25], v2 offset:49152
    ds_read_b64_tr_b16 a[26:27], v2 offset:51200
    ds_read_b64_tr_b16 a[28:29], v2 offset:49160
    ds_read_b64_tr_b16 a[30:31], v2 offset:51208
    s_lshl4_add_u32 s58, s43, 761856
    s_add_u32 m0, s4, 82944
    s_nop 0
    buffer_load_dwordx4 v122, s[24:27], s58 offen  lds
    s_lshl4_add_u32 s58, s43, 770048
    s_add_u32 m0, s4, 83968
    s_nop 0
    buffer_load_dwordx4 v122, s[24:27], s58 offen  lds
    s_lshl4_add_u32 s58, s43, 778240
    s_add_u32 m0, s4, 84992
    s_nop 0
    buffer_load_dwordx4 v122, s[24:27], s58 offen  lds
    s_waitcnt lgkmcnt(0)
    s_lshl4_add_u32 s58, s43, 1114112
    s_add_u32 m0, s4, 98304
    s_nop 0
    buffer_load_dwordx4 v122, s[24:27], s58 offen  lds
    ds_read_b64_tr_b16 a[32:33], v1 offset:0
    ds_read_b64_tr_b16 a[34:35], v1 offset:2048
    ds_read_b64_tr_b16 a[36:37], v1 offset:8
    ds_read_b64_tr_b16 a[38:39], v1 offset:2056
    ds_read_b64_tr_b16 a[40:41], v2 offset:0
    ds_read_b64_tr_b16 a[42:43], v2 offset:2048
    ds_read_b64_tr_b16 a[44:45], v2 offset:8
    ds_read_b64_tr_b16 a[46:47], v2 offset:2056
    s_lshl4_add_u32 s58, s43, 1122304
    s_add_u32 m0, s4, 99328
    s_nop 0
    buffer_load_dwordx4 v122, s[24:27], s58 offen  lds
    s_lshl4_add_u32 s58, s43, 1130496
    s_add_u32 m0, s4, 100352
    s_nop 0
    buffer_load_dwordx4 v122, s[24:27], s58 offen  lds
    s_lshl4_add_u32 s58, s43, 1138688
    s_add_u32 m0, s4, 101376
    s_nop 0
    buffer_load_dwordx4 v122, s[24:27], s58 offen  lds
    s_waitcnt lgkmcnt(0)
    s_lshl4_add_u32 s58, s51, 65536
    s_add_u32 m0, s4, 49152
    s_nop 0
    buffer_load_dwordx4 v122, s[24:27], s58 offen  lds
    s_waitcnt vmcnt(18)
    ds_read_b64_tr_b16 a[48:49], v1 offset:16384
    ds_read_b64_tr_b16 a[50:51], v1 offset:18432
    ds_read_b64_tr_b16 a[52:53], v1 offset:16392
    ds_read_b64_tr_b16 a[54:55], v1 offset:18440
    ds_read_b64_tr_b16 a[56:57], v2 offset:16384
    ds_read_b64_tr_b16 a[58:59], v2 offset:18432
    ds_read_b64_tr_b16 a[60:61], v2 offset:16392
    ds_read_b64_tr_b16 a[62:63], v2 offset:18440
    s_lshl4_add_u32 s58, s51, 73728
    s_add_u32 m0, s4, 50176
    s_nop 0
    buffer_load_dwordx4 v122, s[24:27], s58 offen  lds
    s_lshl4_add_u32 s58, s51, 81920
    s_add_u32 m0, s4, 51200
    s_nop 0
    buffer_load_dwordx4 v122, s[24:27], s58 offen  lds
    s_lshl4_add_u32 s58, s51, 90112
    s_add_u32 m0, s4, 52224
    s_nop 0
    buffer_load_dwordx4 v122, s[24:27], s58 offen  lds
    s_waitcnt lgkmcnt(0)
    s_lshl4_add_u32 s58, s51, 163840
    s_add_u32 m0, s4, 65536
    s_nop 0
    buffer_load_dwordx4 v122, s[24:27], s58 offen  lds
    s_waitcnt vmcnt(18)
    ds_read_b64_tr_b16 a[64:65], v3 offset:0
    ds_read_b64_tr_b16 a[66:67], v3 offset:2048
    ds_read_b64_tr_b16 a[68:69], v3 offset:8
    ds_read_b64_tr_b16 a[70:71], v3 offset:2056
    ds_read_b64_tr_b16 a[72:73], v4 offset:0
    ds_read_b64_tr_b16 a[74:75], v4 offset:2048
    ds_read_b64_tr_b16 a[76:77], v4 offset:8
    ds_read_b64_tr_b16 a[78:79], v4 offset:2056
    s_lshl4_add_u32 s58, s51, 172032
    s_add_u32 m0, s4, 66560
    s_nop 0
    buffer_load_dwordx4 v122, s[24:27], s58 offen  lds
    s_lshl4_add_u32 s58, s51, 180224
    s_add_u32 m0, s4, 67584
    s_nop 0
    buffer_load_dwordx4 v122, s[24:27], s58 offen  lds
    s_lshl4_add_u32 s58, s51, 188416
    s_add_u32 m0, s4, 68608
    s_nop 0
    buffer_load_dwordx4 v122, s[24:27], s58 offen  lds
    s_waitcnt lgkmcnt(0)
    s_lshl4_add_u32 s58, s51, 262144
    s_add_u32 m0, s4, 114688
    s_nop 0
    buffer_load_dwordx4 v122, s[24:27], s58 offen  lds
    s_waitcnt vmcnt(17)
    ds_read_b64_tr_b16 a[80:81], v3 offset:16384
    ds_read_b64_tr_b16 a[82:83], v3 offset:18432
    ds_read_b64_tr_b16 a[84:85], v3 offset:16392
    ds_read_b64_tr_b16 a[86:87], v3 offset:18440
    ds_read_b64_tr_b16 a[88:89], v4 offset:16384
    ds_read_b64_tr_b16 a[90:91], v4 offset:18432
    ds_read_b64_tr_b16 a[92:93], v4 offset:16392
    ds_read_b64_tr_b16 a[94:95], v4 offset:18440
    s_lshl4_add_u32 s58, s51, 270336
    s_add_u32 m0, s4, 115712
    s_nop 0
    buffer_load_dwordx4 v122, s[24:27], s58 offen  lds
    s_lshl4_add_u32 s58, s51, 278528
    s_add_u32 m0, s4, 116736
    s_nop 0
    buffer_load_dwordx4 v122, s[24:27], s58 offen  lds
    s_lshl4_add_u32 s58, s51, 286720
    s_add_u32 m0, s4, 117760
    s_nop 0
    buffer_load_dwordx4 v122, s[24:27], s58 offen  lds
    s_lshl_b32 s54, s96, 13
    s_add_u32 s54, s54, 14811136
    s_mov_b64 exec, 0xff
    buffer_load_dword v127, v126, s[32:35], s54 offen sc1
    s_mov_b64 exec, -1
    s_waitcnt lgkmcnt(0)
    s_lshl4_add_u32 s58, s6, 0
    s_add_u32 m0, s4, 131072
    s_nop 0
    buffer_load_dwordx4 v122, s[28:31], s58 offen  lds
    s_waitcnt vmcnt(18)
    ds_read_b64_tr_b16 a[96:97], v1 offset:32768
    ds_read_b64_tr_b16 a[98:99], v1 offset:34816
    ds_read_b64_tr_b16 a[100:101], v1 offset:32776
    ds_read_b64_tr_b16 a[102:103], v1 offset:34824
    ds_read_b64_tr_b16 a[104:105], v2 offset:32768
    ds_read_b64_tr_b16 a[106:107], v2 offset:34816
    ds_read_b64_tr_b16 a[108:109], v2 offset:32776
    ds_read_b64_tr_b16 a[110:111], v2 offset:34824
    s_lshl4_add_u32 s58, s6, 8192
    s_add_u32 m0, s4, 132096
    s_nop 0
    buffer_load_dwordx4 v122, s[28:31], s58 offen  lds
    s_lshl4_add_u32 s58, s6, 16384
    s_add_u32 m0, s4, 133120
    s_nop 0
    buffer_load_dwordx4 v122, s[28:31], s58 offen  lds
    s_lshl4_add_u32 s58, s6, 24576
    s_add_u32 m0, s4, 134144
    s_nop 0
    buffer_load_dwordx4 v122, s[28:31], s58 offen  lds
    s_waitcnt lgkmcnt(0)
    s_lshl4_add_u32 s58, s6, 131072
    s_add_u32 m0, s4, 81920
    s_nop 0
    buffer_load_dwordx4 v122, s[28:31], s58 offen  lds
    s_waitcnt vmcnt(18)
    ds_read_b64_tr_b16 a[112:113], v1 offset:49152
    ds_read_b64_tr_b16 a[114:115], v1 offset:51200
    ds_read_b64_tr_b16 a[116:117], v1 offset:49160
    ds_read_b64_tr_b16 a[118:119], v1 offset:51208
    ds_read_b64_tr_b16 a[120:121], v2 offset:49152
    ds_read_b64_tr_b16 a[122:123], v2 offset:51200
    ds_read_b64_tr_b16 a[124:125], v2 offset:49160
    ds_read_b64_tr_b16 a[126:127], v2 offset:51208
    s_lshl4_add_u32 s58, s6, 139264
    s_add_u32 m0, s4, 82944
    s_nop 0
    buffer_load_dwordx4 v122, s[28:31], s58 offen  lds
    s_lshl4_add_u32 s58, s6, 147456
    s_add_u32 m0, s4, 83968
    s_nop 0
    buffer_load_dwordx4 v122, s[28:31], s58 offen  lds
    s_lshl4_add_u32 s58, s6, 155648
    s_add_u32 m0, s4, 84992
    s_nop 0
    buffer_load_dwordx4 v122, s[28:31], s58 offen  lds
    s_waitcnt vmcnt(8)
    v_cmp_ne_u32 vcc, s100, v127
    s_nop 0
    s_and_b32 vcc_lo, vcc_lo, 0xff
    s_cbranch_scc1 L_gated_mix__sliding_block__swiglu_ffn__prompt_kernel_poll_38
L_gated_mix__sliding_block__swiglu_ffn__prompt_kernel_poll_38b:
    s_add_u32 s57, s43, 0
    s_add_u32 s58, s15, s57
    buffer_load_dwordx4 v[72:75], v121, s[32:35], s58 offen sc1
    s_add_u32 s58, s13, s57
    buffer_load_dwordx4 v[76:79], v121, s[32:35], s58 offen sc1
    s_add_u32 s58, s14, s57
    buffer_load_dwordx4 v[80:83], v121, s[32:35], s58 offen sc1
    s_add_u32 s58, s12, s57
    buffer_load_dwordx4 v[84:87], v121, s[32:35], s58 offen sc1
    s_add_u32 s57, s43, 22528
    s_add_u32 s58, s15, s57
    buffer_load_dwordx4 v[88:91], v121, s[32:35], s58 offen sc1
    s_add_u32 s58, s13, s57
    buffer_load_dwordx4 v[92:95], v121, s[32:35], s58 offen sc1
    s_add_u32 s58, s14, s57
    buffer_load_dwordx4 v[96:99], v121, s[32:35], s58 offen sc1
    s_add_u32 s58, s12, s57
    buffer_load_dwordx4 v[100:103], v121, s[32:35], s58 offen sc1
    s_add_u32 s57, s43, 45056
    s_add_u32 s58, s15, s57
    buffer_load_dwordx4 v[104:107], v121, s[32:35], s58 offen sc1
    s_add_u32 s58, s13, s57
    buffer_load_dwordx4 v[108:111], v121, s[32:35], s58 offen sc1
    s_add_u32 s58, s14, s57
    buffer_load_dwordx4 v[112:115], v121, s[32:35], s58 offen sc1
    s_add_u32 s58, s12, s57
    buffer_load_dwordx4 v[116:119], v121, s[32:35], s58 offen sc1
    s_waitcnt lgkmcnt(0)
    s_lshl4_add_u32 s58, s6, 262144
    s_add_u32 m0, s4, 98304
    s_nop 0
    buffer_load_dwordx4 v122, s[28:31], s58 offen  lds
    s_lshl4_add_u32 s58, s6, 270336
    s_add_u32 m0, s4, 99328
    s_nop 0
    buffer_load_dwordx4 v122, s[28:31], s58 offen  lds
    s_lshl4_add_u32 s58, s6, 278528
    s_add_u32 m0, s4, 100352
    s_nop 0
    buffer_load_dwordx4 v122, s[28:31], s58 offen  lds
    s_lshl4_add_u32 s58, s6, 286720
    s_add_u32 m0, s4, 101376
    s_nop 0
    buffer_load_dwordx4 v122, s[28:31], s58 offen  lds
    s_setprio 2
    v_lshlrev_b32 v7, 4, v0
    s_add_u32 s55, s4, 49152
    v_add_u32 v7, s55, v7
    s_waitcnt vmcnt(15)
    v_mfma_f32_16x16x32_bf16 v[56:59], a[0:3], v[72:75], 0
    v_mfma_f32_16x16x32_bf16 v[60:63], a[4:7], v[72:75], 0
    v_mfma_f32_16x16x32_bf16 v[64:67], a[8:11], v[72:75], 0
    v_mfma_f32_16x16x32_bf16 v[68:71], a[12:15], v[72:75], 0
    s_add_u32 s57, s43, 67584
    s_add_u32 s58, s15, s57
    buffer_load_dwordx4 v[72:75], v121, s[32:35], s58 offen sc1
    s_waitcnt vmcnt(15)
    v_mfma_f32_16x16x32_bf16 v[24:27], a[0:3], v[76:79], 0
    v_mfma_f32_16x16x32_bf16 v[28:31], a[4:7], v[76:79], 0
    v_mfma_f32_16x16x32_bf16 v[32:35], a[8:11], v[76:79], 0
    v_mfma_f32_16x16x32_bf16 v[36:39], a[12:15], v[76:79], 0
    s_add_u32 s58, s13, s57
    buffer_load_dwordx4 v[76:79], v121, s[32:35], s58 offen sc1
    s_waitcnt vmcnt(15)
    v_mfma_f32_16x16x32_bf16 v[40:43], a[0:3], v[80:83], 0
    v_mfma_f32_16x16x32_bf16 v[44:47], a[4:7], v[80:83], 0
    v_mfma_f32_16x16x32_bf16 v[48:51], a[8:11], v[80:83], 0
    v_mfma_f32_16x16x32_bf16 v[52:55], a[12:15], v[80:83], 0
    s_add_u32 s58, s14, s57
    buffer_load_dwordx4 v[80:83], v121, s[32:35], s58 offen sc1
    s_waitcnt vmcnt(15)
    v_mfma_f32_16x16x32_bf16 v[8:11], a[0:3], v[84:87], 0
    v_mfma_f32_16x16x32_bf16 v[12:15], a[4:7], v[84:87], 0
    v_mfma_f32_16x16x32_bf16 v[16:19], a[8:11], v[84:87], 0
    v_mfma_f32_16x16x32_bf16 v[20:23], a[12:15], v[84:87], 0
    s_add_u32 s58, s12, s57
    buffer_load_dwordx4 v[84:87], v121, s[32:35], s58 offen sc1
    s_waitcnt vmcnt(15)
    v_mfma_f32_16x16x32_bf16 v[56:59], a[16:19], v[88:91], v[56:59]
    v_mfma_f32_16x16x32_bf16 v[60:63], a[20:23], v[88:91], v[60:63]
    v_mfma_f32_16x16x32_bf16 v[64:67], a[24:27], v[88:91], v[64:67]
    v_mfma_f32_16x16x32_bf16 v[68:71], a[28:31], v[88:91], v[68:71]
    s_add_u32 s57, s43, 2048
    s_add_u32 s58, s15, s57
    buffer_load_dwordx4 a[0:3], v121, s[32:35], s58 offen sc1
    s_waitcnt vmcnt(15)
    v_mfma_f32_16x16x32_bf16 v[24:27], a[16:19], v[92:95], v[24:27]
    v_mfma_f32_16x16x32_bf16 v[28:31], a[20:23], v[92:95], v[28:31]
    v_mfma_f32_16x16x32_bf16 v[32:35], a[24:27], v[92:95], v[32:35]
    v_mfma_f32_16x16x32_bf16 v[36:39], a[28:31], v[92:95], v[36:39]
    s_add_u32 s58, s13, s57
    buffer_load_dwordx4 a[4:7], v121, s[32:35], s58 offen sc1
    s_waitcnt vmcnt(15)
    v_mfma_f32_16x16x32_bf16 v[40:43], a[16:19], v[96:99], v[40:43]
    v_mfma_f32_16x16x32_bf16 v[44:47], a[20:23], v[96:99], v[44:47]
    v_mfma_f32_16x16x32_bf16 v[48:51], a[24:27], v[96:99], v[48:51]
    v_mfma_f32_16x16x32_bf16 v[52:55], a[28:31], v[96:99], v[52:55]
    s_add_u32 s58, s14, s57
    buffer_load_dwordx4 a[8:11], v121, s[32:35], s58 offen sc1
    s_waitcnt vmcnt(15)
    v_mfma_f32_16x16x32_bf16 v[8:11], a[16:19], v[100:103], v[8:11]
    v_mfma_f32_16x16x32_bf16 v[12:15], a[20:23], v[100:103], v[12:15]
    v_mfma_f32_16x16x32_bf16 v[16:19], a[24:27], v[100:103], v[16:19]
    v_mfma_f32_16x16x32_bf16 v[20:23], a[28:31], v[100:103], v[20:23]
    s_add_u32 s58, s12, s57
    buffer_load_dwordx4 a[12:15], v121, s[32:35], s58 offen sc1
    s_waitcnt vmcnt(15)
    v_mfma_f32_16x16x32_bf16 v[56:59], a[32:35], v[104:107], v[56:59]
    s_lshl_b32 s53, s96, 13
    s_add_u32 s53, s53, 14811264
    s_mov_b64 exec, 0x77
    buffer_load_dword v124, v125, s[32:35], s53 offen sc1
    s_mov_b64 exec, -1
    v_mfma_f32_16x16x32_bf16 v[60:63], a[36:39], v[104:107], v[60:63]
    v_mfma_f32_16x16x32_bf16 v[64:67], a[40:43], v[104:107], v[64:67]
    v_mfma_f32_16x16x32_bf16 v[68:71], a[44:47], v[104:107], v[68:71]
    s_add_u32 s57, s43, 24576
    s_add_u32 s58, s15, s57
    buffer_load_dwordx4 v[88:91], v121, s[32:35], s58 offen sc1
    s_waitcnt vmcnt(16)
    v_mfma_f32_16x16x32_bf16 v[24:27], a[32:35], v[108:111], v[24:27]
    v_mfma_f32_16x16x32_bf16 v[28:31], a[36:39], v[108:111], v[28:31]
    v_mfma_f32_16x16x32_bf16 v[32:35], a[40:43], v[108:111], v[32:35]
    v_mfma_f32_16x16x32_bf16 v[36:39], a[44:47], v[108:111], v[36:39]
    s_add_u32 s58, s13, s57
    buffer_load_dwordx4 v[92:95], v121, s[32:35], s58 offen sc1
    s_waitcnt vmcnt(16)
    v_mfma_f32_16x16x32_bf16 v[40:43], a[32:35], v[112:115], v[40:43]
    v_mfma_f32_16x16x32_bf16 v[44:47], a[36:39], v[112:115], v[44:47]
    v_mfma_f32_16x16x32_bf16 v[48:51], a[40:43], v[112:115], v[48:51]
    v_mfma_f32_16x16x32_bf16 v[52:55], a[44:47], v[112:115], v[52:55]
    s_add_u32 s58, s14, s57
    buffer_load_dwordx4 v[96:99], v121, s[32:35], s58 offen sc1
    s_waitcnt vmcnt(16)
    v_mfma_f32_16x16x32_bf16 v[8:11], a[32:35], v[116:119], v[8:11]
    v_mfma_f32_16x16x32_bf16 v[12:15], a[36:39], v[116:119], v[12:15]
    v_mfma_f32_16x16x32_bf16 v[16:19], a[40:43], v[116:119], v[16:19]
    v_mfma_f32_16x16x32_bf16 v[20:23], a[44:47], v[116:119], v[20:23]
    s_add_u32 s58, s12, s57
    buffer_load_dwordx4 v[100:103], v121, s[32:35], s58 offen sc1
    s_waitcnt vmcnt(12)
    v_mfma_f32_16x16x32_bf16 v[56:59], a[48:51], v[72:75], v[56:59]
    v_mfma_f32_16x16x32_bf16 v[60:63], a[52:55], v[72:75], v[60:63]
    v_mfma_f32_16x16x32_bf16 v[64:67], a[56:59], v[72:75], v[64:67]
    v_mfma_f32_16x16x32_bf16 v[68:71], a[60:63], v[72:75], v[68:71]
    s_add_u32 s57, s43, 47104
    s_add_u32 s58, s15, s57
    buffer_load_dwordx4 a[16:19], v121, s[32:35], s58 offen sc1
    s_waitcnt vmcnt(12)
    v_mfma_f32_16x16x32_bf16 v[24:27], a[48:51], v[76:79], v[24:27]
    v_mfma_f32_16x16x32_bf16 v[28:31], a[52:55], v[76:79], v[28:31]
    v_mfma_f32_16x16x32_bf16 v[32:35], a[56:59], v[76:79], v[32:35]
    v_mfma_f32_16x16x32_bf16 v[36:39], a[60:63], v[76:79], v[36:39]
    s_add_u32 s58, s13, s57
    buffer_load_dwordx4 a[20:23], v121, s[32:35], s58 offen sc1
    s_waitcnt vmcnt(12)
    v_mfma_f32_16x16x32_bf16 v[40:43], a[48:51], v[80:83], v[40:43]
    v_mfma_f32_16x16x32_bf16 v[44:47], a[52:55], v[80:83], v[44:47]
    v_mfma_f32_16x16x32_bf16 v[48:51], a[56:59], v[80:83], v[48:51]
    v_mfma_f32_16x16x32_bf16 v[52:55], a[60:63], v[80:83], v[52:55]
    s_add_u32 s58, s14, s57
    buffer_load_dwordx4 a[24:27], v121, s[32:35], s58 offen sc1
    s_waitcnt vmcnt(12)
    v_mfma_f32_16x16x32_bf16 v[8:11], a[48:51], v[84:87], v[8:11]
    v_mfma_f32_16x16x32_bf16 v[12:15], a[52:55], v[84:87], v[12:15]
    v_mfma_f32_16x16x32_bf16 v[16:19], a[56:59], v[84:87], v[16:19]
    v_mfma_f32_16x16x32_bf16 v[20:23], a[60:63], v[84:87], v[20:23]
    s_add_u32 s58, s12, s57
    buffer_load_dwordx4 a[28:31], v121, s[32:35], s58 offen sc1
    s_waitcnt vmcnt(12)
    v_mfma_f32_16x16x32_bf16 v[56:59], a[64:67], a[0:3], v[56:59]
    v_mfma_f32_16x16x32_bf16 v[60:63], a[68:71], a[0:3], v[60:63]
    v_mfma_f32_16x16x32_bf16 v[64:67], a[72:75], a[0:3], v[64:67]
    v_mfma_f32_16x16x32_bf16 v[68:71], a[76:79], a[0:3], v[68:71]
    s_add_u32 s57, s43, 69632
    s_cmp_eq_u32 s52, 3
    s_cselect_b32 s57, s41, s57
    s_add_u32 s58, s15, s57
    buffer_load_dwordx4 v[104:107], v121, s[32:35], s58 offen sc1
    s_waitcnt vmcnt(12)
    v_mfma_f32_16x16x32_bf16 v[24:27], a[64:67], a[4:7], v[24:27]
    v_mfma_f32_16x16x32_bf16 v[28:31], a[68:71], a[4:7], v[28:31]
    v_mfma_f32_16x16x32_bf16 v[32:35], a[72:75], a[4:7], v[32:35]
    v_mfma_f32_16x16x32_bf16 v[36:39], a[76:79], a[4:7], v[36:39]
    s_add_u32 s58, s13, s57
    buffer_load_dwordx4 v[108:111], v121, s[32:35], s58 offen sc1
    s_waitcnt vmcnt(12)
    v_mfma_f32_16x16x32_bf16 v[40:43], a[64:67], a[8:11], v[40:43]
    v_mfma_f32_16x16x32_bf16 v[44:47], a[68:71], a[8:11], v[44:47]
    v_mfma_f32_16x16x32_bf16 v[48:51], a[72:75], a[8:11], v[48:51]
    v_mfma_f32_16x16x32_bf16 v[52:55], a[76:79], a[8:11], v[52:55]
    s_add_u32 s58, s14, s57
    buffer_load_dwordx4 v[112:115], v121, s[32:35], s58 offen sc1
    s_waitcnt vmcnt(12)
    v_mfma_f32_16x16x32_bf16 v[8:11], a[64:67], a[12:15], v[8:11]
    v_mfma_f32_16x16x32_bf16 v[12:15], a[68:71], a[12:15], v[12:15]
    v_mfma_f32_16x16x32_bf16 v[16:19], a[72:75], a[12:15], v[16:19]
    v_mfma_f32_16x16x32_bf16 v[20:23], a[76:79], a[12:15], v[20:23]
    s_add_u32 s58, s12, s57
    buffer_load_dwordx4 v[116:119], v121, s[32:35], s58 offen sc1
    s_waitcnt vmcnt(11)
    v_mfma_f32_16x16x32_bf16 v[56:59], a[80:83], v[88:91], v[56:59]
    v_mfma_f32_16x16x32_bf16 v[60:63], a[84:87], v[88:91], v[60:63]
    v_mfma_f32_16x16x32_bf16 v[64:67], a[88:91], v[88:91], v[64:67]
    v_mfma_f32_16x16x32_bf16 v[68:71], a[92:95], v[88:91], v[68:71]
    v_cmp_ne_u32 vcc, s100, v124
    s_nop 0
    s_and_b32 vcc_lo, vcc_lo, 0x77
    s_cbranch_scc1 L_gated_mix__sliding_block__swiglu_ffn__prompt_kernel_poll_39
L_gated_mix__sliding_block__swiglu_ffn__prompt_kernel_poll_39b:
    s_add_u32 s57, s51, 4096
    s_add_u32 s58, s15, s57
    buffer_load_dwordx4 a[32:35], v121, s[32:35], s58 offen sc1
    s_waitcnt vmcnt(11)
    v_mfma_f32_16x16x32_bf16 v[24:27], a[80:83], v[92:95], v[24:27]
    v_mfma_f32_16x16x32_bf16 v[28:31], a[84:87], v[92:95], v[28:31]
    v_mfma_f32_16x16x32_bf16 v[32:35], a[88:91], v[92:95], v[32:35]
    v_mfma_f32_16x16x32_bf16 v[36:39], a[92:95], v[92:95], v[36:39]
    s_add_u32 s58, s13, s57
    buffer_load_dwordx4 a[36:39], v121, s[32:35], s58 offen sc1
    s_waitcnt vmcnt(11)
    v_mfma_f32_16x16x32_bf16 v[40:43], a[80:83], v[96:99], v[40:43]
    v_mfma_f32_16x16x32_bf16 v[44:47], a[84:87], v[96:99], v[44:47]
    v_mfma_f32_16x16x32_bf16 v[48:51], a[88:91], v[96:99], v[48:51]
    v_mfma_f32_16x16x32_bf16 v[52:55], a[92:95], v[96:99], v[52:55]
    s_add_u32 s58, s14, s57
    buffer_load_dwordx4 a[40:43], v121, s[32:35], s58 offen sc1
    s_waitcnt vmcnt(11)
    v_mfma_f32_16x16x32_bf16 v[8:11], a[80:83], v[100:103], v[8:11]
    v_mfma_f32_16x16x32_bf16 v[12:15], a[84:87], v[100:103], v[12:15]
    v_mfma_f32_16x16x32_bf16 v[16:19], a[88:91], v[100:103], v[16:19]
    v_mfma_f32_16x16x32_bf16 v[20:23], a[92:95], v[100:103], v[20:23]
    s_add_u32 s58, s12, s57
    buffer_load_dwordx4 a[44:47], v121, s[32:35], s58 offen sc1
    s_waitcnt vmcnt(11)
    v_mfma_f32_16x16x32_bf16 v[56:59], a[96:99], a[16:19], v[56:59]
    v_mfma_f32_16x16x32_bf16 v[60:63], a[100:103], a[16:19], v[60:63]
    v_mfma_f32_16x16x32_bf16 v[64:67], a[104:107], a[16:19], v[64:67]
    v_mfma_f32_16x16x32_bf16 v[68:71], a[108:111], a[16:19], v[68:71]
    s_add_u32 s57, s51, 10240
    s_add_u32 s58, s15, s57
    buffer_load_dwordx4 v[72:75], v121, s[32:35], s58 offen sc1
    s_waitcnt vmcnt(11)
    v_mfma_f32_16x16x32_bf16 v[24:27], a[96:99], a[20:23], v[24:27]
    v_mfma_f32_16x16x32_bf16 v[28:31], a[100:103], a[20:23], v[28:31]
    v_mfma_f32_16x16x32_bf16 v[32:35], a[104:107], a[20:23], v[32:35]
    v_mfma_f32_16x16x32_bf16 v[36:39], a[108:111], a[20:23], v[36:39]
    s_add_u32 s58, s13, s57
    buffer_load_dwordx4 v[76:79], v121, s[32:35], s58 offen sc1
    s_waitcnt vmcnt(11)
    v_mfma_f32_16x16x32_bf16 v[40:43], a[96:99], a[24:27], v[40:43]
    ds_read_b64_tr_b16 v[80:81], v1 offset:0
    v_mfma_f32_16x16x32_bf16 v[44:47], a[100:103], a[24:27], v[44:47]
    ds_read_b64_tr_b16 v[82:83], v1 offset:2048
    v_mfma_f32_16x16x32_bf16 v[48:51], a[104:107], a[24:27], v[48:51]
    ds_read_b64_tr_b16 v[84:85], v1 offset:8
    v_mfma_f32_16x16x32_bf16 v[52:55], a[108:111], a[24:27], v[52:55]
    s_add_u32 s58, s14, s57
    buffer_load_dwordx4 a[56:59], v121, s[32:35], s58 offen sc1
    s_waitcnt vmcnt(11)
    v_mfma_f32_16x16x32_bf16 v[8:11], a[96:99], a[28:31], v[8:11]
    ds_read_b64_tr_b16 v[86:87], v1 offset:2056
    v_mfma_f32_16x16x32_bf16 v[12:15], a[100:103], a[28:31], v[12:15]
    ds_read_b64_tr_b16 a[48:49], v2 offset:0
    v_mfma_f32_16x16x32_bf16 v[16:19], a[104:107], a[28:31], v[16:19]
    ds_read_b64_tr_b16 a[50:51], v2 offset:2048
    v_mfma_f32_16x16x32_bf16 v[20:23], a[108:111], a[28:31], v[20:23]
    s_add_u32 s58, s12, s57
    buffer_load_dwordx4 a[60:63], v121, s[32:35], s58 offen sc1
    s_waitcnt vmcnt(11)
    v_mfma_f32_16x16x32_bf16 v[56:59], a[112:115], v[104:107], v[56:59]
    ds_read_b64_tr_b16 a[52:53], v2 offset:8
    s_lshl_b32 s54, s96, 13
    s_add_u32 s54, s54, 15073408
    s_mov_b64 exec, 0xff
    buffer_load_dword v127, v126, s[32:35], s54 offen sc1
    s_mov_b64 exec, -1
    v_mfma_f32_16x16x32_bf16 v[60:63], a[116:119], v[104:107], v[60:63]
    ds_read_b64_tr_b16 a[54:55], v2 offset:2056
    v_mfma_f32_16x16x32_bf16 v[64:67], a[120:123], v[104:107], v[64:67]
    v_mfma_f32_16x16x32_bf16 v[68:71], a[124:127], v[104:107], v[68:71]
    s_add_u32 s57, s51, 16384
    s_add_u32 s58, s15, s57
    buffer_load_dwordx4 a[0:3], v121, s[32:35], s58 offen sc1
    s_waitcnt vmcnt(12)
    v_mfma_f32_16x16x32_bf16 v[24:27], a[112:115], v[108:111], v[24:27]
    v_mfma_f32_16x16x32_bf16 v[28:31], a[116:119], v[108:111], v[28:31]
    v_mfma_f32_16x16x32_bf16 v[32:35], a[120:123], v[108:111], v[32:35]
    v_mfma_f32_16x16x32_bf16 v[36:39], a[124:127], v[108:111], v[36:39]
    s_add_u32 s58, s13, s57
    buffer_load_dwordx4 a[4:7], v121, s[32:35], s58 offen sc1
    s_waitcnt vmcnt(12)
    v_mfma_f32_16x16x32_bf16 v[40:43], a[112:115], v[112:115], v[40:43]
    ds_read_b64_tr_b16 a[8:9], v1 offset:16384
    v_mfma_f32_16x16x32_bf16 v[44:47], a[116:119], v[112:115], v[44:47]
    ds_read_b64_tr_b16 a[10:11], v1 offset:18432
    v_mfma_f32_16x16x32_bf16 v[48:51], a[120:123], v[112:115], v[48:51]
    ds_read_b64_tr_b16 a[12:13], v1 offset:16392
    v_mfma_f32_16x16x32_bf16 v[52:55], a[124:127], v[112:115], v[52:55]
    s_add_u32 s58, s14, s57
    buffer_load_dwordx4 a[72:75], v121, s[32:35], s58 offen sc1
    s_waitcnt vmcnt(12)
    v_mfma_f32_16x16x32_bf16 v[8:11], a[112:115], v[116:119], v[8:11]
    ds_read_b64_tr_b16 a[14:15], v1 offset:18440
    v_mfma_f32_16x16x32_bf16 v[12:15], a[116:119], v[116:119], v[12:15]
    ds_read_b64_tr_b16 a[64:65], v2 offset:16384
    v_mfma_f32_16x16x32_bf16 v[16:19], a[120:123], v[116:119], v[16:19]
    ds_read_b64_tr_b16 a[66:67], v2 offset:18432
    v_mfma_f32_16x16x32_bf16 v[20:23], a[124:127], v[116:119], v[20:23]
    s_add_u32 s58, s12, s57
    buffer_load_dwordx4 a[76:79], v121, s[32:35], s58 offen sc1
    s_waitcnt vmcnt(12)
    s_waitcnt lgkmcnt(6)
    v_mfma_f32_16x16x32_bf16 v[56:59], v[80:83], a[32:35], v[56:59]
    ds_read_b64_tr_b16 a[68:69], v2 offset:16392
    v_mfma_f32_16x16x32_bf16 v[60:63], v[84:87], a[32:35], v[60:63]
    ds_read_b64_tr_b16 a[70:71], v2 offset:18440
    s_lshl4_add_u32 s58, s6, 393216
    s_add_u32 m0, s4, 49152
    s_nop 0
    buffer_load_dwordx4 v122, s[28:31], s58 offen  lds
    v_mfma_f32_16x16x32_bf16 v[64:67], a[48:51], a[32:35], v[64:67]
    v_mfma_f32_16x16x32_bf16 v[68:71], a[52:55], a[32:35], v[68:71]
    s_waitcnt vmcnt(12)
    v_mfma_f32_16x16x32_bf16 v[24:27], v[80:83], a[36:39], v[24:27]
    v_mfma_f32_16x16x32_bf16 v[28:31], v[84:87], a[36:39], v[28:31]
    s_lshl4_add_u32 s58, s6, 401408
    s_add_u32 m0, s4, 50176
    s_nop 0
    buffer_load_dwordx4 v122, s[28:31], s58 offen  lds
    v_mfma_f32_16x16x32_bf16 v[32:35], a[48:51], a[36:39], v[32:35]
    v_mfma_f32_16x16x32_bf16 v[36:39], a[52:55], a[36:39], v[36:39]
    s_waitcnt vmcnt(12)
    v_mfma_f32_16x16x32_bf16 v[40:43], v[80:83], a[40:43], v[40:43]
    ds_read_b64_tr_b16 v[88:89], v3 offset:0
    v_mfma_f32_16x16x32_bf16 v[44:47], v[84:87], a[40:43], v[44:47]
    ds_read_b64_tr_b16 v[90:91], v3 offset:2048
    s_lshl4_add_u32 s58, s6, 409600
    s_add_u32 m0, s4, 51200
    s_nop 0
    buffer_load_dwordx4 v122, s[28:31], s58 offen  lds
    v_mfma_f32_16x16x32_bf16 v[48:51], a[48:51], a[40:43], v[48:51]
    ds_read_b64_tr_b16 v[92:93], v3 offset:8
    v_mfma_f32_16x16x32_bf16 v[52:55], a[52:55], a[40:43], v[52:55]
    s_waitcnt vmcnt(7)
    v_cmp_ne_u32 vcc, s100, v127
    s_nop 0
    s_and_b32 vcc_lo, vcc_lo, 0xff
    s_cbranch_scc1 L_gated_mix__sliding_block__swiglu_ffn__prompt_kernel_poll_40
L_gated_mix__sliding_block__swiglu_ffn__prompt_kernel_poll_40b:
    s_add_u32 s57, s6, 88064
    s_add_u32 s58, s15, s57
    buffer_load_dwordx4 a[80:83], v121, s[32:35], s58 offen sc1
    v_mfma_f32_16x16x32_bf16 v[8:11], v[80:83], a[44:47], v[8:11]
    ds_read_b64_tr_b16 v[94:95], v3 offset:2056
    v_mfma_f32_16x16x32_bf16 v[12:15], v[84:87], a[44:47], v[12:15]
    ds_read_b64_tr_b16 v[96:97], v4 offset:0
    s_lshl4_add_u32 s58, s6, 417792
    s_add_u32 m0, s4, 52224
    s_nop 0
    buffer_load_dwordx4 v122, s[28:31], s58 offen  lds
    v_mfma_f32_16x16x32_bf16 v[16:19], a[48:51], a[44:47], v[16:19]
    ds_read_b64_tr_b16 v[98:99], v4 offset:2048
    v_mfma_f32_16x16x32_bf16 v[20:23], a[52:55], a[44:47], v[20:23]
    s_add_u32 s58, s13, s57
    buffer_load_dwordx4 a[84:87], v121, s[32:35], s58 offen sc1
    s_waitcnt lgkmcnt(6)
    v_mfma_f32_16x16x32_bf16 v[56:59], a[8:11], v[72:75], v[56:59]
    ds_read_b64_tr_b16 v[100:101], v4 offset:8
    v_mfma_f32_16x16x32_bf16 v[60:63], a[12:15], v[72:75], v[60:63]
    ds_read_b64_tr_b16 v[102:103], v4 offset:2056
    v_mfma_f32_16x16x32_bf16 v[64:67], a[64:67], v[72:75], v[64:67]
    v_mfma_f32_16x16x32_bf16 v[68:71], a[68:71], v[72:75], v[68:71]
    s_add_u32 s58, s14, s57
    buffer_load_dwordx4 a[88:91], v121, s[32:35], s58 offen sc1
    v_mfma_f32_16x16x32_bf16 v[24:27], a[8:11], v[76:79], v[24:27]
    v_mfma_f32_16x16x32_bf16 v[28:31], a[12:15], v[76:79], v[28:31]
    v_mfma_f32_16x16x32_bf16 v[32:35], a[64:67], v[76:79], v[32:35]
    v_mfma_f32_16x16x32_bf16 v[36:39], a[68:71], v[76:79], v[36:39]
    s_add_u32 s58, s12, s57
    buffer_load_dwordx4 a[92:95], v121, s[32:35], s58 offen sc1
    v_mfma_f32_16x16x32_bf16 v[40:43], a[8:11], a[56:59], v[40:43]
    ds_read_b64_tr_b16 a[16:17], v3 offset:16384
    v_mfma_f32_16x16x32_bf16 v[44:47], a[12:15], a[56:59], v[44:47]
    ds_read_b64_tr_b16 a[18:19], v3 offset:18432
    v_mfma_f32_16x16x32_bf16 v[48:51], a[64:67], a[56:59], v[48:51]
    ds_read_b64_tr_b16 a[20:21], v3 offset:16392
    v_mfma_f32_16x16x32_bf16 v[52:55], a[68:71], a[56:59], v[52:55]
    s_add_u32 s57, s6, 96256
    s_add_u32 s58, s15, s57
    buffer_load_dwordx4 a[96:99], v121, s[32:35], s58 offen sc1
    v_mfma_f32_16x16x32_bf16 v[8:11], a[8:11], a[60:63], v[8:11]
    ds_read_b64_tr_b16 a[22:23], v3 offset:18440
    v_mfma_f32_16x16x32_bf16 v[12:15], a[12:15], a[60:63], v[12:15]
    ds_read_b64_tr_b16 a[24:25], v4 offset:16384
    v_mfma_f32_16x16x32_bf16 v[16:19], a[64:67], a[60:63], v[16:19]
    ds_read_b64_tr_b16 a[26:27], v4 offset:18432
    v_mfma_f32_16x16x32_bf16 v[20:23], a[68:71], a[60:63], v[20:23]
    s_add_u32 s58, s13, s57
    buffer_load_dwordx4 a[100:103], v121, s[32:35], s58 offen sc1
    s_waitcnt vmcnt(13)
    s_waitcnt lgkmcnt(6)
    v_mfma_f32_16x16x32_bf16 v[56:59], v[88:91], a[0:3], v[56:59]
    ds_read_b64_tr_b16 a[28:29], v4 offset:16392
    v_mfma_f32_16x16x32_bf16 v[60:63], v[92:95], a[0:3], v[60:63]
    ds_read_b64_tr_b16 a[30:31], v4 offset:18440
    v_mfma_f32_16x16x32_bf16 v[64:67], v[96:99], a[0:3], v[64:67]
    v_mfma_f32_16x16x32_bf16 v[68:71], v[100:103], a[0:3], v[68:71]
    s_add_u32 s58, s14, s57
    buffer_load_dwordx4 a[104:107], v121, s[32:35], s58 offen sc1
    s_waitcnt vmcnt(13)
    v_mfma_f32_16x16x32_bf16 v[24:27], v[88:91], a[4:7], v[24:27]
    v_mfma_f32_16x16x32_bf16 v[28:31], v[92:95], a[4:7], v[28:31]
    v_mfma_f32_16x16x32_bf16 v[32:35], v[96:99], a[4:7], v[32:35]
    v_mfma_f32_16x16x32_bf16 v[36:39], v[100:103], a[4:7], v[36:39]
    s_add_u32 s58, s12, s57
    buffer_load_dwordx4 a[108:111], v121, s[32:35], s58 offen sc1
    s_waitcnt vmcnt(13)
    v_mfma_f32_16x16x32_bf16 v[40:43], v[88:91], a[72:75], v[40:43]
    ds_read_b64_tr_b16 v[104:105], v1 offset:32768
    v_mfma_f32_16x16x32_bf16 v[44:47], v[92:95], a[72:75], v[44:47]
    ds_read_b64_tr_b16 v[106:107], v1 offset:34816
    v_mfma_f32_16x16x32_bf16 v[48:51], v[96:99], a[72:75], v[48:51]
    ds_read_b64_tr_b16 v[108:109], v1 offset:32776
    v_mfma_f32_16x16x32_bf16 v[52:55], v[100:103], a[72:75], v[52:55]
    s_add_u32 s57, s6, 104448
    s_add_u32 s58, s15, s57
    buffer_load_dwordx4 a[112:115], v121, s[32:35], s58 offen sc1
    s_waitcnt vmcnt(13)
    v_mfma_f32_16x16x32_bf16 v[8:11], v[88:91], a[76:79], v[8:11]
    ds_read_b64_tr_b16 v[110:111], v1 offset:34824
    v_mfma_f32_16x16x32_bf16 v[12:15], v[92:95], a[76:79], v[12:15]
    ds_read_b64_tr_b16 v[112:113], v2 offset:32768
    v_mfma_f32_16x16x32_bf16 v[16:19], v[96:99], a[76:79], v[16:19]
    ds_read_b64_tr_b16 v[114:115], v2 offset:34816
    v_mfma_f32_16x16x32_bf16 v[20:23], v[100:103], a[76:79], v[20:23]
    s_add_u32 s57, s6, 112640
    s_add_u32 s58, s15, s57
    buffer_load_dwordx4 a[116:119], v121, s[32:35], s58 offen sc1
    s_waitcnt vmcnt(10)
    s_waitcnt lgkmcnt(6)
    v_mfma_f32_16x16x32_bf16 v[56:59], a[16:19], a[80:83], v[56:59]
    ds_read_b64_tr_b16 v[116:117], v2 offset:32776
    v_mfma_f32_16x16x32_bf16 v[60:63], a[20:23], a[80:83], v[60:63]
    ds_read_b64_tr_b16 v[118:119], v2 offset:34824
    v_mfma_f32_16x16x32_bf16 v[64:67], a[24:27], a[80:83], v[64:67]
    ds_read_b64_tr_b16 a[120:121], v1 offset:49152
    v_mfma_f32_16x16x32_bf16 v[68:71], a[28:31], a[80:83], v[68:71]
    s_add_u32 s57, s6, 104448
    s_add_u32 s58, s13, s57
    buffer_load_dwordx4 a[40:43], v121, s[32:35], s58 offen sc1
    s_waitcnt vmcnt(9)
    v_mfma_f32_16x16x32_bf16 v[24:27], a[16:19], a[84:87], v[24:27]
    ds_read_b64_tr_b16 a[122:123], v1 offset:51200
    v_mfma_f32_16x16x32_bf16 v[28:31], a[20:23], a[84:87], v[28:31]
    ds_read_b64_tr_b16 a[124:125], v1 offset:49160
    v_mfma_f32_16x16x32_bf16 v[32:35], a[24:27], a[84:87], v[32:35]
    ds_read_b64_tr_b16 a[126:127], v1 offset:51208
    v_mfma_f32_16x16x32_bf16 v[36:39], a[28:31], a[84:87], v[36:39]
    s_add_u32 s57, s6, 112640
    s_add_u32 s58, s13, s57
    buffer_load_dwordx4 a[44:47], v121, s[32:35], s58 offen sc1
    s_waitcnt vmcnt(9)
    v_mfma_f32_16x16x32_bf16 v[40:43], a[16:19], a[88:91], v[40:43]
    ds_read_b64_tr_b16 a[32:33], v2 offset:49152
    v_mfma_f32_16x16x32_bf16 v[44:47], a[20:23], a[88:91], v[44:47]
    ds_read_b64_tr_b16 a[34:35], v2 offset:51200
    v_mfma_f32_16x16x32_bf16 v[48:51], a[24:27], a[88:91], v[48:51]
    ds_read_b64_tr_b16 a[36:37], v2 offset:49160
    v_mfma_f32_16x16x32_bf16 v[52:55], a[28:31], a[88:91], v[52:55]
    s_add_u32 s57, s6, 104448
    s_add_u32 s58, s14, s57
    buffer_load_dwordx4 v[72:75], v121, s[32:35], s58 offen sc1
    s_waitcnt vmcnt(9)
    v_mfma_f32_16x16x32_bf16 v[8:11], a[16:19], a[92:95], v[8:11]
    ds_read_b64_tr_b16 a[38:39], v2 offset:51208
    v_mfma_f32_16x16x32_bf16 v[12:15], a[20:23], a[92:95], v[12:15]
    ds_read_b64_tr_b16 v[80:81], v1 offset:0
    v_mfma_f32_16x16x32_bf16 v[16:19], a[24:27], a[92:95], v[16:19]
    ds_read_b64_tr_b16 v[82:83], v1 offset:2048
    v_mfma_f32_16x16x32_bf16 v[20:23], a[28:31], a[92:95], v[20:23]
    s_add_u32 s57, s6, 112640
    s_add_u32 s58, s14, s57
    buffer_load_dwordx4 v[76:79], v121, s[32:35], s58 offen sc1
    s_waitcnt vmcnt(9)
    s_waitcnt lgkmcnt(10)
    v_mfma_f32_16x16x32_bf16 v[56:59], v[104:107], a[96:99], v[56:59]
    ds_read_b64_tr_b16 v[84:85], v1 offset:8
    v_mfma_f32_16x16x32_bf16 v[60:63], v[108:111], a[96:99], v[60:63]
    ds_read_b64_tr_b16 v[86:87], v1 offset:2056
    v_mfma_f32_16x16x32_bf16 v[64:67], v[112:115], a[96:99], v[64:67]
    ds_read_b64_tr_b16 a[48:49], v2 offset:0
    v_mfma_f32_16x16x32_bf16 v[68:71], v[116:119], a[96:99], v[68:71]
    s_add_u32 s57, s6, 104448
    s_add_u32 s58, s12, s57
    buffer_load_dwordx4 a[56:59], v121, s[32:35], s58 offen sc1
    s_waitcnt vmcnt(9)
    v_mfma_f32_16x16x32_bf16 v[24:27], v[104:107], a[100:103], v[24:27]
    ds_read_b64_tr_b16 a[50:51], v2 offset:2048
    v_mfma_f32_16x16x32_bf16 v[28:31], v[108:111], a[100:103], v[28:31]
    ds_read_b64_tr_b16 a[52:53], v2 offset:8
    v_mfma_f32_16x16x32_bf16 v[32:35], v[112:115], a[100:103], v[32:35]
    ds_read_b64_tr_b16 a[54:55], v2 offset:2056
    v_mfma_f32_16x16x32_bf16 v[36:39], v[116:119], a[100:103], v[36:39]
    s_add_u32 s57, s6, 112640
    s_add_u32 s58, s12, s57
    buffer_load_dwordx4 a[60:63], v121, s[32:35], s58 offen sc1
    s_waitcnt vmcnt(9)
    v_mfma_f32_16x16x32_bf16 v[40:43], v[104:107], a[104:107], v[40:43]
    v_mfma_f32_16x16x32_bf16 v[44:47], v[108:111], a[104:107], v[44:47]
    v_mfma_f32_16x16x32_bf16 v[48:51], v[112:115], a[104:107], v[48:51]
    v_mfma_f32_16x16x32_bf16 v[52:55], v[116:119], a[104:107], v[52:55]
    s_waitcnt vmcnt(8)
    v_mfma_f32_16x16x32_bf16 v[8:11], v[104:107], a[108:111], v[8:11]
    v_mfma_f32_16x16x32_bf16 v[12:15], v[108:111], a[108:111], v[12:15]
    v_mfma_f32_16x16x32_bf16 v[16:19], v[112:115], a[108:111], v[16:19]
    v_mfma_f32_16x16x32_bf16 v[20:23], v[116:119], a[108:111], v[20:23]
    s_waitcnt vmcnt(7)
    s_waitcnt lgkmcnt(8)
    v_mfma_f32_16x16x32_bf16 v[56:59], a[120:123], a[112:115], v[56:59]
    v_mfma_f32_16x16x32_bf16 v[60:63], a[124:127], a[112:115], v[60:63]
    v_mfma_f32_16x16x32_bf16 v[64:67], a[32:35], a[112:115], v[64:67]
    v_mfma_f32_16x16x32_bf16 v[68:71], a[36:39], a[112:115], v[68:71]
    s_waitcnt vmcnt(6)
    s_waitcnt lgkmcnt(0)
    v_mfma_f32_16x16x32_bf16 v[56:59], v[80:83], a[116:119], v[56:59]
    v_mfma_f32_16x16x32_bf16 v[60:63], v[84:87], a[116:119], v[60:63]
    v_mfma_f32_16x16x32_bf16 v[64:67], a[48:51], a[116:119], v[64:67]
    v_mfma_f32_16x16x32_bf16 v[68:71], a[52:55], a[116:119], v[68:71]
    s_waitcnt vmcnt(5)
    v_mfma_f32_16x16x32_bf16 v[24:27], a[120:123], a[40:43], v[24:27]
    v_mfma_f32_16x16x32_bf16 v[28:31], a[124:127], a[40:43], v[28:31]
    s_nop 1
    ds_write_b128 v7, v[56:59] offset:32768
    v_mfma_f32_16x16x32_bf16 v[32:35], a[32:35], a[40:43], v[32:35]
    v_mfma_f32_16x16x32_bf16 v[36:39], a[36:39], a[40:43], v[36:39]
    ds_write_b128 v7, v[60:63] offset:33792
    s_waitcnt vmcnt(4)
    v_mfma_f32_16x16x32_bf16 v[24:27], v[80:83], a[44:47], v[24:27]
    v_mfma_f32_16x16x32_bf16 v[28:31], v[84:87], a[44:47], v[28:31]
    ds_write_b128 v7, v[64:67] offset:34816
    v_mfma_f32_16x16x32_bf16 v[32:35], a[48:51], a[44:47], v[32:35]
    v_mfma_f32_16x16x32_bf16 v[36:39], a[52:55], a[44:47], v[36:39]
    ds_write_b128 v7, v[68:71] offset:35840
    s_waitcnt vmcnt(3)
    v_mfma_f32_16x16x32_bf16 v[40:43], a[120:123], v[72:75], v[40:43]
    v_mfma_f32_16x16x32_bf16 v[44:47], a[124:127], v[72:75], v[44:47]
    ds_write_b128 v7, v[24:27] offset:0
    v_mfma_f32_16x16x32_bf16 v[48:51], a[32:35], v[72:75], v[48:51]
    v_mfma_f32_16x16x32_bf16 v[52:55], a[36:39], v[72:75], v[52:55]
    ds_write_b128 v7, v[28:31] offset:1024
    s_waitcnt vmcnt(2)
    v_mfma_f32_16x16x32_bf16 v[40:43], v[80:83], v[76:79], v[40:43]
    v_mfma_f32_16x16x32_bf16 v[44:47], v[84:87], v[76:79], v[44:47]
    ds_write_b128 v7, v[32:35] offset:2048
    v_mfma_f32_16x16x32_bf16 v[48:51], a[48:51], v[76:79], v[48:51]
    v_mfma_f32_16x16x32_bf16 v[52:55], a[52:55], v[76:79], v[52:55]
    ds_write_b128 v7, v[36:39] offset:3072
    s_waitcnt vmcnt(1)
    v_mfma_f32_16x16x32_bf16 v[8:11], a[120:123], a[56:59], v[8:11]
    v_mfma_f32_16x16x32_bf16 v[12:15], a[124:127], a[56:59], v[12:15]
    ds_write_b128 v7, v[40:43] offset:16384
    v_mfma_f32_16x16x32_bf16 v[16:19], a[32:35], a[56:59], v[16:19]
    v_mfma_f32_16x16x32_bf16 v[20:23], a[36:39], a[56:59], v[20:23]
    ds_write_b128 v7, v[44:47] offset:17408
    s_waitcnt vmcnt(0)
    v_mfma_f32_16x16x32_bf16 v[8:11], v[80:83], a[60:63], v[8:11]
    v_mfma_f32_16x16x32_bf16 v[12:15], v[84:87], a[60:63], v[12:15]
    ds_write_b128 v7, v[48:51] offset:18432
    v_mfma_f32_16x16x32_bf16 v[16:19], a[48:51], a[60:63], v[16:19]
    v_mfma_f32_16x16x32_bf16 v[20:23], a[52:55], a[60:63], v[20:23]
    ds_write_b128 v7, v[52:55] offset:19456
    v_xor_b32 v2, 4096, v7
    v_xor_b32 v3, 8192, v7
    v_xor_b32 v4, 12288, v7
    s_lshl2_add_u32 s57, s96, s52
    s_lshl_b32 s57, s57, 14
    s_lshl_b32 s58, s97, 7
    s_add_u32 s57, s57, s58
    v_and_b32 v5, 7, v0
    v_and_b32 v6, 48, v0
    v_lshl_add_u32 v5, v5, 10, v6
    v_and_b32 v6, 8, v0
    v_lshl_add_u32 v5, v6, 3, v5
    s_waitcnt lgkmcnt(0)
    s_barrier
    ds_read_b128 v[24:27], v2 offset:0
    ds_read_b128 v[40:43], v3 offset:16384
    ds_read_b128 v[56:59], v4 offset:32768
    ds_read_b128 v[28:31], v2 offset:1024
    ds_read_b128 v[44:47], v3 offset:17408
    ds_read_b128 v[60:63], v4 offset:33792
    ds_read_b128 v[32:35], v2 offset:2048
    ds_read_b128 v[48:51], v3 offset:18432
    ds_read_b128 v[64:67], v4 offset:34816
    ds_read_b128 v[36:39], v2 offset:3072
    ds_read_b128 v[52:55], v3 offset:19456
    ds_read_b128 v[68:71], v4 offset:35840
    s_waitcnt lgkmcnt(9)
    v_pk_add_f32 v[8:9], v[8:9], v[24:25]
    v_pk_add_f32 v[40:41], v[40:41], v[56:57]
    v_pk_add_f32 v[10:11], v[10:11], v[26:27]
    v_pk_add_f32 v[42:43], v[42:43], v[58:59]
    v_pk_add_f32 v[8:9], v[8:9], v[40:41]
    v_pk_add_f32 v[10:11], v[10:11], v[42:43]
    v_cvt_pk_bf16_f32 v72, v8, v9
    v_cvt_pk_bf16_f32 v73, v10, v11
    s_waitcnt lgkmcnt(6)
    v_pk_add_f32 v[12:13], v[12:13], v[28:29]
    v_pk_add_f32 v[44:45], v[44:45], v[60:61]
    v_pk_add_f32 v[14:15], v[14:15], v[30:31]
    v_pk_add_f32 v[46:47], v[46:47], v[62:63]
    v_pk_add_f32 v[12:13], v[12:13], v[44:45]
    v_pk_add_f32 v[14:15], v[14:15], v[46:47]
    v_cvt_pk_bf16_f32 v74, v12, v13
    v_cvt_pk_bf16_f32 v75, v14, v15
    s_waitcnt lgkmcnt(3)
    v_pk_add_f32 v[16:17], v[16:17], v[32:33]
    v_pk_add_f32 v[48:49], v[48:49], v[64:65]
    v_pk_add_f32 v[18:19], v[18:19], v[34:35]
    v_pk_add_f32 v[50:51], v[50:51], v[66:67]
    v_pk_add_f32 v[16:17], v[16:17], v[48:49]
    v_pk_add_f32 v[18:19], v[18:19], v[50:51]
    v_cvt_pk_bf16_f32 v76, v16, v17
    v_mov_b32 v80, v76
    v_cvt_pk_bf16_f32 v77, v18, v19
    v_mov_b32 v81, v77
    s_waitcnt lgkmcnt(0)
    v_pk_add_f32 v[20:21], v[20:21], v[36:37]
    v_pk_add_f32 v[52:53], v[52:53], v[68:69]
    v_pk_add_f32 v[22:23], v[22:23], v[38:39]
    v_pk_add_f32 v[54:55], v[54:55], v[70:71]
    v_pk_add_f32 v[20:21], v[20:21], v[52:53]
    v_pk_add_f32 v[22:23], v[22:23], v[54:55]
    v_cvt_pk_bf16_f32 v78, v20, v21
    v_mov_b32 v82, v78
    v_cvt_pk_bf16_f32 v79, v22, v23
    v_mov_b32 v83, v79
    v_mov_b32_dpp v76, v72 row_ror:8 row_mask:0xf bank_mask:0x3
    v_mov_b32_dpp v77, v73 row_ror:8 row_mask:0xf bank_mask:0x3
    v_mov_b32_dpp v78, v74 row_ror:8 row_mask:0xf bank_mask:0x3
    v_mov_b32_dpp v79, v75 row_ror:8 row_mask:0xf bank_mask:0x3
    v_mov_b32_dpp v72, v80 row_ror:8 row_mask:0xf bank_mask:0xc
    v_mov_b32_dpp v73, v81 row_ror:8 row_mask:0xf bank_mask:0xc
    v_mov_b32_dpp v74, v82 row_ror:8 row_mask:0xf bank_mask:0xc
    v_mov_b32_dpp v75, v83 row_ror:8 row_mask:0xf bank_mask:0xc
    s_add_u32 s58, s57, 8192
    buffer_store_dwordx4 v[76:79], v5, s[36:39], s58 offen sc1
    buffer_store_dwordx4 v[72:75], v5, s[36:39], s57 offen sc1
L_join:
    s_endpgm
L_gated_mix__sliding_block__swiglu_ffn__prompt_kernel_non_1:
    s_add_u32 s101, s101, 1
    s_cmp_gt_u32 s101, 400000
    s_cbranch_scc1 L_gated_mix__sliding_block__swiglu_ffn__prompt_kernel_non_1b
    buffer_load_dword v15, off, s[44:47], 0 sc1
    s_waitcnt vmcnt(0)
    v_readfirstlane_b32 s100, v15
    s_nop 1
    s_cmp_eq_u32 s100, 0
    s_cbranch_scc1 L_gated_mix__sliding_block__swiglu_ffn__prompt_kernel_non_1
    s_branch L_gated_mix__sliding_block__swiglu_ffn__prompt_kernel_non_1b
L_gated_mix__sliding_block__swiglu_ffn__prompt_kernel_poll_2:
    s_add_u32 s101, s101, 1
    s_cmp_gt_u32 s101, 400000
    s_cbranch_scc1 L_gated_mix__sliding_block__swiglu_ffn__prompt_kernel_poll_2b
    s_sleep 6
    s_mov_b64 exec, 0xfff0fff
    buffer_load_dword v41, v40, s[32:35], s54 offen sc1
    s_mov_b64 exec, -1
    s_waitcnt vmcnt(0)
    v_cmp_ne_u32 vcc, s100, v41
    s_nop 0
    s_and_b32 vcc_lo, vcc_lo, 0xfff0fff
    s_cbranch_scc1 L_gated_mix__sliding_block__swiglu_ffn__prompt_kernel_poll_2
    s_branch L_gated_mix__sliding_block__swiglu_ffn__prompt_kernel_poll_2b
L_at0_neg:
    v_mov_b32 v16, 0xf149f2ca
    v_mov_b32 v17, 0xf149f2ca
    v_mov_b32 v18, 0xf149f2ca
    v_mov_b32 v19, 0xf149f2ca
    v_mov_b32 v20, 0xf149f2ca
    v_mov_b32 v21, 0xf149f2ca
    v_mov_b32 v22, 0xf149f2ca
    v_mov_b32 v23, 0xf149f2ca
    v_mov_b32 v24, 0xf149f2ca
    v_mov_b32 v25, 0xf149f2ca
    v_mov_b32 v26, 0xf149f2ca
    v_mov_b32 v27, 0xf149f2ca
    v_mov_b32 v28, 0xf149f2ca
    v_mov_b32 v29, 0xf149f2ca
    v_mov_b32 v30, 0xf149f2ca
    v_mov_b32 v31, 0xf149f2ca
    s_branch L_at0_negb
L_at0_x7:
    s_nop 1
    v_mfma_f32_32x32x16_bf16 v[80:95], a[100:103], v[8:11], 0
    s_mov_b64 exec, s[0:1]
    ds_read_b128 a[100:103], v1 offset:35072
    s_mov_b64 exec, -1
    v_mfma_f32_32x32x16_bf16 v[80:95], a[104:107], v[12:15], v[80:95]
    s_mov_b64 exec, s[0:1]
    ds_read_b128 a[104:107], v1 offset:36096
    s_mov_b64 exec, -1
    v_mfma_f32_32x32x16_bf16 v[80:95], a[36:39], v[64:67], v[80:95]
    s_mov_b64 exec, s[0:1]
    ds_read_b128 a[36:39], v1 offset:2304
    s_mov_b64 exec, -1
    v_mfma_f32_32x32x16_bf16 v[80:95], a[40:43], v[68:71], v[80:95]
    s_mov_b64 exec, s[0:1]
    ds_read_b128 a[40:43], v1 offset:3328
    s_mov_b64 exec, -1
    s_branch L_at0_pre
L_at0_x6:
    s_nop 1
    v_mfma_f32_32x32x16_bf16 v[80:95], a[92:95], v[72:75], v[80:95]
    s_mov_b64 exec, s[0:1]
    ds_read_b128 a[92:95], v1 offset:30976
    s_mov_b64 exec, -1
    v_mfma_f32_32x32x16_bf16 v[80:95], a[96:99], v[76:79], v[80:95]
    s_mov_b64 exec, s[0:1]
    ds_read_b128 a[96:99], v1 offset:32000
    s_mov_b64 exec, -1
    s_branch L_at0_pre
L_at0_x5:
    s_nop 1
    v_mfma_f32_32x32x16_bf16 v[80:95], a[84:87], v[64:67], v[80:95]
    s_mov_b64 exec, s[0:1]
    ds_read_b128 a[84:87], v1 offset:26880
    s_mov_b64 exec, -1
    v_mfma_f32_32x32x16_bf16 v[80:95], a[88:91], v[68:71], v[80:95]
    s_mov_b64 exec, s[0:1]
    ds_read_b128 a[88:91], v1 offset:27904
    s_mov_b64 exec, -1
    s_branch L_at0_pre
L_at0_x4:
    s_nop 1
    v_mfma_f32_32x32x16_bf16 v[80:95], a[76:79], v[72:75], v[80:95]
    s_mov_b64 exec, s[0:1]
    ds_read_b128 a[76:79], v1 offset:22784
    s_mov_b64 exec, -1
    v_mfma_f32_32x32x16_bf16 v[80:95], a[80:83], v[76:79], v[80:95]
    s_mov_b64 exec, s[0:1]
    ds_read_b128 a[80:83], v1 offset:23808
    s_mov_b64 exec, -1
    s_branch L_at0_pre
L_at0_x3:
    s_nop 1
    v_mfma_f32_32x32x16_bf16 v[80:95], a[68:71], v[64:67], v[80:95]
    s_mov_b64 exec, s[0:1]
    ds_read_b128 a[68:71], v1 offset:18688
    s_mov_b64 exec, -1
    v_mfma_f32_32x32x16_bf16 v[80:95], a[72:75], v[68:71], v[80:95]
    s_mov_b64 exec, s[0:1]
    ds_read_b128 a[72:75], v1 offset:19712
    s_mov_b64 exec, -1
    s_branch L_at0_pre
L_at0_x2:
    s_nop 1
    v_mfma_f32_32x32x16_bf16 v[80:95], a[60:63], v[72:75], v[80:95]
    s_mov_b64 exec, s[0:1]
    ds_read_b128 a[60:63], v1 offset:14592
    s_mov_b64 exec, -1
    v_mfma_f32_32x32x16_bf16 v[80:95], a[64:67], v[76:79], v[80:95]
    s_mov_b64 exec, s[0:1]
    ds_read_b128 a[64:67], v1 offset:15616
    s_mov_b64 exec, -1
    s_branch L_at0_pre
L_at0_x1:
    s_nop 1
    v_mfma_f32_32x32x16_bf16 v[80:95], a[52:55], v[64:67], v[80:95]
    s_mov_b64 exec, s[0:1]
    ds_read_b128 a[52:55], v1 offset:10496
    s_mov_b64 exec, -1
    v_mfma_f32_32x32x16_bf16 v[80:95], a[56:59], v[68:71], v[80:95]
    s_mov_b64 exec, s[0:1]
    ds_read_b128 a[56:59], v1 offset:11520
    s_mov_b64 exec, -1
    s_branch L_at0_pre
L_at0_ng1:
    v_mov_b32 v16, 0xf149f2ca
    v_mov_b32 v17, 0xf149f2ca
    v_mov_b32 v18, 0xf149f2ca
    v_mov_b32 v19, 0xf149f2ca
    v_mov_b32 v20, 0xf149f2ca
    v_mov_b32 v21, 0xf149f2ca
    v_mov_b32 v22, 0xf149f2ca
    v_mov_b32 v23, 0xf149f2ca
    v_mov_b32 v24, 0xf149f2ca
    v_mov_b32 v25, 0xf149f2ca
    v_mov_b32 v26, 0xf149f2ca
    v_mov_b32 v27, 0xf149f2ca
    v_mov_b32 v28, 0xf149f2ca
    v_mov_b32 v29, 0xf149f2ca
    v_mov_b32 v30, 0xf149f2ca
    v_mov_b32 v31, 0xf149f2ca
    s_branch L_at0_ng1b
L_at0_pre:
    s_waitcnt lgkmcnt(0)
    s_nop 7
    s_nop 7
    v_mfma_f32_32x32x16_bf16 v[48:63], a[32:35], a[112:115], 0
    v_mfma_f32_32x32x16_bf16 v[16:31], a[0:3], a[112:115], 0
    v_mfma_f32_32x32x16_bf16 v[32:47], a[28:31], a[112:115], 0
    s_nop 7
    s_nop 7
    s_cmp_eq_u32 s53, 0
    s_cbranch_scc1 L_h1a
    v_mov_b32 v16, 0xf149f2ca
    v_mov_b32 v17, 0xf149f2ca
    v_mov_b32 v18, 0xf149f2ca
    v_mov_b32 v19, 0xf149f2ca
    v_mov_b32 v20, 0xf149f2ca
    v_mov_b32 v21, 0xf149f2ca
    v_mov_b32 v22, 0xf149f2ca
    v_mov_b32 v23, 0xf149f2ca
    v_mov_b32 v24, 0xf149f2ca
    v_mov_b32 v25, 0xf149f2ca
    v_mov_b32 v26, 0xf149f2ca
    v_mov_b32 v27, 0xf149f2ca
    v_mov_b32 v28, 0xf149f2ca
    v_mov_b32 v29, 0xf149f2ca
    v_mov_b32 v30, 0xf149f2ca
    v_mov_b32 v31, 0xf149f2ca
L_h1a:
    v_bfi_b32 v48, v96, v48, v16
    v_bfi_b32 v49, v97, v49, v17
    v_bfi_b32 v50, v98, v50, v18
    v_bfi_b32 v51, v99, v51, v19
    v_bfi_b32 v52, v100, v52, v20
    v_bfi_b32 v53, v101, v53, v21
    v_bfi_b32 v54, v102, v54, v22
    v_bfi_b32 v55, v103, v55, v23
    v_bfi_b32 v56, v104, v56, v24
    v_bfi_b32 v57, v105, v57, v25
    v_bfi_b32 v58, v106, v58, v26
    v_bfi_b32 v59, v107, v59, v27
    v_bfi_b32 v60, v108, v60, v28
    v_bfi_b32 v61, v109, v61, v29
    v_bfi_b32 v62, v110, v62, v30
    v_bfi_b32 v63, v111, v63, v31
    s_branch L_at0_fin
L_at0_slow:
    s_waitcnt lgkmcnt(0)
    s_nop 7
    s_nop 7
    ds_read_b128 a[32:35], v1 offset:32768
    ds_read_b128 a[0:3], v1 offset:0
    ds_read_b128 a[28:31], v1 offset:28672
    ds_read_b128 a[24:27], v1 offset:24576
    ds_read_b128 a[20:23], v1 offset:20480
    ds_read_b128 a[16:19], v1 offset:16384
    ds_read_b128 a[12:15], v1 offset:12288
    ds_read_b128 a[8:11], v1 offset:8192
    ds_read_b128 a[4:7], v1 offset:4096
    s_mov_b64 exec, s[0:1]
    ds_read_b128 a[100:103], v1 offset:34816
    ds_read_b128 a[104:107], v1 offset:35840
    ds_read_b128 a[36:39], v1 offset:2048
    ds_read_b128 a[40:43], v1 offset:3072
    ds_read_b128 a[92:95], v1 offset:30720
    ds_read_b128 a[96:99], v1 offset:31744
    ds_read_b128 a[84:87], v1 offset:26624
    ds_read_b128 a[88:91], v1 offset:27648
    ds_read_b128 a[76:79], v1 offset:22528
    ds_read_b128 a[80:83], v1 offset:23552
    ds_read_b128 a[68:71], v1 offset:18432
    ds_read_b128 a[72:75], v1 offset:19456
    ds_read_b128 a[60:63], v1 offset:14336
    ds_read_b128 a[64:67], v1 offset:15360
    ds_read_b128 a[52:55], v1 offset:10240
    ds_read_b128 a[56:59], v1 offset:11264
    ds_read_b128 a[44:47], v1 offset:6144
    ds_read_b128 a[48:51], v1 offset:7168
    s_mov_b64 exec, -1
    s_mov_b32 s58, 0
    s_waitcnt lgkmcnt(0)
    s_branch L_slow
L_at0_ret:
    ds_read_b128 a[32:35], v1 offset:33792
    ds_read_b128 a[0:3], v1 offset:1024
    ds_read_b128 a[28:31], v1 offset:29696
    ds_read_b128 a[24:27], v1 offset:25600
    ds_read_b128 a[20:23], v1 offset:21504
    ds_read_b128 a[16:19], v1 offset:17408
    ds_read_b128 a[12:15], v1 offset:13312
    ds_read_b128 a[8:11], v1 offset:9216
    ds_read_b128 a[4:7], v1 offset:5120
    s_mov_b64 exec, s[0:1]
    ds_read_b128 a[100:103], v1 offset:35072
    ds_read_b128 a[104:107], v1 offset:36096
    ds_read_b128 a[36:39], v1 offset:2304
    ds_read_b128 a[40:43], v1 offset:3328
    ds_read_b128 a[92:95], v1 offset:30976
    ds_read_b128 a[96:99], v1 offset:32000
    ds_read_b128 a[84:87], v1 offset:26880
    ds_read_b128 a[88:91], v1 offset:27904
    ds_read_b128 a[76:79], v1 offset:22784
    ds_read_b128 a[80:83], v1 offset:23808
    ds_read_b128 a[68:71], v1 offset:18688
    ds_read_b128 a[72:75], v1 offset:19712
    ds_read_b128 a[60:63], v1 offset:14592
    ds_read_b128 a[64:67], v1 offset:15616
    ds_read_b128 a[52:55], v1 offset:10496
    ds_read_b128 a[56:59], v1 offset:11520
    ds_read_b128 a[44:47], v1 offset:6400
    ds_read_b128 a[48:51], v1 offset:7424
    s_mov_b64 exec, -1
    s_waitcnt lgkmcnt(0)
    s_waitcnt lgkmcnt(0)
    s_nop 7
    s_nop 7
    v_mfma_f32_32x32x16_bf16 v[48:63], a[32:35], a[112:115], 0
    v_mfma_f32_32x32x16_bf16 v[16:31], a[0:3], a[112:115], 0
    v_mfma_f32_32x32x16_bf16 v[32:47], a[28:31], a[112:115], 0
    s_nop 7
    s_nop 7
    s_cmp_eq_u32 s53, 0
    s_cbranch_scc1 L_h1b
    v_mov_b32 v16, 0xf149f2ca
    v_mov_b32 v17, 0xf149f2ca
    v_mov_b32 v18, 0xf149f2ca
    v_mov_b32 v19, 0xf149f2ca
    v_mov_b32 v20, 0xf149f2ca
    v_mov_b32 v21, 0xf149f2ca
    v_mov_b32 v22, 0xf149f2ca
    v_mov_b32 v23, 0xf149f2ca
    v_mov_b32 v24, 0xf149f2ca
    v_mov_b32 v25, 0xf149f2ca
    v_mov_b32 v26, 0xf149f2ca
    v_mov_b32 v27, 0xf149f2ca
    v_mov_b32 v28, 0xf149f2ca
    v_mov_b32 v29, 0xf149f2ca
    v_mov_b32 v30, 0xf149f2ca
    v_mov_b32 v31, 0xf149f2ca
L_h1b:
    v_bfi_b32 v48, v96, v48, v16
    v_bfi_b32 v49, v97, v49, v17
    v_bfi_b32 v50, v98, v50, v18
    v_bfi_b32 v51, v99, v51, v19
    v_bfi_b32 v52, v100, v52, v20
    v_bfi_b32 v53, v101, v53, v21
    v_bfi_b32 v54, v102, v54, v22
    v_bfi_b32 v55, v103, v55, v23
    v_bfi_b32 v56, v104, v56, v24
    v_bfi_b32 v57, v105, v57, v25
    v_bfi_b32 v58, v106, v58, v26
    v_bfi_b32 v59, v107, v59, v27
    v_bfi_b32 v60, v108, v60, v28
    v_bfi_b32 v61, v109, v61, v29
    v_bfi_b32 v62, v110, v62, v30
    v_bfi_b32 v63, v111, v63, v31
    s_branch L_at0_back
L_at1_x7:
    s_nop 1
    v_mfma_f32_32x32x16_bf16 v[80:95], a[100:103], v[8:11], 0
    v_mfma_f32_32x32x16_bf16 v[80:95], a[104:107], v[12:15], v[80:95]
    v_mfma_f32_32x32x16_bf16 v[80:95], a[36:39], v[64:67], v[80:95]
    v_mfma_f32_32x32x16_bf16 v[80:95], a[40:43], v[68:71], v[80:95]
    s_nop 7
    s_nop 7
    s_branch L_at1_fin
L_at1_x6:
    s_nop 1
    v_mfma_f32_32x32x16_bf16 v[80:95], a[92:95], v[72:75], v[80:95]
    v_mfma_f32_32x32x16_bf16 v[80:95], a[96:99], v[76:79], v[80:95]
    s_nop 7
    s_nop 7
    s_branch L_at1_fin
L_at1_x5:
    s_nop 1
    v_mfma_f32_32x32x16_bf16 v[80:95], a[84:87], v[64:67], v[80:95]
    v_mfma_f32_32x32x16_bf16 v[80:95], a[88:91], v[68:71], v[80:95]
    s_nop 7
    s_nop 7
    s_branch L_at1_fin
L_at1_x4:
    s_nop 1
    v_mfma_f32_32x32x16_bf16 v[80:95], a[76:79], v[72:75], v[80:95]
    v_mfma_f32_32x32x16_bf16 v[80:95], a[80:83], v[76:79], v[80:95]
    s_nop 7
    s_nop 7
    s_branch L_at1_fin
L_at1_x3:
    s_nop 1
    v_mfma_f32_32x32x16_bf16 v[80:95], a[68:71], v[64:67], v[80:95]
    v_mfma_f32_32x32x16_bf16 v[80:95], a[72:75], v[68:71], v[80:95]
    s_nop 7
    s_nop 7
    s_branch L_at1_fin
L_at1_x2:
    s_nop 1
    v_mfma_f32_32x32x16_bf16 v[80:95], a[60:63], v[72:75], v[80:95]
    v_mfma_f32_32x32x16_bf16 v[80:95], a[64:67], v[76:79], v[80:95]
    s_nop 7
    s_nop 7
    s_branch L_at1_fin
L_at1_x1:
    s_nop 1
    v_mfma_f32_32x32x16_bf16 v[80:95], a[52:55], v[64:67], v[80:95]
    v_mfma_f32_32x32x16_bf16 v[80:95], a[56:59], v[68:71], v[80:95]
    s_nop 7
    s_nop 7
    s_branch L_at1_fin
L_at1_slow:
    v_accvgpr_mov_b32 a108, a112
    v_accvgpr_mov_b32 a109, a113
    v_accvgpr_mov_b32 a110, a114
    v_accvgpr_mov_b32 a111, a115
    s_mov_b32 s58, 1
    s_nop 1
    s_branch L_slow
L_gated_mix__sliding_block__swiglu_ffn__prompt_kernel_non_15:
    s_add_u32 s101, s101, 1
    s_cmp_gt_u32 s101, 400000
    s_cbranch_scc1 L_gated_mix__sliding_block__swiglu_ffn__prompt_kernel_non_15b
    buffer_load_dword v47, off, s[44:47], 0 sc1
    s_waitcnt vmcnt(0)
    v_readfirstlane_b32 s100, v47
    s_nop 1
    s_cmp_eq_u32 s100, 0
    s_cbranch_scc1 L_gated_mix__sliding_block__swiglu_ffn__prompt_kernel_non_15
    s_branch L_gated_mix__sliding_block__swiglu_ffn__prompt_kernel_non_15b
L_gated_mix__sliding_block__swiglu_ffn__prompt_kernel_c_16l:
    ds_read_b32 v107, v106 offset:176
    s_add_u32 s101, s101, 1
    s_cmp_gt_u32 s101, s42
    s_cbranch_scc1 L_gated_mix__sliding_block__swiglu_ffn__prompt_kernel_c_16b
    s_waitcnt lgkmcnt(0)
    v_cmp_ne_u32 vcc, 0, v107
    s_nop 0
    s_cbranch_vccnz L_gated_mix__sliding_block__swiglu_ffn__prompt_kernel_c_16l
    s_branch L_gated_mix__sliding_block__swiglu_ffn__prompt_kernel_c_16b
L_gated_mix__sliding_block__swiglu_ffn__prompt_kernel_c_17l:
    ds_read_b32 v107, v106 offset:192
    s_add_u32 s101, s101, 1
    s_cmp_gt_u32 s101, s42
    s_cbranch_scc1 L_gated_mix__sliding_block__swiglu_ffn__prompt_kernel_c_17b
    s_waitcnt lgkmcnt(0)
    v_cmp_ne_u32 vcc, 0, v107
    s_nop 0
    s_cbranch_vccnz L_gated_mix__sliding_block__swiglu_ffn__prompt_kernel_c_17l
    s_branch L_gated_mix__sliding_block__swiglu_ffn__prompt_kernel_c_17b
L_gated_mix__sliding_block__swiglu_ffn__prompt_kernel_non_29:
    s_add_u32 s101, s101, 1
    s_cmp_gt_u32 s101, 400000
    s_cbranch_scc1 L_gated_mix__sliding_block__swiglu_ffn__prompt_kernel_non_29b
    buffer_load_dword v47, off, s[44:47], 0 sc1
    s_waitcnt vmcnt(0)
    v_readfirstlane_b32 s100, v47
    s_nop 1
    s_cmp_eq_u32 s100, 0
    s_cbranch_scc1 L_gated_mix__sliding_block__swiglu_ffn__prompt_kernel_non_29
    s_branch L_gated_mix__sliding_block__swiglu_ffn__prompt_kernel_non_29b
L_gated_mix__sliding_block__swiglu_ffn__prompt_kernel_c_30l:
    ds_read_b32 v107, v106 offset:176
    s_add_u32 s101, s101, 1
    s_cmp_gt_u32 s101, s42
    s_cbranch_scc1 L_gated_mix__sliding_block__swiglu_ffn__prompt_kernel_c_30b
    s_waitcnt lgkmcnt(0)
    v_cmp_ne_u32 vcc, 0, v107
    s_nop 0
    s_cbranch_vccnz L_gated_mix__sliding_block__swiglu_ffn__prompt_kernel_c_30l
    s_branch L_gated_mix__sliding_block__swiglu_ffn__prompt_kernel_c_30b
L_gated_mix__sliding_block__swiglu_ffn__prompt_kernel_c_31l:
    ds_read_b32 v107, v106 offset:192
    s_add_u32 s101, s101, 1
    s_cmp_gt_u32 s101, s42
    s_cbranch_scc1 L_gated_mix__sliding_block__swiglu_ffn__prompt_kernel_c_31b
    s_waitcnt lgkmcnt(0)
    v_cmp_ne_u32 vcc, 0, v107
    s_nop 0
    s_cbranch_vccnz L_gated_mix__sliding_block__swiglu_ffn__prompt_kernel_c_31l
    s_branch L_gated_mix__sliding_block__swiglu_ffn__prompt_kernel_c_31b
L_gated_mix__sliding_block__swiglu_ffn__prompt_kernel_c_32l:
    ds_read_b32 v107, v106 offset:208
    s_add_u32 s101, s101, 1
    s_cmp_gt_u32 s101, s42
    s_cbranch_scc1 L_gated_mix__sliding_block__swiglu_ffn__prompt_kernel_c_32b
    s_waitcnt lgkmcnt(0)
    v_cmp_ne_u32 vcc, 0, v107
    s_nop 0
    s_cbranch_vccnz L_gated_mix__sliding_block__swiglu_ffn__prompt_kernel_c_32l
    s_branch L_gated_mix__sliding_block__swiglu_ffn__prompt_kernel_c_32b
L_gated_mix__sliding_block__swiglu_ffn__prompt_kernel_c_33l:
    ds_read_b32 v107, v106 offset:224
    s_add_u32 s101, s101, 1
    s_cmp_gt_u32 s101, s42
    s_cbranch_scc1 L_gated_mix__sliding_block__swiglu_ffn__prompt_kernel_c_33b
    s_waitcnt lgkmcnt(0)
    v_cmp_ne_u32 vcc, 0, v107
    s_nop 0
    s_cbranch_vccnz L_gated_mix__sliding_block__swiglu_ffn__prompt_kernel_c_33l
    s_branch L_gated_mix__sliding_block__swiglu_ffn__prompt_kernel_c_33b
L_gated_mix__sliding_block__swiglu_ffn__prompt_kernel_c_34l:
    ds_read_b32 v107, v106 offset:240
    s_add_u32 s101, s101, 1
    s_cmp_gt_u32 s101, s42
    s_cbranch_scc1 L_gated_mix__sliding_block__swiglu_ffn__prompt_kernel_c_34b
    s_waitcnt lgkmcnt(0)
    v_cmp_ne_u32 vcc, 0, v107
    s_nop 0
    s_cbranch_vccnz L_gated_mix__sliding_block__swiglu_ffn__prompt_kernel_c_34l
    s_branch L_gated_mix__sliding_block__swiglu_ffn__prompt_kernel_c_34b
L_gated_mix__sliding_block__swiglu_ffn__prompt_kernel_c_35l:
    ds_read_b32 v107, v106 offset:256
    s_add_u32 s101, s101, 1
    s_cmp_gt_u32 s101, s42
    s_cbranch_scc1 L_gated_mix__sliding_block__swiglu_ffn__prompt_kernel_c_35b
    s_waitcnt lgkmcnt(0)
    v_cmp_ne_u32 vcc, 0, v107
    s_nop 0
    s_cbranch_vccnz L_gated_mix__sliding_block__swiglu_ffn__prompt_kernel_c_35l
    s_branch L_gated_mix__sliding_block__swiglu_ffn__prompt_kernel_c_35b
L_gated_mix__sliding_block__swiglu_ffn__prompt_kernel_poll_38:
    s_add_u32 s101, s101, 1
    s_cmp_gt_u32 s101, 400000
    s_cbranch_scc1 L_gated_mix__sliding_block__swiglu_ffn__prompt_kernel_poll_38b
    s_sleep 6
    s_mov_b64 exec, 0xff
    buffer_load_dword v127, v126, s[32:35], s54 offen sc1
    s_mov_b64 exec, -1
    s_waitcnt vmcnt(0)
    v_cmp_ne_u32 vcc, s100, v127
    s_nop 0
    s_and_b32 vcc_lo, vcc_lo, 0xff
    s_cbranch_scc1 L_gated_mix__sliding_block__swiglu_ffn__prompt_kernel_poll_38
    s_branch L_gated_mix__sliding_block__swiglu_ffn__prompt_kernel_poll_38b
L_gated_mix__sliding_block__swiglu_ffn__prompt_kernel_poll_39:
    s_add_u32 s101, s101, 1
    s_cmp_gt_u32 s101, 400000
    s_cbranch_scc1 L_gated_mix__sliding_block__swiglu_ffn__prompt_kernel_poll_39b
    s_sleep 6
    s_mov_b64 exec, 0x77
    buffer_load_dword v124, v125, s[32:35], s53 offen sc1
    s_mov_b64 exec, -1
    s_waitcnt vmcnt(0)
    v_cmp_ne_u32 vcc, s100, v124
    s_nop 0
    s_and_b32 vcc_lo, vcc_lo, 0x77
    s_cbranch_scc1 L_gated_mix__sliding_block__swiglu_ffn__prompt_kernel_poll_39
    s_branch L_gated_mix__sliding_block__swiglu_ffn__prompt_kernel_poll_39b
L_gated_mix__sliding_block__swiglu_ffn__prompt_kernel_poll_40:
    s_add_u32 s101, s101, 1
    s_cmp_gt_u32 s101, 400000
    s_cbranch_scc1 L_gated_mix__sliding_block__swiglu_ffn__prompt_kernel_poll_40b
    s_sleep 6
    s_mov_b64 exec, 0xff
    buffer_load_dword v127, v126, s[32:35], s54 offen sc1
    s_mov_b64 exec, -1
    s_waitcnt vmcnt(0)
    v_cmp_ne_u32 vcc, s100, v127
    s_nop 0
    s_and_b32 vcc_lo, vcc_lo, 0xff
    s_cbranch_scc1 L_gated_mix__sliding_block__swiglu_ffn__prompt_kernel_poll_40
    s_branch L_gated_mix__sliding_block__swiglu_ffn__prompt_kernel_poll_40b
L_slow:
    s_nop 7
    s_nop 7
    v_mov_b32 v32, 0xf149f2ca
    v_mov_b32 v33, 0xf149f2ca
    v_mov_b32 v34, 0xf149f2ca
    v_mov_b32 v35, 0xf149f2ca
    v_mov_b32 v36, 0xf149f2ca
    v_mov_b32 v37, 0xf149f2ca
    v_mov_b32 v38, 0xf149f2ca
    v_mov_b32 v39, 0xf149f2ca
    v_mov_b32 v40, 0xf149f2ca
    v_mov_b32 v41, 0xf149f2ca
    v_mov_b32 v42, 0xf149f2ca
    v_mov_b32 v43, 0xf149f2ca
    v_mov_b32 v44, 0xf149f2ca
    v_mov_b32 v45, 0xf149f2ca
    v_mov_b32 v46, 0xf149f2ca
    v_mov_b32 v47, 0xf149f2ca
    v_mfma_f32_32x32x16_bf16 v[48:63], a[32:35], a[108:111], 0
    s_nop 7
    s_nop 7
    s_cmp_lg_u32 s53, 0
    s_cbranch_scc1 L_cb_a_0
    v_mov_b32 v32, 0
    v_mov_b32 v33, 0
    v_mov_b32 v34, 0
    v_mov_b32 v35, 0
    v_mov_b32 v36, 0
    v_mov_b32 v37, 0
    v_mov_b32 v38, 0
    v_mov_b32 v39, 0
    v_mov_b32 v40, 0
    v_mov_b32 v41, 0
    v_mov_b32 v42, 0
    v_mov_b32 v43, 0
    v_mov_b32 v44, 0
    v_mov_b32 v45, 0
    v_mov_b32 v46, 0
    v_mov_b32 v47, 0
L_cb_a_0:
    s_nop 1
    v_mfma_f32_32x32x16_bf16 v[16:31], a[0:3], a[108:111], v[32:47]
    s_nop 7
    s_nop 7
    v_bfi_b32 v48, v96, v48, v16
    v_bfi_b32 v49, v97, v49, v17
    v_bfi_b32 v50, v98, v50, v18
    v_bfi_b32 v51, v99, v51, v19
    v_bfi_b32 v52, v100, v52, v20
    v_bfi_b32 v53, v101, v53, v21
    v_bfi_b32 v54, v102, v54, v22
    v_bfi_b32 v55, v103, v55, v23
    v_bfi_b32 v56, v104, v56, v24
    v_bfi_b32 v57, v105, v57, v25
    v_bfi_b32 v58, v106, v58, v26
    v_bfi_b32 v59, v107, v59, v27
    v_bfi_b32 v60, v108, v60, v28
    v_bfi_b32 v61, v109, v61, v29
    v_bfi_b32 v62, v110, v62, v30
    v_bfi_b32 v63, v111, v63, v31
    v_mov_b32 v10, v48
    v_max3_f32 v10, v10, v48, v49
    v_max3_f32 v10, v10, v50, v51
    v_max3_f32 v10, v10, v52, v53
    v_max3_f32 v10, v10, v54, v55
    v_max3_f32 v10, v10, v56, v57
    v_max3_f32 v10, v10, v58, v59
    v_max3_f32 v10, v10, v60, v61
    v_max3_f32 v10, v10, v62, v63
    s_cmp_lg_u32 s53, 1
    s_cbranch_scc1 L_cb_a_1
    v_mov_b32 v32, 0
    v_mov_b32 v33, 0
    v_mov_b32 v34, 0
    v_mov_b32 v35, 0
    v_mov_b32 v36, 0
    v_mov_b32 v37, 0
    v_mov_b32 v38, 0
    v_mov_b32 v39, 0
    v_mov_b32 v40, 0
    v_mov_b32 v41, 0
    v_mov_b32 v42, 0
    v_mov_b32 v43, 0
    v_mov_b32 v44, 0
    v_mov_b32 v45, 0
    v_mov_b32 v46, 0
    v_mov_b32 v47, 0
L_cb_a_1:
    s_nop 1
    v_mfma_f32_32x32x16_bf16 v[16:31], a[4:7], a[108:111], v[32:47]
    s_nop 7
    s_nop 7
    v_max3_f32 v10, v10, v16, v17
    v_max3_f32 v10, v10, v18, v19
    v_max3_f32 v10, v10, v20, v21
    v_max3_f32 v10, v10, v22, v23
    v_max3_f32 v10, v10, v24, v25
    v_max3_f32 v10, v10, v26, v27
    v_max3_f32 v10, v10, v28, v29
    v_max3_f32 v10, v10, v30, v31
    s_cmp_lg_u32 s53, 2
    s_cbranch_scc1 L_cb_a_2
    v_mov_b32 v32, 0
    v_mov_b32 v33, 0
    v_mov_b32 v34, 0
    v_mov_b32 v35, 0
    v_mov_b32 v36, 0
    v_mov_b32 v37, 0
    v_mov_b32 v38, 0
    v_mov_b32 v39, 0
    v_mov_b32 v40, 0
    v_mov_b32 v41, 0
    v_mov_b32 v42, 0
    v_mov_b32 v43, 0
    v_mov_b32 v44, 0
    v_mov_b32 v45, 0
    v_mov_b32 v46, 0
    v_mov_b32 v47, 0
L_cb_a_2:
    s_nop 1
    v_mfma_f32_32x32x16_bf16 v[16:31], a[8:11], a[108:111], v[32:47]
    s_nop 7
    s_nop 7
    v_max3_f32 v10, v10, v16, v17
    v_max3_f32 v10, v10, v18, v19
    v_max3_f32 v10, v10, v20, v21
    v_max3_f32 v10, v10, v22, v23
    v_max3_f32 v10, v10, v24, v25
    v_max3_f32 v10, v10, v26, v27
    v_max3_f32 v10, v10, v28, v29
    v_max3_f32 v10, v10, v30, v31
    s_cmp_lg_u32 s53, 3
    s_cbranch_scc1 L_cb_a_3
    v_mov_b32 v32, 0
    v_mov_b32 v33, 0
    v_mov_b32 v34, 0
    v_mov_b32 v35, 0
    v_mov_b32 v36, 0
    v_mov_b32 v37, 0
    v_mov_b32 v38, 0
    v_mov_b32 v39, 0
    v_mov_b32 v40, 0
    v_mov_b32 v41, 0
    v_mov_b32 v42, 0
    v_mov_b32 v43, 0
    v_mov_b32 v44, 0
    v_mov_b32 v45, 0
    v_mov_b32 v46, 0
    v_mov_b32 v47, 0
L_cb_a_3:
    s_nop 1
    v_mfma_f32_32x32x16_bf16 v[16:31], a[12:15], a[108:111], v[32:47]
    s_nop 7
    s_nop 7
    v_max3_f32 v10, v10, v16, v17
    v_max3_f32 v10, v10, v18, v19
    v_max3_f32 v10, v10, v20, v21
    v_max3_f32 v10, v10, v22, v23
    v_max3_f32 v10, v10, v24, v25
    v_max3_f32 v10, v10, v26, v27
    v_max3_f32 v10, v10, v28, v29
    v_max3_f32 v10, v10, v30, v31
    s_cmp_lg_u32 s53, 4
    s_cbranch_scc1 L_cb_a_4
    v_mov_b32 v32, 0
    v_mov_b32 v33, 0
    v_mov_b32 v34, 0
    v_mov_b32 v35, 0
    v_mov_b32 v36, 0
    v_mov_b32 v37, 0
    v_mov_b32 v38, 0
    v_mov_b32 v39, 0
    v_mov_b32 v40, 0
    v_mov_b32 v41, 0
    v_mov_b32 v42, 0
    v_mov_b32 v43, 0
    v_mov_b32 v44, 0
    v_mov_b32 v45, 0
    v_mov_b32 v46, 0
    v_mov_b32 v47, 0
L_cb_a_4:
    s_nop 1
    v_mfma_f32_32x32x16_bf16 v[16:31], a[16:19], a[108:111], v[32:47]
    s_nop 7
    s_nop 7
    v_max3_f32 v10, v10, v16, v17
    v_max3_f32 v10, v10, v18, v19
    v_max3_f32 v10, v10, v20, v21
    v_max3_f32 v10, v10, v22, v23
    v_max3_f32 v10, v10, v24, v25
    v_max3_f32 v10, v10, v26, v27
    v_max3_f32 v10, v10, v28, v29
    v_max3_f32 v10, v10, v30, v31
    s_cmp_lg_u32 s53, 5
    s_cbranch_scc1 L_cb_a_5
    v_mov_b32 v32, 0
    v_mov_b32 v33, 0
    v_mov_b32 v34, 0
    v_mov_b32 v35, 0
    v_mov_b32 v36, 0
    v_mov_b32 v37, 0
    v_mov_b32 v38, 0
    v_mov_b32 v39, 0
    v_mov_b32 v40, 0
    v_mov_b32 v41, 0
    v_mov_b32 v42, 0
    v_mov_b32 v43, 0
    v_mov_b32 v44, 0
    v_mov_b32 v45, 0
    v_mov_b32 v46, 0
    v_mov_b32 v47, 0
L_cb_a_5:
    s_nop 1
    v_mfma_f32_32x32x16_bf16 v[16:31], a[20:23], a[108:111], v[32:47]
    s_nop 7
    s_nop 7
    v_max3_f32 v10, v10, v16, v17
    v_max3_f32 v10, v10, v18, v19
    v_max3_f32 v10, v10, v20, v21
    v_max3_f32 v10, v10, v22, v23
    v_max3_f32 v10, v10, v24, v25
    v_max3_f32 v10, v10, v26, v27
    v_max3_f32 v10, v10, v28, v29
    v_max3_f32 v10, v10, v30, v31
    s_cmp_lg_u32 s53, 6
    s_cbranch_scc1 L_cb_a_6
    v_mov_b32 v32, 0
    v_mov_b32 v33, 0
    v_mov_b32 v34, 0
    v_mov_b32 v35, 0
    v_mov_b32 v36, 0
    v_mov_b32 v37, 0
    v_mov_b32 v38, 0
    v_mov_b32 v39, 0
    v_mov_b32 v40, 0
    v_mov_b32 v41, 0
    v_mov_b32 v42, 0
    v_mov_b32 v43, 0
    v_mov_b32 v44, 0
    v_mov_b32 v45, 0
    v_mov_b32 v46, 0
    v_mov_b32 v47, 0
L_cb_a_6:
    s_nop 1
    v_mfma_f32_32x32x16_bf16 v[16:31], a[24:27], a[108:111], v[32:47]
    s_nop 7
    s_nop 7
    v_max3_f32 v10, v10, v16, v17
    v_max3_f32 v10, v10, v18, v19
    v_max3_f32 v10, v10, v20, v21
    v_max3_f32 v10, v10, v22, v23
    v_max3_f32 v10, v10, v24, v25
    v_max3_f32 v10, v10, v26, v27
    v_max3_f32 v10, v10, v28, v29
    v_max3_f32 v10, v10, v30, v31
    s_cmp_lg_u32 s53, 7
    s_cbranch_scc1 L_cb_a_7
    v_mov_b32 v32, 0
    v_mov_b32 v33, 0
    v_mov_b32 v34, 0
    v_mov_b32 v35, 0
    v_mov_b32 v36, 0
    v_mov_b32 v37, 0
    v_mov_b32 v38, 0
    v_mov_b32 v39, 0
    v_mov_b32 v40, 0
    v_mov_b32 v41, 0
    v_mov_b32 v42, 0
    v_mov_b32 v43, 0
    v_mov_b32 v44, 0
    v_mov_b32 v45, 0
    v_mov_b32 v46, 0
    v_mov_b32 v47, 0
L_cb_a_7:
    s_nop 1
    v_mfma_f32_32x32x16_bf16 v[16:31], a[28:31], a[108:111], v[32:47]
    s_nop 7
    s_nop 7
    v_max3_f32 v10, v10, v16, v17
    v_max3_f32 v10, v10, v18, v19
    v_max3_f32 v10, v10, v20, v21
    v_max3_f32 v10, v10, v22, v23
    v_max3_f32 v10, v10, v24, v25
    v_max3_f32 v10, v10, v26, v27
    v_max3_f32 v10, v10, v28, v29
    v_max3_f32 v10, v10, v30, v31
    v_mov_b32 v11, v10
    s_nop 1
    v_permlane32_swap_b32 v10, v11
    s_nop 1
    v_max_f32 v10, v10, v11
    v_sub_f32 v48, v48, v10
    v_sub_f32 v49, v49, v10
    v_sub_f32 v50, v50, v10
    v_sub_f32 v51, v51, v10
    v_sub_f32 v52, v52, v10
    v_sub_f32 v53, v53, v10
    v_sub_f32 v54, v54, v10
    v_sub_f32 v55, v55, v10
    v_sub_f32 v56, v56, v10
    v_sub_f32 v57, v57, v10
    v_sub_f32 v58, v58, v10
    v_sub_f32 v59, v59, v10
    v_sub_f32 v60, v60, v10
    v_sub_f32 v61, v61, v10
    v_sub_f32 v62, v62, v10
    v_sub_f32 v63, v63, v10
    v_exp_f32 v48, v48
    v_exp_f32 v49, v49
    v_exp_f32 v50, v50
    v_exp_f32 v51, v51
    v_exp_f32 v52, v52
    v_exp_f32 v53, v53
    v_exp_f32 v54, v54
    v_exp_f32 v55, v55
    v_exp_f32 v56, v56
    v_exp_f32 v57, v57
    v_exp_f32 v58, v58
    v_exp_f32 v59, v59
    v_exp_f32 v60, v60
    v_exp_f32 v61, v61
    v_exp_f32 v62, v62
    v_exp_f32 v63, v63
    s_nop 0
    v_cvt_pk_bf16_f32 v64, v48, v49
    v_cvt_pk_bf16_f32 v65, v50, v51
    v_cvt_pk_bf16_f32 v66, v52, v53
    v_cvt_pk_bf16_f32 v67, v54, v55
    v_cvt_pk_bf16_f32 v68, v56, v57
    v_cvt_pk_bf16_f32 v69, v58, v59
    v_cvt_pk_bf16_f32 v70, v60, v61
    v_cvt_pk_bf16_f32 v71, v62, v63
    v_and_b32 v72, v64, v112
    v_and_b32 v73, v65, v113
    v_and_b32 v74, v66, v114
    v_and_b32 v75, v67, v115
    v_and_b32 v76, v68, v116
    v_and_b32 v77, v69, v117
    v_and_b32 v78, v70, v118
    v_and_b32 v79, v71, v119
    v_xor_b32 v64, v64, v72
    v_xor_b32 v65, v65, v73
    v_xor_b32 v66, v66, v74
    v_xor_b32 v67, v67, v75
    v_xor_b32 v68, v68, v76
    v_xor_b32 v69, v69, v77
    v_xor_b32 v70, v70, v78
    v_xor_b32 v71, v71, v79
    s_nop 1
    v_mfma_f32_32x32x16_bf16 v[80:95], a[100:103], v[72:75], 0
    v_mfma_f32_32x32x16_bf16 v[80:95], a[104:107], v[76:79], v[80:95]
    s_nop 7
    s_nop 7
    s_nop 1
    v_mfma_f32_32x32x16_bf16 v[80:95], a[36:39], v[64:67], v[80:95]
    v_mfma_f32_32x32x16_bf16 v[80:95], a[40:43], v[68:71], v[80:95]
    s_nop 7
    s_nop 7
    s_cmp_eq_u32 s53, 0
    s_cselect_b32 s57, 0, 0xf149f2ca
    v_mov_b32 v32, s57
    v_mov_b32 v33, s57
    v_mov_b32 v34, s57
    v_mov_b32 v35, s57
    v_mov_b32 v36, s57
    v_mov_b32 v37, s57
    v_mov_b32 v38, s57
    v_mov_b32 v39, s57
    v_mov_b32 v40, s57
    v_mov_b32 v41, s57
    v_mov_b32 v42, s57
    v_mov_b32 v43, s57
    v_mov_b32 v44, s57
    v_mov_b32 v45, s57
    v_mov_b32 v46, s57
    v_mov_b32 v47, s57
    s_cmp_lg_u32 s53, 1
    s_cbranch_scc1 L_cb_b_1
    v_mov_b32 v32, 0
    v_mov_b32 v33, 0
    v_mov_b32 v34, 0
    v_mov_b32 v35, 0
    v_mov_b32 v36, 0
    v_mov_b32 v37, 0
    v_mov_b32 v38, 0
    v_mov_b32 v39, 0
    v_mov_b32 v40, 0
    v_mov_b32 v41, 0
    v_mov_b32 v42, 0
    v_mov_b32 v43, 0
    v_mov_b32 v44, 0
    v_mov_b32 v45, 0
    v_mov_b32 v46, 0
    v_mov_b32 v47, 0
L_cb_b_1:
    s_nop 1
    v_mfma_f32_32x32x16_bf16 v[16:31], a[4:7], a[108:111], v[32:47]
    s_nop 7
    s_nop 7
    v_sub_f32 v16, v16, v10
    v_sub_f32 v17, v17, v10
    v_sub_f32 v18, v18, v10
    v_sub_f32 v19, v19, v10
    v_sub_f32 v20, v20, v10
    v_sub_f32 v21, v21, v10
    v_sub_f32 v22, v22, v10
    v_sub_f32 v23, v23, v10
    v_sub_f32 v24, v24, v10
    v_sub_f32 v25, v25, v10
    v_sub_f32 v26, v26, v10
    v_sub_f32 v27, v27, v10
    v_sub_f32 v28, v28, v10
    v_sub_f32 v29, v29, v10
    v_sub_f32 v30, v30, v10
    v_sub_f32 v31, v31, v10
    v_exp_f32 v16, v16
    v_exp_f32 v17, v17
    v_exp_f32 v18, v18
    v_exp_f32 v19, v19
    v_exp_f32 v20, v20
    v_exp_f32 v21, v21
    v_exp_f32 v22, v22
    v_exp_f32 v23, v23
    v_exp_f32 v24, v24
    v_exp_f32 v25, v25
    v_exp_f32 v26, v26
    v_exp_f32 v27, v27
    v_exp_f32 v28, v28
    v_exp_f32 v29, v29
    v_exp_f32 v30, v30
    v_exp_f32 v31, v31
    s_nop 0
    v_cvt_pk_bf16_f32 v64, v16, v17
    v_cvt_pk_bf16_f32 v65, v18, v19
    v_cvt_pk_bf16_f32 v66, v20, v21
    v_cvt_pk_bf16_f32 v67, v22, v23
    v_cvt_pk_bf16_f32 v68, v24, v25
    v_cvt_pk_bf16_f32 v69, v26, v27
    v_cvt_pk_bf16_f32 v70, v28, v29
    v_cvt_pk_bf16_f32 v71, v30, v31
    s_nop 1
    v_mfma_f32_32x32x16_bf16 v[80:95], a[44:47], v[64:67], v[80:95]
    v_mfma_f32_32x32x16_bf16 v[80:95], a[48:51], v[68:71], v[80:95]
    s_nop 7
    s_nop 7
    s_cmp_lg_u32 s53, 2
    s_cbranch_scc1 L_cb_b_2
    v_mov_b32 v32, 0
    v_mov_b32 v33, 0
    v_mov_b32 v34, 0
    v_mov_b32 v35, 0
    v_mov_b32 v36, 0
    v_mov_b32 v37, 0
    v_mov_b32 v38, 0
    v_mov_b32 v39, 0
    v_mov_b32 v40, 0
    v_mov_b32 v41, 0
    v_mov_b32 v42, 0
    v_mov_b32 v43, 0
    v_mov_b32 v44, 0
    v_mov_b32 v45, 0
    v_mov_b32 v46, 0
    v_mov_b32 v47, 0
L_cb_b_2:
    s_nop 1
    v_mfma_f32_32x32x16_bf16 v[16:31], a[8:11], a[108:111], v[32:47]
    s_nop 7
    s_nop 7
    v_sub_f32 v16, v16, v10
    v_sub_f32 v17, v17, v10
    v_sub_f32 v18, v18, v10
    v_sub_f32 v19, v19, v10
    v_sub_f32 v20, v20, v10
    v_sub_f32 v21, v21, v10
    v_sub_f32 v22, v22, v10
    v_sub_f32 v23, v23, v10
    v_sub_f32 v24, v24, v10
    v_sub_f32 v25, v25, v10
    v_sub_f32 v26, v26, v10
    v_sub_f32 v27, v27, v10
    v_sub_f32 v28, v28, v10
    v_sub_f32 v29, v29, v10
    v_sub_f32 v30, v30, v10
    v_sub_f32 v31, v31, v10
    v_exp_f32 v16, v16
    v_exp_f32 v17, v17
    v_exp_f32 v18, v18
    v_exp_f32 v19, v19
    v_exp_f32 v20, v20
    v_exp_f32 v21, v21
    v_exp_f32 v22, v22
    v_exp_f32 v23, v23
    v_exp_f32 v24, v24
    v_exp_f32 v25, v25
    v_exp_f32 v26, v26
    v_exp_f32 v27, v27
    v_exp_f32 v28, v28
    v_exp_f32 v29, v29
    v_exp_f32 v30, v30
    v_exp_f32 v31, v31
    s_nop 0
    v_cvt_pk_bf16_f32 v64, v16, v17
    v_cvt_pk_bf16_f32 v65, v18, v19
    v_cvt_pk_bf16_f32 v66, v20, v21
    v_cvt_pk_bf16_f32 v67, v22, v23
    v_cvt_pk_bf16_f32 v68, v24, v25
    v_cvt_pk_bf16_f32 v69, v26, v27
    v_cvt_pk_bf16_f32 v70, v28, v29
    v_cvt_pk_bf16_f32 v71, v30, v31
    s_nop 1
    v_mfma_f32_32x32x16_bf16 v[80:95], a[52:55], v[64:67], v[80:95]
    v_mfma_f32_32x32x16_bf16 v[80:95], a[56:59], v[68:71], v[80:95]
    s_nop 7
    s_nop 7
    s_cmp_lg_u32 s53, 3
    s_cbranch_scc1 L_cb_b_3
    v_mov_b32 v32, 0
    v_mov_b32 v33, 0
    v_mov_b32 v34, 0
    v_mov_b32 v35, 0
    v_mov_b32 v36, 0
    v_mov_b32 v37, 0
    v_mov_b32 v38, 0
    v_mov_b32 v39, 0
    v_mov_b32 v40, 0
    v_mov_b32 v41, 0
    v_mov_b32 v42, 0
    v_mov_b32 v43, 0
    v_mov_b32 v44, 0
    v_mov_b32 v45, 0
    v_mov_b32 v46, 0
    v_mov_b32 v47, 0
L_cb_b_3:
    s_nop 1
    v_mfma_f32_32x32x16_bf16 v[16:31], a[12:15], a[108:111], v[32:47]
    s_nop 7
    s_nop 7
    v_sub_f32 v16, v16, v10
    v_sub_f32 v17, v17, v10
    v_sub_f32 v18, v18, v10
    v_sub_f32 v19, v19, v10
    v_sub_f32 v20, v20, v10
    v_sub_f32 v21, v21, v10
    v_sub_f32 v22, v22, v10
    v_sub_f32 v23, v23, v10
    v_sub_f32 v24, v24, v10
    v_sub_f32 v25, v25, v10
    v_sub_f32 v26, v26, v10
    v_sub_f32 v27, v27, v10
    v_sub_f32 v28, v28, v10
    v_sub_f32 v29, v29, v10
    v_sub_f32 v30, v30, v10
    v_sub_f32 v31, v31, v10
    v_exp_f32 v16, v16
    v_exp_f32 v17, v17
    v_exp_f32 v18, v18
    v_exp_f32 v19, v19
    v_exp_f32 v20, v20
    v_exp_f32 v21, v21
    v_exp_f32 v22, v22
    v_exp_f32 v23, v23
    v_exp_f32 v24, v24
    v_exp_f32 v25, v25
    v_exp_f32 v26, v26
    v_exp_f32 v27, v27
    v_exp_f32 v28, v28
    v_exp_f32 v29, v29
    v_exp_f32 v30, v30
    v_exp_f32 v31, v31
    s_nop 0
    v_cvt_pk_bf16_f32 v64, v16, v17
    v_cvt_pk_bf16_f32 v65, v18, v19
    v_cvt_pk_bf16_f32 v66, v20, v21
    v_cvt_pk_bf16_f32 v67, v22, v23
    v_cvt_pk_bf16_f32 v68, v24, v25
    v_cvt_pk_bf16_f32 v69, v26, v27
    v_cvt_pk_bf16_f32 v70, v28, v29
    v_cvt_pk_bf16_f32 v71, v30, v31
    s_nop 1
    v_mfma_f32_32x32x16_bf16 v[80:95], a[60:63], v[64:67], v[80:95]
    v_mfma_f32_32x32x16_bf16 v[80:95], a[64:67], v[68:71], v[80:95]
    s_nop 7
    s_nop 7
    s_cmp_lg_u32 s53, 4
    s_cbranch_scc1 L_cb_b_4
    v_mov_b32 v32, 0
    v_mov_b32 v33, 0
    v_mov_b32 v34, 0
    v_mov_b32 v35, 0
    v_mov_b32 v36, 0
    v_mov_b32 v37, 0
    v_mov_b32 v38, 0
    v_mov_b32 v39, 0
    v_mov_b32 v40, 0
    v_mov_b32 v41, 0
    v_mov_b32 v42, 0
    v_mov_b32 v43, 0
    v_mov_b32 v44, 0
    v_mov_b32 v45, 0
    v_mov_b32 v46, 0
    v_mov_b32 v47, 0
L_cb_b_4:
    s_nop 1
    v_mfma_f32_32x32x16_bf16 v[16:31], a[16:19], a[108:111], v[32:47]
    s_nop 7
    s_nop 7
    v_sub_f32 v16, v16, v10
    v_sub_f32 v17, v17, v10
    v_sub_f32 v18, v18, v10
    v_sub_f32 v19, v19, v10
    v_sub_f32 v20, v20, v10
    v_sub_f32 v21, v21, v10
    v_sub_f32 v22, v22, v10
    v_sub_f32 v23, v23, v10
    v_sub_f32 v24, v24, v10
    v_sub_f32 v25, v25, v10
    v_sub_f32 v26, v26, v10
    v_sub_f32 v27, v27, v10
    v_sub_f32 v28, v28, v10
    v_sub_f32 v29, v29, v10
    v_sub_f32 v30, v30, v10
    v_sub_f32 v31, v31, v10
    v_exp_f32 v16, v16
    v_exp_f32 v17, v17
    v_exp_f32 v18, v18
    v_exp_f32 v19, v19
    v_exp_f32 v20, v20
    v_exp_f32 v21, v21
    v_exp_f32 v22, v22
    v_exp_f32 v23, v23
    v_exp_f32 v24, v24
    v_exp_f32 v25, v25
    v_exp_f32 v26, v26
    v_exp_f32 v27, v27
    v_exp_f32 v28, v28
    v_exp_f32 v29, v29
    v_exp_f32 v30, v30
    v_exp_f32 v31, v31
    s_nop 0
    v_cvt_pk_bf16_f32 v64, v16, v17
    v_cvt_pk_bf16_f32 v65, v18, v19
    v_cvt_pk_bf16_f32 v66, v20, v21
    v_cvt_pk_bf16_f32 v67, v22, v23
    v_cvt_pk_bf16_f32 v68, v24, v25
    v_cvt_pk_bf16_f32 v69, v26, v27
    v_cvt_pk_bf16_f32 v70, v28, v29
    v_cvt_pk_bf16_f32 v71, v30, v31
    s_nop 1
    v_mfma_f32_32x32x16_bf16 v[80:95], a[68:71], v[64:67], v[80:95]
    v_mfma_f32_32x32x16_bf16 v[80:95], a[72:75], v[68:71], v[80:95]
    s_nop 7
    s_nop 7
    s_cmp_lg_u32 s53, 5
    s_cbranch_scc1 L_cb_b_5
    v_mov_b32 v32, 0
    v_mov_b32 v33, 0
    v_mov_b32 v34, 0
    v_mov_b32 v35, 0
    v_mov_b32 v36, 0
    v_mov_b32 v37, 0
    v_mov_b32 v38, 0
    v_mov_b32 v39, 0
    v_mov_b32 v40, 0
    v_mov_b32 v41, 0
    v_mov_b32 v42, 0
    v_mov_b32 v43, 0
    v_mov_b32 v44, 0
    v_mov_b32 v45, 0
    v_mov_b32 v46, 0
    v_mov_b32 v47, 0
L_cb_b_5:
    s_nop 1
    v_mfma_f32_32x32x16_bf16 v[16:31], a[20:23], a[108:111], v[32:47]
    s_nop 7
    s_nop 7
    v_sub_f32 v16, v16, v10
    v_sub_f32 v17, v17, v10
    v_sub_f32 v18, v18, v10
    v_sub_f32 v19, v19, v10
    v_sub_f32 v20, v20, v10
    v_sub_f32 v21, v21, v10
    v_sub_f32 v22, v22, v10
    v_sub_f32 v23, v23, v10
    v_sub_f32 v24, v24, v10
    v_sub_f32 v25, v25, v10
    v_sub_f32 v26, v26, v10
    v_sub_f32 v27, v27, v10
    v_sub_f32 v28, v28, v10
    v_sub_f32 v29, v29, v10
    v_sub_f32 v30, v30, v10
    v_sub_f32 v31, v31, v10
    v_exp_f32 v16, v16
    v_exp_f32 v17, v17
    v_exp_f32 v18, v18
    v_exp_f32 v19, v19
    v_exp_f32 v20, v20
    v_exp_f32 v21, v21
    v_exp_f32 v22, v22
    v_exp_f32 v23, v23
    v_exp_f32 v24, v24
    v_exp_f32 v25, v25
    v_exp_f32 v26, v26
    v_exp_f32 v27, v27
    v_exp_f32 v28, v28
    v_exp_f32 v29, v29
    v_exp_f32 v30, v30
    v_exp_f32 v31, v31
    s_nop 0
    v_cvt_pk_bf16_f32 v64, v16, v17
    v_cvt_pk_bf16_f32 v65, v18, v19
    v_cvt_pk_bf16_f32 v66, v20, v21
    v_cvt_pk_bf16_f32 v67, v22, v23
    v_cvt_pk_bf16_f32 v68, v24, v25
    v_cvt_pk_bf16_f32 v69, v26, v27
    v_cvt_pk_bf16_f32 v70, v28, v29
    v_cvt_pk_bf16_f32 v71, v30, v31
    s_nop 1
    v_mfma_f32_32x32x16_bf16 v[80:95], a[76:79], v[64:67], v[80:95]
    v_mfma_f32_32x32x16_bf16 v[80:95], a[80:83], v[68:71], v[80:95]
    s_nop 7
    s_nop 7
    s_cmp_lg_u32 s53, 6
    s_cbranch_scc1 L_cb_b_6
    v_mov_b32 v32, 0
    v_mov_b32 v33, 0
    v_mov_b32 v34, 0
    v_mov_b32 v35, 0
    v_mov_b32 v36, 0
    v_mov_b32 v37, 0
    v_mov_b32 v38, 0
    v_mov_b32 v39, 0
    v_mov_b32 v40, 0
    v_mov_b32 v41, 0
    v_mov_b32 v42, 0
    v_mov_b32 v43, 0
    v_mov_b32 v44, 0
    v_mov_b32 v45, 0
    v_mov_b32 v46, 0
    v_mov_b32 v47, 0
L_cb_b_6:
    s_nop 1
    v_mfma_f32_32x32x16_bf16 v[16:31], a[24:27], a[108:111], v[32:47]
    s_nop 7
    s_nop 7
    v_sub_f32 v16, v16, v10
    v_sub_f32 v17, v17, v10
    v_sub_f32 v18, v18, v10
    v_sub_f32 v19, v19, v10
    v_sub_f32 v20, v20, v10
    v_sub_f32 v21, v21, v10
    v_sub_f32 v22, v22, v10
    v_sub_f32 v23, v23, v10
    v_sub_f32 v24, v24, v10
    v_sub_f32 v25, v25, v10
    v_sub_f32 v26, v26, v10
    v_sub_f32 v27, v27, v10
    v_sub_f32 v28, v28, v10
    v_sub_f32 v29, v29, v10
    v_sub_f32 v30, v30, v10
    v_sub_f32 v31, v31, v10
    v_exp_f32 v16, v16
    v_exp_f32 v17, v17
    v_exp_f32 v18, v18
    v_exp_f32 v19, v19
    v_exp_f32 v20, v20
    v_exp_f32 v21, v21
    v_exp_f32 v22, v22
    v_exp_f32 v23, v23
    v_exp_f32 v24, v24
    v_exp_f32 v25, v25
    v_exp_f32 v26, v26
    v_exp_f32 v27, v27
    v_exp_f32 v28, v28
    v_exp_f32 v29, v29
    v_exp_f32 v30, v30
    v_exp_f32 v31, v31
    s_nop 0
    v_cvt_pk_bf16_f32 v64, v16, v17
    v_cvt_pk_bf16_f32 v65, v18, v19
    v_cvt_pk_bf16_f32 v66, v20, v21
    v_cvt_pk_bf16_f32 v67, v22, v23
    v_cvt_pk_bf16_f32 v68, v24, v25
    v_cvt_pk_bf16_f32 v69, v26, v27
    v_cvt_pk_bf16_f32 v70, v28, v29
    v_cvt_pk_bf16_f32 v71, v30, v31
    s_nop 1
    v_mfma_f32_32x32x16_bf16 v[80:95], a[84:87], v[64:67], v[80:95]
    v_mfma_f32_32x32x16_bf16 v[80:95], a[88:91], v[68:71], v[80:95]
    s_nop 7
    s_nop 7
    s_cmp_lg_u32 s53, 7
    s_cbranch_scc1 L_cb_b_7
    v_mov_b32 v32, 0
    v_mov_b32 v33, 0
    v_mov_b32 v34, 0
    v_mov_b32 v35, 0
    v_mov_b32 v36, 0
    v_mov_b32 v37, 0
    v_mov_b32 v38, 0
    v_mov_b32 v39, 0
    v_mov_b32 v40, 0
    v_mov_b32 v41, 0
    v_mov_b32 v42, 0
    v_mov_b32 v43, 0
    v_mov_b32 v44, 0
    v_mov_b32 v45, 0
    v_mov_b32 v46, 0
    v_mov_b32 v47, 0
L_cb_b_7:
    s_nop 1
    v_mfma_f32_32x32x16_bf16 v[16:31], a[28:31], a[108:111], v[32:47]
    s_nop 7
    s_nop 7
    v_sub_f32 v16, v16, v10
    v_sub_f32 v17, v17, v10
    v_sub_f32 v18, v18, v10
    v_sub_f32 v19, v19, v10
    v_sub_f32 v20, v20, v10
    v_sub_f32 v21, v21, v10
    v_sub_f32 v22, v22, v10
    v_sub_f32 v23, v23, v10
    v_sub_f32 v24, v24, v10
    v_sub_f32 v25, v25, v10
    v_sub_f32 v26, v26, v10
    v_sub_f32 v27, v27, v10
    v_sub_f32 v28, v28, v10
    v_sub_f32 v29, v29, v10
    v_sub_f32 v30, v30, v10
    v_sub_f32 v31, v31, v10
    v_exp_f32 v16, v16
    v_exp_f32 v17, v17
    v_exp_f32 v18, v18
    v_exp_f32 v19, v19
    v_exp_f32 v20, v20
    v_exp_f32 v21, v21
    v_exp_f32 v22, v22
    v_exp_f32 v23, v23
    v_exp_f32 v24, v24
    v_exp_f32 v25, v25
    v_exp_f32 v26, v26
    v_exp_f32 v27, v27
    v_exp_f32 v28, v28
    v_exp_f32 v29, v29
    v_exp_f32 v30, v30
    v_exp_f32 v31, v31
    s_nop 0
    v_cvt_pk_bf16_f32 v64, v16, v17
    v_cvt_pk_bf16_f32 v65, v18, v19
    v_cvt_pk_bf16_f32 v66, v20, v21
    v_cvt_pk_bf16_f32 v67, v22, v23
    v_cvt_pk_bf16_f32 v68, v24, v25
    v_cvt_pk_bf16_f32 v69, v26, v27
    v_cvt_pk_bf16_f32 v70, v28, v29
    v_cvt_pk_bf16_f32 v71, v30, v31
    s_nop 1
    v_mfma_f32_32x32x16_bf16 v[80:95], a[92:95], v[64:67], v[80:95]
    v_mfma_f32_32x32x16_bf16 v[80:95], a[96:99], v[68:71], v[80:95]
    s_nop 7
    s_nop 7
    v_rcp_f32 v8, v88
    s_cmp_eq_u32 s58, 0
    s_cbranch_scc1 L_at0_ret
    s_branch L_at1_back
L_end:
    s_endpgm
.section .rodata,"a"
.p2align 6
.amdhsa_kernel gated_mix__sliding_block__swiglu_ffn__prompt_kernel
  .amdhsa_next_free_vgpr 256
  .amdhsa_next_free_sgpr 102
  .amdhsa_accum_offset 128
  .amdhsa_group_segment_fixed_size 0
  .amdhsa_kernarg_size 88
  .amdhsa_user_sgpr_count 2
  .amdhsa_user_sgpr_kernarg_segment_ptr 1
  .amdhsa_system_sgpr_workgroup_id_x 1
  .amdhsa_float_denorm_mode_32 3
.end_amdhsa_kernel
```
